```python
import torch

def _softmax(x, axis=-1):
    return torch.softmax(x, dim=axis)

def _gelu(x):
    return torch.nn.functional.gelu(x, approximate='tanh')

def _silu(x):
    return torch.nn.functional.silu(x)

def _sigmoid(x):
    return torch.sigmoid(x)

def _layernorm(x, axis=-1, eps=1e-05):
    m = x.mean(dim=axis, keepdim=True)
    v = x.var(dim=axis, keepdim=True, unbiased=False)
    return (x - m) / torch.sqrt(v + eps)

def _scatter_add(tgt, idx, src, axis=0):
    return tgt.clone().index_add_(axis, idx, src)

def _segment_sum(src, seg, n):
    out = torch.zeros((n,) + src.shape[1:], dtype=src.dtype)
    return out.index_add_(0, seg, src)

def _pad(x, pw):
    flat = tuple((v for pair in reversed(pw) for v in pair))
    return torch.nn.functional.pad(x, flat)
kernel_name = 'gated_mix__ssm_conv_s4__mixer_gmlp__prompt'

def setup_inputs():

    _w = lambda a: (lambda t: t.to(torch.bfloat16) if t.is_floating_point() else t)(torch.as_tensor(a))

    def _A_setup():
        B, L, D, N = (1, 2048, 640, 192)
        A_re = -(lambda _x: torch.exp(torch.as_tensor(_x)))((lambda *s: torch.randn(*s, dtype=torch.bfloat16) * 3.2)(D, N))
        A_im = torch.pi * (lambda *s: torch.randn(*s, dtype=torch.bfloat16) * 0.1)(D, N)
        B_re = (lambda *s: torch.randn(*s, dtype=torch.bfloat16) * 0.8)(D, N)
        B_im = (lambda *s: torch.randn(*s, dtype=torch.bfloat16) * 0.8)(D, N)
        C_re = (lambda *s: torch.randn(*s, dtype=torch.bfloat16) * 0.8)(D, N)
        C_im = (lambda *s: torch.randn(*s, dtype=torch.bfloat16) * 0.8)(D, N)
        log_dt = (lambda *s: torch.randn(*s, dtype=torch.bfloat16) * 0.1)(D) * 0.5 - 4.0
        Dskip = (lambda *s: torch.randn(*s, dtype=torch.bfloat16) * 0.8)(D)
        return {'u': _w((lambda *s: torch.randn(*s, dtype=torch.bfloat16) * 0.05)(B, L, D)), 'A_re': _w(A_re), 'A_im': _w(A_im), 'B_re': _w(B_re), 'B_im': _w(B_im), 'C_re': _w(C_re), 'C_im': _w(C_im), 'log_dt': _w(log_dt), 'Dskip': _w(Dskip)}
    _A_in = _A_setup()

    def _B_setup():
        B, S, D, F = (1, 2048, 640, 1536)
        Fh = F // 2
        return {'x': _w((lambda *s: torch.randn(*s, dtype=torch.bfloat16) * 0.05)(B, S, D)), 'w_in': _w((lambda *s: torch.randn(*s, dtype=torch.bfloat16) * 0.4)(D, 2 * Fh)), 'w_sp': _w(0.01 * (lambda *s: torch.randn(*s, dtype=torch.bfloat16) * 0.4)(S, S)), 'b_sp': _w(1.0 + 0.01 * (lambda *s: torch.randn(*s, dtype=torch.bfloat16) * 0.05)(S)), 'w_out': _w((lambda *s: torch.randn(*s, dtype=torch.bfloat16) * 0.05)(Fh, D))}
    _B_in = _B_setup()
    return {'A_u': _A_in['u'], 'A_A_re': _A_in['A_re'], 'A_A_im': _A_in['A_im'], 'A_B_re': _A_in['B_re'], 'A_B_im': _A_in['B_im'], 'A_C_re': _A_in['C_re'], 'A_C_im': _A_in['C_im'], 'A_log_dt': _A_in['log_dt'], 'A_Dskip': _A_in['Dskip'], 'B_x': _B_in['x'], 'B_w_in': _B_in['w_in'], 'B_w_sp': _B_in['w_sp'], 'B_b_sp': _B_in['b_sp'], 'B_w_out': _B_in['w_out'], 'gate_w': _w((lambda *s: torch.randn(*s, dtype=torch.bfloat16) * 0.05)(640) * 16.0)}

def reference(A_u, A_A_re, A_A_im, A_B_re, A_B_im, A_C_re, A_C_im, A_log_dt, A_Dskip, B_x, B_w_in, B_w_sp, B_b_sp, B_w_out, gate_w):

    def _A_ref(u, A_re, A_im, B_re, B_im, C_re, C_im, log_dt, Dskip):
        Bsz, L, D = u.shape
        dt = torch.exp(log_dt)[:, None]
        A = A_re + 1j * A_im
        Bc = B_re + 1j * B_im
        Cc = C_re + 1j * C_im
        logdA = dt * A
        dB = dt * Bc
        l = (lambda x, dt: x.to(dt))(torch.arange(L), A_re.dtype)
        P = torch.exp(logdA[:, :, None] * l[None, None, :])
        K = torch.einsum('dn,dnl,dn->dl', Cc, P, dB).real
        L2 = 2 * L
        Kp = _pad(K, ((0, 0), (0, L)))
        up = (lambda x, *d: x.permute(*d))(u, 0, 2, 1)
        up = _pad(up, ((0, 0), (0, 0), (0, L)))
        Kf = (lambda x, axes=(-2, -1): torch.fft.rfft2(x.float(), dim=axes))(Kp[:, None, :], axes=(-2, -1))
        Uf = (lambda x, axes=(-2, -1): torch.fft.rfft2(x.float(), dim=axes))(up[:, :, None, :], axes=(-2, -1))
        Yf = Uf * Kf[None, :, :, :]
        y = (lambda x, s, axes=(-2, -1): torch.fft.irfft2(x, s=s, dim=axes).to(torch.bfloat16))(Yf, (1, L2), axes=(-2, -1))[:, :, 0, :L]
        y = (lambda x, *d: x.permute(*d))(y, 0, 2, 1) + u * Dskip[None, None, :]
        return y

    def _B_ref(x, w_in, w_sp, b_sp, w_out):
        B, S, D = x.shape
        F = w_in.shape[-1]
        Fh = F // 2
        z = _gelu(torch.einsum('bsd,df->bsf', x, w_in))
        z1 = z[..., :Fh].clone()
        z2 = _layernorm(z[..., Fh:], axis=-1)
        g = torch.einsum('ts,bsf->btf', w_sp, z2) + b_sp[None, :, None]
        return torch.einsum('bsf,fd->bsd', z1 * g, w_out)
    x = A_u
    g = _sigmoid((x * gate_w).sum(-1, keepdims=True))
    a = _A_ref(x, A_A_re, A_A_im, A_B_re, A_B_im, A_C_re, A_C_im, A_log_dt, A_Dskip)
    b = _B_ref(x, B_w_in, B_w_sp, B_b_sp, B_w_out)
    return g * a + (1 - g) * b
```

```asm
; @launch grid=(256,1,1) block=(768,1,1) lds=163840
.amdgcn_target "amdgcn-amd-amdhsa--gfx950"
.text
.globl gated_mix__ssm_conv_s4__mixer_gmlp__prompt_kernel
.p2align 8
.type gated_mix__ssm_conv_s4__mixer_gmlp__prompt_kernel,@function
gated_mix__ssm_conv_s4__mixer_gmlp__prompt_kernel:
f_start:
    s_cmp_ge_u32 s2, 256
    s_cbranch_scc1 f_end
    s_load_dwordx4 s[92:95], s[0:1], 128
    v_lshrrev_b32 v2, 6, v0
    v_and_b32 v1, 63, v0
    v_readfirstlane_b32 s96, v2
    v_lshlrev_b32 v2, 2, v1
    v_add_u32 v2, 163824, v2
    v_mov_b32 v3, 0
    s_mov_b64 exec, 0x7
    ds_write_b32 v2, v3
    s_mov_b64 exec, -1
    s_cmp_ge_u32 s2, 192
    s_cbranch_scc1 f_aux
    s_load_dwordx2 s[4:5], s[0:1], 0
    s_load_dwordx2 s[6:7], s[0:1], 80
    s_load_dwordx4 s[8:11], s[0:1], 88
    s_and_b32 s46, s2, 7
    s_lshr_b32 s47, s2, 3
    s_lshr_b32 s44, s46, 1
    s_lshl_b32 s44, s44, 3
    s_and_b32 s45, s47, 7
    s_add_u32 s44, s44, s45
    s_and_b32 s46, s46, 1
    s_mul_i32 s46, s46, 3
    s_lshr_b32 s45, s47, 3
    s_add_u32 s45, s45, s46
    s_and_b32 s46, s2, 7
    s_lshr_b32 s47, s2, 3
    s_lshr_b32 s70, s46, 1
    s_lshl_b32 s70, s70, 2
    s_and_b32 s71, s47, 3
    s_add_u32 s70, s70, s71
    s_and_b32 s71, s46, 1
    s_mul_i32 s71, s71, 6
    s_lshr_b32 s47, s47, 2
    s_add_u32 s71, s71, s47
    s_cmp_lt_u32 s96, 8
    s_cbranch_scc1 m_cons11
    s_sub_u32 s54, s96, 8
    v_lshrrev_b32 v2, 3, v1
    v_and_b32 v3, 7, v1
    v_lshrrev_b32 v4, 1, v2
    v_xor_b32 v4, v3, v4
    v_lshlrev_b32 v4, 4, v4
    s_lshl_b32 s46, s54, 4
    v_add_u32 v5, s46, v2
    v_mul_u32_u24 v5, 1280, v5
    v_add_u32 v5, 4096, v5
    v_add_u32 v8, v5, v4
    v_xor_b32 v4, 64, v4
    v_add_u32 v9, v5, v4
    v_add_u32 v9, 9216, v9
    v_lshrrev_b32 v2, 4, v1
    v_and_b32 v3, 15, v1
    v_lshlrev_b32 v4, 1, v2
    v_xor_b32 v4, v3, v4
    v_lshlrev_b32 v4, 4, v4
    v_add_u32 v5, s46, v2
    v_mul_u32_u24 v5, 3072, v5
    v_add_u32 v2, v5, v4
    v_xor_b32 v4, 128, v4
    v_add_u32 v3, v5, v4
    v_add_u32 v10, 4096, v2
    v_add_u32 v11, 15360, v2
    v_add_u32 v12, 26624, v3
    v_add_u32 v13, 37888, v3
    s_lshl_b32 s52, s54, 11
    s_lshl_b32 s53, s54, 12
    s_add_u32 s53, s53, 8192
    s_waitcnt lgkmcnt(0)
    s_mul_i32 s46, s44, 81920
    s_sub_u32 s4, s4, 4096
    s_subb_u32 s5, s5, 0
    s_add_u32 s16, s4, s46
    s_addc_u32 s17, s5, 0
    s_mov_b32 s18, 0x15000
    s_mov_b32 s19, 0x00020000
    s_lshl_b32 s46, s45, 8
    s_sub_u32 s6, s6, 4096
    s_subb_u32 s7, s7, 0
    s_add_u32 s20, s6, s46
    s_addc_u32 s21, s7, 0
    s_mov_b32 s22, 0x1e0b00
    s_mov_b32 s23, 0x00020000
    s_add_u32 m0, s52, 32768
    s_movk_i32 s50, 0
    buffer_load_dwordx4 v8, s[16:19], s50 offen lds
    s_mov_b32 s51, 1536
    buffer_load_dwordx4 v9, s[16:19], s50 offen offset:1024 lds
    s_add_u32 m0, s53, 32768
    s_nop 0
    buffer_load_dwordx4 v10, s[20:23], s51 offen offset:0 lds
    buffer_load_dwordx4 v11, s[20:23], s51 offen offset:1024 lds
    buffer_load_dwordx4 v12, s[20:23], s51 offen offset:2048 lds
    buffer_load_dwordx4 v13, s[20:23], s51 offen offset:3072 lds
    s_add_u32 m0, s52, 57344
    s_movk_i32 s50, 128
    buffer_load_dwordx4 v8, s[16:19], s50 offen lds
    s_mov_b32 s51, 198144
    buffer_load_dwordx4 v9, s[16:19], s50 offen offset:1024 lds
    s_add_u32 m0, s53, 57344
    s_nop 0
    buffer_load_dwordx4 v10, s[20:23], s51 offen offset:0 lds
    buffer_load_dwordx4 v11, s[20:23], s51 offen offset:1024 lds
    buffer_load_dwordx4 v12, s[20:23], s51 offen offset:2048 lds
    buffer_load_dwordx4 v13, s[20:23], s51 offen offset:3072 lds
    s_add_u32 s88, s94, 0x1400000
    s_addc_u32 s89, s95, 0
    s_mov_b32 s90, 0x40000
    s_mov_b32 s91, 0x00020000
    v_lshrrev_b32 v2, 3, v1
    v_and_b32 v3, 7, v1
    v_lshrrev_b32 v4, 1, v2
    v_xor_b32 v4, v3, v4
    v_lshlrev_b32 v4, 4, v4
    s_lshl_b32 s46, s54, 5
    v_add_u32 v5, s46, v2
    v_mul_u32_u24 v5, 1280, v5
    v_add_u32 v84, v5, v4
    v_xor_b32 v4, 64, v4
    v_add_u32 v85, v5, v4
    v_add_u32 v86, 22528, v84
    v_add_u32 v87, 31744, v85
    v_add_u32 v85, 13312, v85
    v_add_u32 v84, 4096, v84
    v_and_b32 v4, 2, v2
    v_xor_b32 v4, v4, v3
    v_lshlrev_b32 v4, 4, v4
    s_lshl_b32 s46, s54, 4
    v_add_u32 v5, s46, v2
    v_mul_u32_u24 v5, 3072, v5
    v_add_u32 v88, v5, v4
    v_xor_b32 v4, 64, v4
    v_add_u32 v89, v5, v4
    v_add_u32 v89, 27648, v89
    v_add_u32 v88, 4096, v88
    s_mul_i32 s46, s70, 163840
    s_add_u32 s24, s4, s46
    s_addc_u32 s25, s5, 0
    s_mov_b32 s26, 0x29000
    s_mov_b32 s27, 0x00020000
    s_lshl_b32 s46, s71, 7
    s_add_u32 s28, s6, s46
    s_addc_u32 s29, s7, 0
    s_mov_b32 s30, 0x1e0480
    s_mov_b32 s31, 0x00020000
    s_add_u32 m0, s52, 81920
    s_movk_i32 s50, 256
    buffer_load_dwordx4 v8, s[16:19], s50 offen lds
    s_mov_b32 s51, 394752
    buffer_load_dwordx4 v9, s[16:19], s50 offen offset:1024 lds
    s_add_u32 m0, s53, 81920
    s_nop 0
    buffer_load_dwordx4 v10, s[20:23], s51 offen offset:0 lds
    buffer_load_dwordx4 v11, s[20:23], s51 offen offset:1024 lds
    buffer_load_dwordx4 v12, s[20:23], s51 offen offset:2048 lds
    buffer_load_dwordx4 v13, s[20:23], s51 offen offset:3072 lds
    s_add_u32 m0, s52, 106496
    s_movk_i32 s50, 384
    buffer_load_dwordx4 v8, s[16:19], s50 offen lds
    s_mov_b32 s51, 591360
    buffer_load_dwordx4 v9, s[16:19], s50 offen offset:1024 lds
    s_add_u32 m0, s53, 106496
    s_nop 0
    buffer_load_dwordx4 v10, s[20:23], s51 offen offset:0 lds
    buffer_load_dwordx4 v11, s[20:23], s51 offen offset:1024 lds
    buffer_load_dwordx4 v12, s[20:23], s51 offen offset:2048 lds
    buffer_load_dwordx4 v13, s[20:23], s51 offen offset:3072 lds
    s_add_u32 m0, s52, 131072
    s_movk_i32 s50, 512
    buffer_load_dwordx4 v8, s[16:19], s50 offen lds
    s_mov_b32 s51, 787968
    buffer_load_dwordx4 v9, s[16:19], s50 offen offset:1024 lds
    s_add_u32 m0, s53, 131072
    s_nop 0
    buffer_load_dwordx4 v10, s[20:23], s51 offen offset:0 lds
    buffer_load_dwordx4 v11, s[20:23], s51 offen offset:1024 lds
    buffer_load_dwordx4 v12, s[20:23], s51 offen offset:2048 lds
    buffer_load_dwordx4 v13, s[20:23], s51 offen offset:3072 lds
    s_waitcnt vmcnt(24)
    s_barrier
    s_lshr_b32 s74, s2, 3
    s_lshl_b32 s74, s74, 7
    s_waitcnt vmcnt(18)
    s_barrier
    s_add_u32 m0, s52, 32768
    s_movk_i32 s50, 640
    buffer_load_dwordx4 v8, s[16:19], s50 offen lds
    s_mov_b32 s51, 984576
    buffer_load_dwordx4 v9, s[16:19], s50 offen offset:1024 lds
    s_add_u32 m0, s53, 32768
    s_nop 0
    buffer_load_dwordx4 v10, s[20:23], s51 offen offset:0 lds
    buffer_load_dwordx4 v11, s[20:23], s51 offen offset:1024 lds
    buffer_load_dwordx4 v12, s[20:23], s51 offen offset:2048 lds
    buffer_load_dwordx4 v13, s[20:23], s51 offen offset:3072 lds
    s_waitcnt vmcnt(18)
    s_barrier
    s_add_u32 m0, s52, 57344
    s_movk_i32 s50, 768
    buffer_load_dwordx4 v8, s[16:19], s50 offen lds
    s_mov_b32 s51, 1181184
    buffer_load_dwordx4 v9, s[16:19], s50 offen offset:1024 lds
    s_add_u32 m0, s53, 57344
    s_nop 0
    buffer_load_dwordx4 v10, s[20:23], s51 offen offset:0 lds
    buffer_load_dwordx4 v11, s[20:23], s51 offen offset:1024 lds
    buffer_load_dwordx4 v12, s[20:23], s51 offen offset:2048 lds
    buffer_load_dwordx4 v13, s[20:23], s51 offen offset:3072 lds
    s_waitcnt vmcnt(18)
    s_barrier
    s_add_u32 m0, s52, 81920
    s_movk_i32 s50, 896
    buffer_load_dwordx4 v8, s[16:19], s50 offen lds
    s_mov_b32 s51, 1377792
    buffer_load_dwordx4 v9, s[16:19], s50 offen offset:1024 lds
    s_add_u32 m0, s53, 81920
    s_nop 0
    buffer_load_dwordx4 v10, s[20:23], s51 offen offset:0 lds
    buffer_load_dwordx4 v11, s[20:23], s51 offen offset:1024 lds
    buffer_load_dwordx4 v12, s[20:23], s51 offen offset:2048 lds
    buffer_load_dwordx4 v13, s[20:23], s51 offen offset:3072 lds
    s_waitcnt vmcnt(18)
    s_barrier
    s_add_u32 m0, s52, 106496
    s_movk_i32 s50, 1024
    buffer_load_dwordx4 v8, s[16:19], s50 offen lds
    s_mov_b32 s51, 1574400
    buffer_load_dwordx4 v9, s[16:19], s50 offen offset:1024 lds
    s_add_u32 m0, s53, 106496
    s_nop 0
    buffer_load_dwordx4 v10, s[20:23], s51 offen offset:0 lds
    buffer_load_dwordx4 v11, s[20:23], s51 offen offset:1024 lds
    buffer_load_dwordx4 v12, s[20:23], s51 offen offset:2048 lds
    buffer_load_dwordx4 v13, s[20:23], s51 offen offset:3072 lds
    s_waitcnt vmcnt(18)
    s_barrier
    s_add_u32 m0, s52, 131072
    s_movk_i32 s50, 1152
    buffer_load_dwordx4 v8, s[16:19], s50 offen lds
    s_mov_b32 s51, 1771008
    buffer_load_dwordx4 v9, s[16:19], s50 offen offset:1024 lds
    s_add_u32 m0, s53, 131072
    s_nop 0
    buffer_load_dwordx4 v10, s[20:23], s51 offen offset:0 lds
    buffer_load_dwordx4 v11, s[20:23], s51 offen offset:1024 lds
    buffer_load_dwordx4 v12, s[20:23], s51 offen offset:2048 lds
    buffer_load_dwordx4 v13, s[20:23], s51 offen offset:3072 lds
    s_waitcnt vmcnt(18)
    s_barrier
    s_add_u32 m0, s52, 49152
    s_mov_b32 s51, 0
    buffer_load_dwordx4 v88, s[28:31], s51 offen offset:0 lds
    buffer_load_dwordx4 v89, s[28:31], s51 offen offset:1024 lds
    s_add_u32 m0, s53, 24576
    s_movk_i32 s50, 0
    buffer_load_dwordx4 v84, s[24:27], s50 offen offset:0 lds
    buffer_load_dwordx4 v85, s[24:27], s50 offen offset:1024 lds
    buffer_load_dwordx4 v86, s[24:27], s50 offen offset:2048 lds
    buffer_load_dwordx4 v87, s[24:27], s50 offen offset:3072 lds
    s_waitcnt vmcnt(18)
    s_barrier
    s_add_u32 m0, s52, 73728
    s_mov_b32 s51, 196608
    buffer_load_dwordx4 v88, s[28:31], s51 offen offset:0 lds
    buffer_load_dwordx4 v89, s[28:31], s51 offen offset:1024 lds
    s_add_u32 m0, s53, 49152
    s_movk_i32 s50, 128
    buffer_load_dwordx4 v84, s[24:27], s50 offen offset:0 lds
    buffer_load_dwordx4 v85, s[24:27], s50 offen offset:1024 lds
    buffer_load_dwordx4 v86, s[24:27], s50 offen offset:2048 lds
    buffer_load_dwordx4 v87, s[24:27], s50 offen offset:3072 lds
    s_waitcnt vmcnt(18)
    s_barrier
    s_add_u32 m0, s52, 98304
    s_mov_b32 s51, 393216
    buffer_load_dwordx4 v88, s[28:31], s51 offen offset:0 lds
    buffer_load_dwordx4 v89, s[28:31], s51 offen offset:1024 lds
    s_add_u32 m0, s53, 73728
    s_movk_i32 s50, 256
    buffer_load_dwordx4 v84, s[24:27], s50 offen offset:0 lds
    buffer_load_dwordx4 v85, s[24:27], s50 offen offset:1024 lds
    buffer_load_dwordx4 v86, s[24:27], s50 offen offset:2048 lds
    buffer_load_dwordx4 v87, s[24:27], s50 offen offset:3072 lds
    s_waitcnt vmcnt(18)
    s_barrier
    s_add_u32 m0, s52, 122880
    s_mov_b32 s51, 589824
    buffer_load_dwordx4 v88, s[28:31], s51 offen offset:0 lds
    buffer_load_dwordx4 v89, s[28:31], s51 offen offset:1024 lds
    s_add_u32 m0, s53, 98304
    s_movk_i32 s50, 384
    buffer_load_dwordx4 v84, s[24:27], s50 offen offset:0 lds
    buffer_load_dwordx4 v85, s[24:27], s50 offen offset:1024 lds
    buffer_load_dwordx4 v86, s[24:27], s50 offen offset:2048 lds
    buffer_load_dwordx4 v87, s[24:27], s50 offen offset:3072 lds
    s_waitcnt vmcnt(18)
    s_barrier
    s_add_u32 m0, s52, 147456
    s_mov_b32 s51, 786432
    buffer_load_dwordx4 v88, s[28:31], s51 offen offset:0 lds
    buffer_load_dwordx4 v89, s[28:31], s51 offen offset:1024 lds
    s_add_u32 m0, s53, 122880
    s_movk_i32 s50, 512
    buffer_load_dwordx4 v84, s[24:27], s50 offen offset:0 lds
    buffer_load_dwordx4 v85, s[24:27], s50 offen offset:1024 lds
    buffer_load_dwordx4 v86, s[24:27], s50 offen offset:2048 lds
    buffer_load_dwordx4 v87, s[24:27], s50 offen offset:3072 lds
    s_waitcnt vmcnt(18)
    s_barrier
    s_add_u32 m0, s52, 49152
    s_mov_b32 s51, 983040
    buffer_load_dwordx4 v88, s[28:31], s51 offen offset:0 lds
    buffer_load_dwordx4 v89, s[28:31], s51 offen offset:1024 lds
    s_add_u32 m0, s53, 24576
    s_movk_i32 s50, 640
    buffer_load_dwordx4 v84, s[24:27], s50 offen offset:0 lds
    buffer_load_dwordx4 v85, s[24:27], s50 offen offset:1024 lds
    buffer_load_dwordx4 v86, s[24:27], s50 offen offset:2048 lds
    buffer_load_dwordx4 v87, s[24:27], s50 offen offset:3072 lds
    s_waitcnt vmcnt(18)
    s_barrier
    s_add_u32 m0, s52, 73728
    s_mov_b32 s51, 1179648
    buffer_load_dwordx4 v88, s[28:31], s51 offen offset:0 lds
    buffer_load_dwordx4 v89, s[28:31], s51 offen offset:1024 lds
    s_add_u32 m0, s53, 49152
    s_movk_i32 s50, 768
    buffer_load_dwordx4 v84, s[24:27], s50 offen offset:0 lds
    buffer_load_dwordx4 v85, s[24:27], s50 offen offset:1024 lds
    buffer_load_dwordx4 v86, s[24:27], s50 offen offset:2048 lds
    buffer_load_dwordx4 v87, s[24:27], s50 offen offset:3072 lds
    s_waitcnt vmcnt(18)
    s_barrier
    s_add_u32 m0, s52, 98304
    s_mov_b32 s51, 1376256
    buffer_load_dwordx4 v88, s[28:31], s51 offen offset:0 lds
    buffer_load_dwordx4 v89, s[28:31], s51 offen offset:1024 lds
    s_add_u32 m0, s53, 73728
    s_movk_i32 s50, 896
    buffer_load_dwordx4 v84, s[24:27], s50 offen offset:0 lds
    buffer_load_dwordx4 v85, s[24:27], s50 offen offset:1024 lds
    buffer_load_dwordx4 v86, s[24:27], s50 offen offset:2048 lds
    buffer_load_dwordx4 v87, s[24:27], s50 offen offset:3072 lds
    s_waitcnt vmcnt(18)
    s_barrier
    s_lshl_b32 s46, s2, 10
    s_add_u32 s46, s46, 640
    v_lshlrev_b32 v32, 2, v1
    v_and_b32 v32, 63, v32
    buffer_load_dword v33, v32, s[88:91], s46 offen sc1
    s_add_u32 m0, s52, 122880
    s_mov_b32 s51, 1572864
    buffer_load_dwordx4 v88, s[28:31], s51 offen offset:0 lds
    buffer_load_dwordx4 v89, s[28:31], s51 offen offset:1024 lds
    s_add_u32 m0, s53, 98304
    s_movk_i32 s50, 1024
    buffer_load_dwordx4 v84, s[24:27], s50 offen offset:0 lds
    buffer_load_dwordx4 v85, s[24:27], s50 offen offset:1024 lds
    buffer_load_dwordx4 v86, s[24:27], s50 offen offset:2048 lds
    buffer_load_dwordx4 v87, s[24:27], s50 offen offset:3072 lds
    s_waitcnt vmcnt(18)
    s_barrier
    s_add_u32 m0, s52, 147456
    s_mov_b32 s51, 1769472
    buffer_load_dwordx4 v88, s[28:31], s51 offen offset:0 lds
    buffer_load_dwordx4 v89, s[28:31], s51 offen offset:1024 lds
    s_add_u32 m0, s53, 122880
    s_movk_i32 s50, 1152
    buffer_load_dwordx4 v84, s[24:27], s50 offen offset:0 lds
    buffer_load_dwordx4 v85, s[24:27], s50 offen offset:1024 lds
    buffer_load_dwordx4 v86, s[24:27], s50 offen offset:2048 lds
    buffer_load_dwordx4 v87, s[24:27], s50 offen offset:3072 lds
    s_waitcnt vmcnt(18)
    s_barrier
    v_lshrrev_b32 v2, 3, v1
    v_and_b32 v3, 7, v1
    v_lshrrev_b32 v4, 1, v2
    v_xor_b32 v3, v3, v4
    v_lshlrev_b32 v3, 4, v3
    v_lshl_add_u32 v3, v2, 12, v3
    v_xor_b32 v4, 64, v3
    s_lshl_b32 s46, s54, 17
    s_add_u32 s47, s46, 4096
    v_add_u32 v20, s47, v3
    s_add_u32 s47, s46, 35840
    v_add_u32 v21, s47, v4
    s_add_u32 s47, s46, 67584
    v_add_u32 v22, s47, v3
    s_add_u32 s47, s46, 99328
    v_add_u32 v23, s47, v4
    s_lshl_b32 s46, s70, 19
    s_sub_u32 s8, s8, 4096
    s_subb_u32 s9, s9, 0
    s_add_u32 s24, s8, s46
    s_addc_u32 s25, s9, 0
    s_mov_b32 s26, 0x81000
    s_mov_b32 s27, 0x00020000
    s_lshl_b32 s46, s54, 16
    v_add_u32 v60, s46, v3
    s_add_u32 s46, s46, 31744
    v_add_u32 v61, s46, v4
    s_lshl_b32 s46, s71, 18
    s_add_u32 s46, s46, 3145728
    s_add_u32 s32, s94, s46
    s_addc_u32 s33, s95, 0
    s_mov_b32 s34, 0x40000
    s_mov_b32 s35, 0x00020000
    s_waitcnt vmcnt(12)
    s_barrier
    v_mov_b32 v34, 163836
    ds_read_b32 v34, v34
    s_waitcnt lgkmcnt(0)
    v_readfirstlane_b32 s97, v34
    s_nop 1
    v_cmp_ne_u32 vcc, s97, v33
    s_nop 1
    s_cmp_eq_u64 vcc, 0
    s_cbranch_scc1 m_fwok2
    v_mov_b32 v32, 163836
    ds_read_b32 v32, v32
    s_waitcnt lgkmcnt(0)
    v_readfirstlane_b32 s97, v32
    s_nop 1
    s_lshl_b32 s46, s2, 10
    s_add_u32 s46, s46, 640
    v_lshlrev_b32 v32, 2, v1
    v_cmp_gt_u32 vcc, 16, v1
    s_mov_b32 s76, 100000
    s_mov_b64 exec, vcc
m_poll3:
    s_sub_u32 s76, s76, 1
    s_cbranch_scc1 m_polld4
    buffer_load_dword v33, v32, s[88:91], s46 offen sc1
    s_waitcnt vmcnt(0)
    v_cmp_ne_u32 vcc, s97, v33
    s_nop 1
    s_cmp_eq_u64 vcc, 0
    s_cbranch_scc1 m_polld4
    s_sleep 1
    s_branch m_poll3
m_polld4:
    s_mov_b64 exec, -1
m_fwok2:
    s_and_b32 s46, s2, 7
    s_lshr_b32 s47, s2, 3
    s_lshl_b32 s72, s46, 2
    s_and_b32 s46, s47, 3
    s_add_u32 s72, s72, s46
    s_lshr_b32 s73, s47, 2
    s_sub_i32 s48, s96, 2
    s_max_i32 s48, s48, 0
    s_cmp_ge_u32 s48, 5
    s_cselect_b32 s46, 5, 0
    s_cselect_b32 s47, 12288, 0
    s_sub_u32 s48, s48, s46
    s_mul_i32 s46, s73, 5
    s_add_u32 s46, s46, s48
    s_mul_i32 s46, s46, 24576
    s_add_u32 s46, s46, s47
    s_add_u32 s46, s46, 22020096
    s_add_u32 s40, s94, s46
    s_addc_u32 s41, s95, 0
    s_mov_b32 s42, 0x3000
    s_mov_b32 s43, 0x00020000
    v_lshlrev_b32 v62, 4, v1
    s_waitcnt vmcnt(6)
    s_barrier
    s_waitcnt vmcnt(0)
    s_barrier
    s_barrier
    s_add_u32 s46, s74, 0
    s_add_u32 m0, s53, 98304
    s_and_b32 s46, s46, 0xfff
    buffer_load_dwordx4 v20, s[24:27], s46 offen offset:0 lds
    buffer_load_dwordx4 v21, s[24:27], s46 offen offset:1024 lds
    buffer_load_dwordx4 v22, s[24:27], s46 offen offset:2048 lds
    buffer_load_dwordx4 v23, s[24:27], s46 offen offset:3072 lds
    s_add_u32 s46, s74, 128
    s_add_u32 m0, s53, 122880
    s_and_b32 s46, s46, 0xfff
    buffer_load_dwordx4 v20, s[24:27], s46 offen offset:0 lds
    buffer_load_dwordx4 v21, s[24:27], s46 offen offset:1024 lds
    buffer_load_dwordx4 v22, s[24:27], s46 offen offset:2048 lds
    buffer_load_dwordx4 v23, s[24:27], s46 offen offset:3072 lds
    s_movk_i32 s46, 0
    buffer_load_dwordx4 v[64:67], v62, s[40:43], s46 offen offset:0 sc1
    buffer_load_dwordx4 v[68:71], v62, s[40:43], s46 offen offset:1024 sc1
    buffer_load_dwordx4 v[72:75], v62, s[40:43], s46 offen offset:2048 sc1
    buffer_load_dwordx4 v[76:79], v62, s[40:43], s46 offen offset:3072 sc1
    s_movk_i32 s46, 4096
    buffer_load_dwordx4 v[80:83], v62, s[40:43], s46 offen offset:0 sc1
    buffer_load_dwordx4 v[84:87], v62, s[40:43], s46 offen offset:1024 sc1
    buffer_load_dwordx4 v[88:91], v62, s[40:43], s46 offen offset:2048 sc1
    buffer_load_dwordx4 v[92:95], v62, s[40:43], s46 offen offset:3072 sc1
    s_movk_i32 s46, 8192
    buffer_load_dwordx4 v[96:99], v62, s[40:43], s46 offen offset:0 sc1
    buffer_load_dwordx4 v[100:103], v62, s[40:43], s46 offen offset:1024 sc1
    buffer_load_dwordx4 v[104:107], v62, s[40:43], s46 offen offset:2048 sc1
    buffer_load_dwordx4 v[108:111], v62, s[40:43], s46 offen offset:3072 sc1
    v_mov_b32 v32, 163836
    ds_read_b32 v32, v32
    s_waitcnt lgkmcnt(0)
    v_readfirstlane_b32 s97, v32
    s_nop 1
    s_lshl_b32 s46, s2, 10
    s_add_u32 s46, s46, 128
    v_lshlrev_b32 v32, 2, v1
    v_cmp_gt_u32 vcc, 32, v1
    s_mov_b32 s76, 100000
    s_mov_b64 exec, vcc
m_poll5:
    s_sub_u32 s76, s76, 1
    s_cbranch_scc1 m_polld6
    buffer_load_dword v33, v32, s[88:91], s46 offen sc1
    s_waitcnt vmcnt(0)
    v_cmp_ne_u32 vcc, s97, v33
    s_nop 1
    s_cmp_eq_u64 vcc, 0
    s_cbranch_scc1 m_polld6
    s_sleep 1
    s_branch m_poll5
m_polld6:
    s_mov_b64 exec, -1
    s_add_u32 s46, s74, 0
    s_add_u32 m0, s52, 98304
    s_and_b32 s46, s46, 0xfff
    buffer_load_dwordx4 v60, s[32:35], s46 offen offset:0 sc1 lds
    buffer_load_dwordx4 v61, s[32:35], s46 offen offset:1024 sc1 lds
    s_add_u32 s46, s74, 128
    s_add_u32 m0, s52, 122880
    s_and_b32 s46, s46, 0xfff
    buffer_load_dwordx4 v60, s[32:35], s46 offen offset:0 sc1 lds
    buffer_load_dwordx4 v61, s[32:35], s46 offen offset:1024 sc1 lds
    s_add_u32 s46, s74, 512
    s_add_u32 m0, s53, 49152
    s_and_b32 s46, s46, 0xfff
    buffer_load_dwordx4 v20, s[24:27], s46 offen offset:0 lds
    buffer_load_dwordx4 v21, s[24:27], s46 offen offset:1024 lds
    buffer_load_dwordx4 v22, s[24:27], s46 offen offset:2048 lds
    buffer_load_dwordx4 v23, s[24:27], s46 offen offset:3072 lds
    s_add_u32 s46, s74, 512
    s_add_u32 m0, s52, 49152
    s_and_b32 s46, s46, 0xfff
    buffer_load_dwordx4 v60, s[32:35], s46 offen offset:0 sc1 lds
    buffer_load_dwordx4 v61, s[32:35], s46 offen offset:1024 sc1 lds
    s_add_u32 s46, s74, 640
    s_add_u32 m0, s53, 73728
    s_and_b32 s46, s46, 0xfff
    buffer_load_dwordx4 v20, s[24:27], s46 offen offset:0 lds
    buffer_load_dwordx4 v21, s[24:27], s46 offen offset:1024 lds
    buffer_load_dwordx4 v22, s[24:27], s46 offen offset:2048 lds
    buffer_load_dwordx4 v23, s[24:27], s46 offen offset:3072 lds
    s_add_u32 s46, s74, 640
    s_add_u32 m0, s52, 73728
    s_and_b32 s46, s46, 0xfff
    buffer_load_dwordx4 v60, s[32:35], s46 offen offset:0 sc1 lds
    buffer_load_dwordx4 v61, s[32:35], s46 offen offset:1024 sc1 lds
    s_waitcnt vmcnt(14)
    s_barrier
    s_add_u32 s46, s74, 256
    s_add_u32 m0, s53, 0
    s_and_b32 s46, s46, 0xfff
    buffer_load_dwordx4 v20, s[24:27], s46 offen offset:0 lds
    buffer_load_dwordx4 v21, s[24:27], s46 offen offset:1024 lds
    buffer_load_dwordx4 v22, s[24:27], s46 offen offset:2048 lds
    buffer_load_dwordx4 v23, s[24:27], s46 offen offset:3072 lds
    s_add_u32 s46, s74, 384
    s_add_u32 m0, s53, 24576
    s_and_b32 s46, s46, 0xfff
    buffer_load_dwordx4 v20, s[24:27], s46 offen offset:0 lds
    buffer_load_dwordx4 v21, s[24:27], s46 offen offset:1024 lds
    buffer_load_dwordx4 v22, s[24:27], s46 offen offset:2048 lds
    buffer_load_dwordx4 v23, s[24:27], s46 offen offset:3072 lds
    s_add_u32 s75, s74, 768
    s_and_b32 s75, s75, 0xfff
    s_waitcnt vmcnt(20)
    s_barrier
    s_add_u32 m0, s53, 98304
    s_nop 0
    buffer_load_dwordx4 v20, s[24:27], s75 offen offset:0 lds
    buffer_load_dwordx4 v21, s[24:27], s75 offen offset:1024 lds
    buffer_load_dwordx4 v22, s[24:27], s75 offen offset:2048 lds
    buffer_load_dwordx4 v23, s[24:27], s75 offen offset:3072 lds
    s_add_u32 s75, s75, 128
    s_and_b32 s75, s75, 0xfff
    s_waitcnt vmcnt(8)
    s_barrier
    s_add_u32 m0, s53, 122880
    s_nop 0
    buffer_load_dwordx4 v20, s[24:27], s75 offen offset:0 lds
    buffer_load_dwordx4 v21, s[24:27], s75 offen offset:1024 lds
    buffer_load_dwordx4 v22, s[24:27], s75 offen offset:2048 lds
    buffer_load_dwordx4 v23, s[24:27], s75 offen offset:3072 lds
    s_add_u32 s75, s75, 128
    s_and_b32 s75, s75, 0xfff
    s_waitcnt vmcnt(8)
    s_barrier
    s_add_u32 m0, s53, 0
    s_nop 0
    buffer_load_dwordx4 v20, s[24:27], s75 offen offset:0 lds
    buffer_load_dwordx4 v21, s[24:27], s75 offen offset:1024 lds
    buffer_load_dwordx4 v22, s[24:27], s75 offen offset:2048 lds
    buffer_load_dwordx4 v23, s[24:27], s75 offen offset:3072 lds
    s_add_u32 s75, s75, 128
    s_and_b32 s75, s75, 0xfff
    s_waitcnt vmcnt(12)
    s_barrier
    s_add_u32 m0, s53, 24576
    s_nop 0
    buffer_load_dwordx4 v20, s[24:27], s75 offen offset:0 lds
    buffer_load_dwordx4 v21, s[24:27], s75 offen offset:1024 lds
    buffer_load_dwordx4 v22, s[24:27], s75 offen offset:2048 lds
    buffer_load_dwordx4 v23, s[24:27], s75 offen offset:3072 lds
    s_add_u32 s75, s75, 128
    s_and_b32 s75, s75, 0xfff
    s_waitcnt vmcnt(16)
    s_barrier
    s_add_u32 m0, s53, 49152
    s_nop 0
    buffer_load_dwordx4 v20, s[24:27], s75 offen offset:0 lds
    buffer_load_dwordx4 v21, s[24:27], s75 offen offset:1024 lds
    buffer_load_dwordx4 v22, s[24:27], s75 offen offset:2048 lds
    buffer_load_dwordx4 v23, s[24:27], s75 offen offset:3072 lds
    s_add_u32 s75, s75, 128
    s_and_b32 s75, s75, 0xfff
    s_waitcnt vmcnt(16)
    s_barrier
    s_add_u32 m0, s53, 73728
    s_nop 0
    buffer_load_dwordx4 v20, s[24:27], s75 offen offset:0 lds
    buffer_load_dwordx4 v21, s[24:27], s75 offen offset:1024 lds
    buffer_load_dwordx4 v22, s[24:27], s75 offen offset:2048 lds
    buffer_load_dwordx4 v23, s[24:27], s75 offen offset:3072 lds
    s_add_u32 s75, s75, 128
    s_and_b32 s75, s75, 0xfff
    s_mov_b32 s76, 3
m_lwloop7:
    s_waitcnt vmcnt(16)
    s_barrier
    s_add_u32 m0, s53, 98304
    s_nop 0
    buffer_load_dwordx4 v20, s[24:27], s75 offen offset:0 lds
    buffer_load_dwordx4 v21, s[24:27], s75 offen offset:1024 lds
    buffer_load_dwordx4 v22, s[24:27], s75 offen offset:2048 lds
    buffer_load_dwordx4 v23, s[24:27], s75 offen offset:3072 lds
    s_add_u32 s75, s75, 128
    s_and_b32 s75, s75, 0xfff
    s_waitcnt vmcnt(16)
    s_barrier
    s_add_u32 m0, s53, 122880
    s_nop 0
    buffer_load_dwordx4 v20, s[24:27], s75 offen offset:0 lds
    buffer_load_dwordx4 v21, s[24:27], s75 offen offset:1024 lds
    buffer_load_dwordx4 v22, s[24:27], s75 offen offset:2048 lds
    buffer_load_dwordx4 v23, s[24:27], s75 offen offset:3072 lds
    s_add_u32 s75, s75, 128
    s_and_b32 s75, s75, 0xfff
    s_waitcnt vmcnt(16)
    s_barrier
    s_add_u32 m0, s53, 0
    s_nop 0
    buffer_load_dwordx4 v20, s[24:27], s75 offen offset:0 lds
    buffer_load_dwordx4 v21, s[24:27], s75 offen offset:1024 lds
    buffer_load_dwordx4 v22, s[24:27], s75 offen offset:2048 lds
    buffer_load_dwordx4 v23, s[24:27], s75 offen offset:3072 lds
    s_add_u32 s75, s75, 128
    s_and_b32 s75, s75, 0xfff
    s_waitcnt vmcnt(16)
    s_barrier
    s_add_u32 m0, s53, 24576
    s_nop 0
    buffer_load_dwordx4 v20, s[24:27], s75 offen offset:0 lds
    buffer_load_dwordx4 v21, s[24:27], s75 offen offset:1024 lds
    buffer_load_dwordx4 v22, s[24:27], s75 offen offset:2048 lds
    buffer_load_dwordx4 v23, s[24:27], s75 offen offset:3072 lds
    s_add_u32 s75, s75, 128
    s_and_b32 s75, s75, 0xfff
    s_waitcnt vmcnt(16)
    s_barrier
    s_add_u32 m0, s53, 49152
    s_nop 0
    buffer_load_dwordx4 v20, s[24:27], s75 offen offset:0 lds
    buffer_load_dwordx4 v21, s[24:27], s75 offen offset:1024 lds
    buffer_load_dwordx4 v22, s[24:27], s75 offen offset:2048 lds
    buffer_load_dwordx4 v23, s[24:27], s75 offen offset:3072 lds
    s_add_u32 s75, s75, 128
    s_and_b32 s75, s75, 0xfff
    s_waitcnt vmcnt(16)
    s_barrier
    s_add_u32 m0, s53, 73728
    s_nop 0
    buffer_load_dwordx4 v20, s[24:27], s75 offen offset:0 lds
    buffer_load_dwordx4 v21, s[24:27], s75 offen offset:1024 lds
    buffer_load_dwordx4 v22, s[24:27], s75 offen offset:2048 lds
    buffer_load_dwordx4 v23, s[24:27], s75 offen offset:3072 lds
    s_add_u32 s75, s75, 128
    s_and_b32 s75, s75, 0xfff
    s_sub_u32 s76, s76, 1
    s_cmp_lg_u32 s76, 0
    s_cbranch_scc1 m_lwloop7
    s_waitcnt vmcnt(16)
    s_barrier
    s_add_u32 m0, s53, 98304
    s_nop 0
    buffer_load_dwordx4 v20, s[24:27], s75 offen offset:0 lds
    buffer_load_dwordx4 v21, s[24:27], s75 offen offset:1024 lds
    buffer_load_dwordx4 v22, s[24:27], s75 offen offset:2048 lds
    buffer_load_dwordx4 v23, s[24:27], s75 offen offset:3072 lds
    s_add_u32 s75, s75, 128
    s_and_b32 s75, s75, 0xfff
    s_waitcnt vmcnt(16)
    s_barrier
    s_add_u32 m0, s53, 122880
    s_nop 0
    buffer_load_dwordx4 v20, s[24:27], s75 offen offset:0 lds
    buffer_load_dwordx4 v21, s[24:27], s75 offen offset:1024 lds
    buffer_load_dwordx4 v22, s[24:27], s75 offen offset:2048 lds
    buffer_load_dwordx4 v23, s[24:27], s75 offen offset:3072 lds
    s_add_u32 s75, s75, 128
    s_and_b32 s75, s75, 0xfff
    s_waitcnt vmcnt(16)
    s_barrier
    s_waitcnt vmcnt(12)
    s_barrier
    s_waitcnt vmcnt(8)
    s_barrier
    s_waitcnt vmcnt(4)
    s_barrier
    s_waitcnt vmcnt(0)
    s_barrier
    s_branch f_phase3b
    s_branch f_phase3
m_cons11:
    s_lshr_b32 s49, s96, 2
    v_and_b32 v6, 15, v1
    v_lshrrev_b32 v7, 4, v1
    v_lshrrev_b32 v2, 1, v6
    v_xor_b32 v2, v2, v7
    s_lshl_b32 s46, s49, 2
    v_xor_b32 v2, s46, v2
    v_lshlrev_b32 v2, 4, v2
    v_lshl_add_u32 v2, v6, 7, v2
    s_and_b32 s46, s96, 1
    s_lshl_b32 s46, s46, 12
    s_add_u32 s46, s46, 32768
    v_add_u32 v8, s46, v2
    v_lshrrev_b32 v2, 2, v6
    v_lshl_add_u32 v3, v7, 3, v2
    s_lshl_b32 s46, s49, 5
    v_add_u32 v3, s46, v3
    v_lshlrev_b32 v3, 8, v3
    v_and_b32 v4, 3, v1
    v_lshl_add_u32 v3, v4, 3, v3
    v_and_b32 v4, 1, v7
    v_lshl_add_u32 v2, v4, 2, v2
    s_lshr_b32 s47, s96, 1
    s_and_b32 s47, s47, 1
    s_lshl_b32 s46, s47, 2
    v_xor_b32 v2, s46, v2
    v_lshl_add_u32 v3, v2, 5, v3
    v_add_u32 v11, 40960, v3
    v_xor_b32 v12, 32, v11
    v_xor_b32 v13, 64, v11
    v_xor_b32 v14, 96, v11
    v_add_u32 v9, 49152, v8
    v_add_u32 v15, 49152, v11
    v_add_u32 v16, 49152, v12
    v_add_u32 v17, 49152, v13
    v_add_u32 v18, 49152, v14
    v_add_u32 v10, 98304, v8
    v_add_u32 v19, 98304, v11
    v_add_u32 v20, 98304, v12
    v_add_u32 v21, 98304, v13
    v_add_u32 v22, 98304, v14
    s_barrier
    ds_read_b128 v[96:99], v8 offset:0
    ds_read_b64_tr_b16 v[104:105], v11 offset:0
    ds_read_b64_tr_b16 v[106:107], v11 offset:1024
    ds_read_b128 v[100:103], v8 offset:2048
    ds_read_b64_tr_b16 v[108:109], v12 offset:0
    ds_read_b64_tr_b16 v[110:111], v12 offset:1024
    ds_read_b64_tr_b16 v[112:113], v13 offset:0
    ds_read_b64_tr_b16 v[114:115], v13 offset:1024
    ds_read_b64_tr_b16 v[116:117], v14 offset:0
    ds_read_b64_tr_b16 v[118:119], v14 offset:1024
    s_waitcnt lgkmcnt(0)
    s_barrier
    v_mfma_f32_16x16x32_bf16 v[32:35], v[96:99], v[104:107], 0
    ds_read_b128 v[120:123], v8 offset:24576
    ds_read_b64_tr_b16 v[128:129], v11 offset:24576
    s_lshr_b32 s47, s96, 1
    s_and_b32 s47, s47, 1
    v_lshlrev_b32 v2, 4, v1
    s_lshl_b32 s46, s96, 12
    v_mfma_f32_16x16x32_bf16 v[48:51], v[100:103], v[104:107], 0
    ds_read_b64_tr_b16 v[130:131], v11 offset:25600
    ds_read_b128 v[124:127], v8 offset:26624
    v_add_u32 v23, s46, v2
    v_xor_b32 v24, 16384, v23
    s_and_b32 s46, s96, 1
    s_lshl_b32 s46, s46, 5
    v_mfma_f32_16x16x32_bf16 v[36:39], v[96:99], v[108:111], 0
    ds_read_b64_tr_b16 v[132:133], v12 offset:24576
    ds_read_b64_tr_b16 v[134:135], v12 offset:25600
    s_lshl_b32 s48, s49, 4
    s_add_u32 s46, s46, s48
    s_lshl_b32 s47, s47, 6
    v_and_b32 v3, 1, v7
    v_mfma_f32_16x16x32_bf16 v[52:55], v[100:103], v[108:111], 0
    ds_read_b64_tr_b16 v[136:137], v13 offset:24576
    ds_read_b64_tr_b16 v[138:139], v13 offset:25600
    v_lshl_add_u32 v2, v3, 4, v6
    v_add_u32 v2, s47, v2
    v_lshlrev_b32 v2, 12, v2
    v_lshrrev_b32 v4, 1, v7
    v_mfma_f32_16x16x32_bf16 v[40:43], v[96:99], v[112:115], 0
    ds_read_b64_tr_b16 v[140:141], v14 offset:24576
    ds_read_b64_tr_b16 v[142:143], v14 offset:25600
    v_lshl_add_u32 v2, v4, 4, v2
    s_lshl_b32 s48, s46, 1
    v_add_u32 v25, s48, v2
    v_add_u32 v2, s46, v6
    v_mfma_f32_16x16x32_bf16 v[56:59], v[100:103], v[112:115], 0
    v_mul_u32_u24 v2, 1536, v2
    v_lshl_add_u32 v2, v3, 5, v2
    v_lshl_add_u32 v2, v4, 4, v2
    s_lshl_b32 s48, s47, 1
    v_mfma_f32_16x16x32_bf16 v[44:47], v[96:99], v[116:119], 0
    v_add_u32 v26, s48, v2
    v_lshl_add_u32 v2, v7, 2, v6
    v_add_u32 v2, s46, v2
    v_lshlrev_b32 v2, 4, v2
    v_mfma_f32_16x16x32_bf16 v[60:63], v[100:103], v[116:119], 0
    s_lshr_b32 s47, s47, 6
    s_lshl_b32 s48, s45, 1
    s_add_u32 s47, s47, s48
    s_lshl_b32 s47, s47, 10
    s_waitcnt lgkmcnt(0)
    s_barrier
    v_mfma_f32_16x16x32_bf16 v[32:35], v[120:123], v[128:131], v[32:35]
    ds_read_b128 v[96:99], v9 offset:0
    ds_read_b64_tr_b16 v[104:105], v15 offset:0
    v_add_u32 v27, s47, v2
    v_lshlrev_b32 v2, 10, v6
    v_lshl_add_u32 v2, v7, 6, v2
    s_lshl_b32 s48, s46, 4
    v_mfma_f32_16x16x32_bf16 v[48:51], v[124:127], v[128:131], v[48:51]
    ds_read_b64_tr_b16 v[106:107], v15 offset:1024
    ds_read_b128 v[100:103], v9 offset:2048
    v_add_u32 v28, s48, v2
    v_cmp_eq_u32 s[60:61], 1, v6
    v_cmp_eq_u32 s[62:63], 2, v6
    v_cmp_eq_u32 s[64:65], 3, v6
    v_mfma_f32_16x16x32_bf16 v[36:39], v[120:123], v[132:135], v[36:39]
    ds_read_b64_tr_b16 v[108:109], v16 offset:0
    ds_read_b64_tr_b16 v[110:111], v16 offset:1024
    v_cmp_gt_u32 s[66:67], 4, v6
    v_cmp_gt_u32 s[68:69], 12, v6
    v_mov_b32 v30, 0xc0135761
    v_mov_b32 v31, 0xc0135761
    v_mfma_f32_16x16x32_bf16 v[52:55], v[124:127], v[132:135], v[52:55]
    ds_read_b64_tr_b16 v[112:113], v17 offset:0
    ds_read_b64_tr_b16 v[114:115], v17 offset:1024
    v_mov_b32 v2, 0x42800000
    v_cndmask_b32 v29, 0, v2, s[68:69]
    s_mov_b32 s58, 0xbdd2d3e8
    s_mov_b32 s59, 0xbdd2d3e8
    v_mfma_f32_16x16x32_bf16 v[40:43], v[120:123], v[136:139], v[40:43]
    ds_read_b64_tr_b16 v[116:117], v18 offset:0
    ds_read_b64_tr_b16 v[118:119], v18 offset:1024
    s_mul_i32 s46, s44, 98304
    s_lshl_b32 s47, s45, 8
    s_add_u32 s46, s46, s47
    s_add_u32 s46, s46, 0
    v_mfma_f32_16x16x32_bf16 v[56:59], v[124:127], v[136:139], v[56:59]
    s_add_u32 s24, s94, s46
    s_addc_u32 s25, s95, 0
    s_mov_b32 s26, 0x17b00
    s_mov_b32 s27, 0x00020000
    v_mfma_f32_16x16x32_bf16 v[44:47], v[120:123], v[140:143], v[44:47]
    s_lshl_b32 s46, s45, 19
    s_lshl_b32 s47, s44, 7
    s_add_u32 s46, s46, s47
    s_add_u32 s46, s46, 3145728
    v_mfma_f32_16x16x32_bf16 v[60:63], v[124:127], v[140:143], v[60:63]
    s_add_u32 s28, s94, s46
    s_addc_u32 s29, s95, 0
    s_mov_b32 s30, 0x7f080
    s_mov_b32 s31, 0x00020000
    s_cmp_lg_u32 s96, 0
    s_cbranch_scc1 m_nn8
    s_mov_b32 s40, s92
    s_mov_b32 s41, s93
    s_mov_b32 s42, 0x100
    s_mov_b32 s43, 0x00020000
    s_memrealtime s[76:77]
    v_mov_b32 v161, 0
    v_mov_b32 v162, 0
    s_waitcnt lgkmcnt(0)
    s_or_b32 s76, s76, 1
    v_mov_b32 v160, s76
    v_mov_b32 v163, s76
    s_mov_b64 exec, 1
    buffer_atomic_cmpswap v[160:161], v162, s[40:43], 0 offen sc0 sc1
    s_mov_b64 exec, -1
m_nn8:
    s_waitcnt lgkmcnt(0)
    s_barrier
    v_mfma_f32_16x16x32_bf16 v[32:35], v[96:99], v[104:107], v[32:35]
    ds_read_b128 v[120:123], v9 offset:24576
    ds_read_b64_tr_b16 v[128:129], v15 offset:24576
    s_lshl_b32 s46, s44, 14
    s_add_u32 s46, s46, 15728640
    s_add_u32 s32, s94, s46
    s_addc_u32 s33, s95, 0
    v_mfma_f32_16x16x32_bf16 v[48:51], v[100:103], v[104:107], v[48:51]
    ds_read_b64_tr_b16 v[130:131], v15 offset:25600
    ds_read_b128 v[124:127], v9 offset:26624
    s_mov_b32 s34, 0x3000
    s_mov_b32 s35, 0x00020000
    s_add_u32 s88, s94, 0x1400000
    s_addc_u32 s89, s95, 0
    v_mfma_f32_16x16x32_bf16 v[36:39], v[96:99], v[108:111], v[36:39]
    ds_read_b64_tr_b16 v[132:133], v16 offset:24576
    ds_read_b64_tr_b16 v[134:135], v16 offset:25600
    s_mov_b32 s90, 0x40000
    s_mov_b32 s91, 0x00020000
    v_mfma_f32_16x16x32_bf16 v[52:55], v[100:103], v[108:111], v[52:55]
    ds_read_b64_tr_b16 v[136:137], v17 offset:24576
    ds_read_b64_tr_b16 v[138:139], v17 offset:25600
    v_mfma_f32_16x16x32_bf16 v[40:43], v[96:99], v[112:115], v[40:43]
    ds_read_b64_tr_b16 v[140:141], v18 offset:24576
    ds_read_b64_tr_b16 v[142:143], v18 offset:25600
    v_mfma_f32_16x16x32_bf16 v[56:59], v[100:103], v[112:115], v[56:59]
    v_mfma_f32_16x16x32_bf16 v[44:47], v[96:99], v[116:119], v[44:47]
    v_mfma_f32_16x16x32_bf16 v[60:63], v[100:103], v[116:119], v[60:63]
    s_waitcnt lgkmcnt(0)
    s_barrier
    v_mfma_f32_16x16x32_bf16 v[32:35], v[120:123], v[128:131], v[32:35]
    ds_read_b128 v[96:99], v10 offset:0
    ds_read_b64_tr_b16 v[104:105], v19 offset:0
    v_mfma_f32_16x16x32_bf16 v[48:51], v[124:127], v[128:131], v[48:51]
    ds_read_b64_tr_b16 v[106:107], v19 offset:1024
    ds_read_b128 v[100:103], v10 offset:2048
    v_mfma_f32_16x16x32_bf16 v[36:39], v[120:123], v[132:135], v[36:39]
    ds_read_b64_tr_b16 v[108:109], v20 offset:0
    ds_read_b64_tr_b16 v[110:111], v20 offset:1024
    v_mfma_f32_16x16x32_bf16 v[52:55], v[124:127], v[132:135], v[52:55]
    ds_read_b64_tr_b16 v[112:113], v21 offset:0
    ds_read_b64_tr_b16 v[114:115], v21 offset:1024
    v_mfma_f32_16x16x32_bf16 v[40:43], v[120:123], v[136:139], v[40:43]
    ds_read_b64_tr_b16 v[116:117], v22 offset:0
    ds_read_b64_tr_b16 v[118:119], v22 offset:1024
    v_mfma_f32_16x16x32_bf16 v[56:59], v[124:127], v[136:139], v[56:59]
    v_mfma_f32_16x16x32_bf16 v[44:47], v[120:123], v[140:143], v[44:47]
    v_mfma_f32_16x16x32_bf16 v[60:63], v[124:127], v[140:143], v[60:63]
    s_waitcnt lgkmcnt(0)
    s_barrier
    v_mfma_f32_16x16x32_bf16 v[32:35], v[96:99], v[104:107], v[32:35]
    ds_read_b128 v[120:123], v8 offset:0
    ds_read_b64_tr_b16 v[128:129], v11 offset:0
    v_mfma_f32_16x16x32_bf16 v[48:51], v[100:103], v[104:107], v[48:51]
    ds_read_b64_tr_b16 v[130:131], v11 offset:1024
    ds_read_b128 v[124:127], v8 offset:2048
    v_mfma_f32_16x16x32_bf16 v[36:39], v[96:99], v[108:111], v[36:39]
    ds_read_b64_tr_b16 v[132:133], v12 offset:0
    ds_read_b64_tr_b16 v[134:135], v12 offset:1024
    v_mfma_f32_16x16x32_bf16 v[52:55], v[100:103], v[108:111], v[52:55]
    ds_read_b64_tr_b16 v[136:137], v13 offset:0
    ds_read_b64_tr_b16 v[138:139], v13 offset:1024
    v_mfma_f32_16x16x32_bf16 v[40:43], v[96:99], v[112:115], v[40:43]
    ds_read_b64_tr_b16 v[140:141], v14 offset:0
    ds_read_b64_tr_b16 v[142:143], v14 offset:1024
    v_mfma_f32_16x16x32_bf16 v[56:59], v[100:103], v[112:115], v[56:59]
    v_mfma_f32_16x16x32_bf16 v[44:47], v[96:99], v[116:119], v[44:47]
    v_mfma_f32_16x16x32_bf16 v[60:63], v[100:103], v[116:119], v[60:63]
    s_waitcnt lgkmcnt(0)
    s_barrier
    v_mfma_f32_16x16x32_bf16 v[32:35], v[120:123], v[128:131], v[32:35]
    ds_read_b128 v[96:99], v8 offset:24576
    ds_read_b64_tr_b16 v[104:105], v11 offset:24576
    v_mfma_f32_16x16x32_bf16 v[48:51], v[124:127], v[128:131], v[48:51]
    ds_read_b64_tr_b16 v[106:107], v11 offset:25600
    ds_read_b128 v[100:103], v8 offset:26624
    v_mfma_f32_16x16x32_bf16 v[36:39], v[120:123], v[132:135], v[36:39]
    ds_read_b64_tr_b16 v[108:109], v12 offset:24576
    ds_read_b64_tr_b16 v[110:111], v12 offset:25600
    v_mfma_f32_16x16x32_bf16 v[52:55], v[124:127], v[132:135], v[52:55]
    ds_read_b64_tr_b16 v[112:113], v13 offset:24576
    ds_read_b64_tr_b16 v[114:115], v13 offset:25600
    v_mfma_f32_16x16x32_bf16 v[40:43], v[120:123], v[136:139], v[40:43]
    ds_read_b64_tr_b16 v[116:117], v14 offset:24576
    ds_read_b64_tr_b16 v[118:119], v14 offset:25600
    v_mfma_f32_16x16x32_bf16 v[56:59], v[124:127], v[136:139], v[56:59]
    v_mfma_f32_16x16x32_bf16 v[44:47], v[120:123], v[140:143], v[44:47]
    v_mfma_f32_16x16x32_bf16 v[60:63], v[124:127], v[140:143], v[60:63]
    s_waitcnt lgkmcnt(0)
    s_barrier
    v_mfma_f32_16x16x32_bf16 v[32:35], v[96:99], v[104:107], v[32:35]
    ds_read_b128 v[120:123], v9 offset:0
    ds_read_b64_tr_b16 v[128:129], v15 offset:0
    v_mfma_f32_16x16x32_bf16 v[48:51], v[100:103], v[104:107], v[48:51]
    ds_read_b64_tr_b16 v[130:131], v15 offset:1024
    ds_read_b128 v[124:127], v9 offset:2048
    v_mfma_f32_16x16x32_bf16 v[36:39], v[96:99], v[108:111], v[36:39]
    ds_read_b64_tr_b16 v[132:133], v16 offset:0
    ds_read_b64_tr_b16 v[134:135], v16 offset:1024
    v_mfma_f32_16x16x32_bf16 v[52:55], v[100:103], v[108:111], v[52:55]
    ds_read_b64_tr_b16 v[136:137], v17 offset:0
    ds_read_b64_tr_b16 v[138:139], v17 offset:1024
    v_mfma_f32_16x16x32_bf16 v[40:43], v[96:99], v[112:115], v[40:43]
    ds_read_b64_tr_b16 v[140:141], v18 offset:0
    ds_read_b64_tr_b16 v[142:143], v18 offset:1024
    v_mfma_f32_16x16x32_bf16 v[56:59], v[100:103], v[112:115], v[56:59]
    v_mfma_f32_16x16x32_bf16 v[44:47], v[96:99], v[116:119], v[44:47]
    v_mfma_f32_16x16x32_bf16 v[60:63], v[100:103], v[116:119], v[60:63]
    s_waitcnt lgkmcnt(0)
    s_barrier
    v_mfma_f32_16x16x32_bf16 v[32:35], v[120:123], v[128:131], v[32:35]
    ds_read_b128 v[96:99], v9 offset:24576
    ds_read_b64_tr_b16 v[104:105], v15 offset:24576
    v_mfma_f32_16x16x32_bf16 v[48:51], v[124:127], v[128:131], v[48:51]
    ds_read_b64_tr_b16 v[106:107], v15 offset:25600
    ds_read_b128 v[100:103], v9 offset:26624
    v_mfma_f32_16x16x32_bf16 v[36:39], v[120:123], v[132:135], v[36:39]
    ds_read_b64_tr_b16 v[108:109], v16 offset:24576
    ds_read_b64_tr_b16 v[110:111], v16 offset:25600
    v_mfma_f32_16x16x32_bf16 v[52:55], v[124:127], v[132:135], v[52:55]
    ds_read_b64_tr_b16 v[112:113], v17 offset:24576
    ds_read_b64_tr_b16 v[114:115], v17 offset:25600
    v_mfma_f32_16x16x32_bf16 v[40:43], v[120:123], v[136:139], v[40:43]
    ds_read_b64_tr_b16 v[116:117], v18 offset:24576
    ds_read_b64_tr_b16 v[118:119], v18 offset:25600
    v_mfma_f32_16x16x32_bf16 v[56:59], v[124:127], v[136:139], v[56:59]
    v_mfma_f32_16x16x32_bf16 v[44:47], v[120:123], v[140:143], v[44:47]
    v_mfma_f32_16x16x32_bf16 v[60:63], v[124:127], v[140:143], v[60:63]
    s_waitcnt lgkmcnt(0)
    s_barrier
    v_mfma_f32_16x16x32_bf16 v[32:35], v[96:99], v[104:107], v[32:35]
    ds_read_b128 v[120:123], v10 offset:0
    ds_read_b64_tr_b16 v[128:129], v19 offset:0
    v_mfma_f32_16x16x32_bf16 v[48:51], v[100:103], v[104:107], v[48:51]
    ds_read_b64_tr_b16 v[130:131], v19 offset:1024
    ds_read_b128 v[124:127], v10 offset:2048
    v_mfma_f32_16x16x32_bf16 v[36:39], v[96:99], v[108:111], v[36:39]
    ds_read_b64_tr_b16 v[132:133], v20 offset:0
    ds_read_b64_tr_b16 v[134:135], v20 offset:1024
    v_mfma_f32_16x16x32_bf16 v[52:55], v[100:103], v[108:111], v[52:55]
    ds_read_b64_tr_b16 v[136:137], v21 offset:0
    ds_read_b64_tr_b16 v[138:139], v21 offset:1024
    v_mfma_f32_16x16x32_bf16 v[40:43], v[96:99], v[112:115], v[40:43]
    ds_read_b64_tr_b16 v[140:141], v22 offset:0
    ds_read_b64_tr_b16 v[142:143], v22 offset:1024
    v_mfma_f32_16x16x32_bf16 v[56:59], v[100:103], v[112:115], v[56:59]
    v_mfma_f32_16x16x32_bf16 v[44:47], v[96:99], v[116:119], v[44:47]
    v_mfma_f32_16x16x32_bf16 v[60:63], v[100:103], v[116:119], v[60:63]
    v_lshrrev_b32 v2, 1, v6
    v_xor_b32 v2, v2, v7
    s_lshl_b32 s46, s49, 2
    v_xor_b32 v2, s46, v2
    v_lshlrev_b32 v2, 4, v2
    v_lshl_add_u32 v2, v6, 7, v2
    s_and_b32 s46, s96, 2
    s_lshl_b32 s46, s46, 12
    s_add_u32 s46, s46, 32768
    v_add_u32 v8, s46, v2
    v_lshrrev_b32 v2, 2, v6
    v_lshl_add_u32 v3, v7, 3, v2
    s_lshl_b32 s46, s49, 5
    v_add_u32 v3, s46, v3
    v_lshlrev_b32 v3, 7, v3
    v_and_b32 v4, 3, v1
    v_lshl_add_u32 v3, v4, 3, v3
    v_lshrrev_b32 v2, 1, v2
    v_and_b32 v4, 1, v7
    v_lshl_add_u32 v2, v4, 1, v2
    s_and_b32 s46, s96, 1
    s_lshl_b32 s46, s46, 1
    v_xor_b32 v2, s46, v2
    v_lshl_add_u32 v3, v2, 5, v3
    v_add_u32 v11, 49152, v3
    v_xor_b32 v12, 32, v11
    v_add_u32 v9, 49152, v8
    v_add_u32 v15, 49152, v11
    v_add_u32 v16, 49152, v12
    v_add_u32 v10, 98304, v8
    v_add_u32 v19, 98304, v11
    v_add_u32 v20, 98304, v12
    s_waitcnt lgkmcnt(0)
    s_barrier
    v_mfma_f32_16x16x32_bf16 v[32:35], v[120:123], v[128:131], v[32:35]
    ds_read_b64_tr_b16 v[96:97], v11 offset:0
    ds_read_b64_tr_b16 v[98:99], v11 offset:512
    v_mfma_f32_16x16x32_bf16 v[48:51], v[124:127], v[128:131], v[48:51]
    ds_read_b128 v[104:107], v8 offset:0
    ds_read_b64_tr_b16 v[100:101], v12 offset:0
    v_mfma_f32_16x16x32_bf16 v[36:39], v[120:123], v[132:135], v[36:39]
    ds_read_b64_tr_b16 v[102:103], v12 offset:512
    ds_read_b128 v[108:111], v8 offset:2048
    v_mfma_f32_16x16x32_bf16 v[52:55], v[124:127], v[132:135], v[52:55]
    ds_read_b128 v[112:115], v8 offset:4096
    ds_read_b128 v[116:119], v8 offset:6144
    v_mfma_f32_16x16x32_bf16 v[40:43], v[120:123], v[136:139], v[40:43]
    v_mfma_f32_16x16x32_bf16 v[56:59], v[124:127], v[136:139], v[56:59]
    v_mfma_f32_16x16x32_bf16 v[44:47], v[120:123], v[140:143], v[44:47]
    v_mfma_f32_16x16x32_bf16 v[60:63], v[124:127], v[140:143], v[60:63]
    s_cmp_lg_u32 s96, 0
    s_cbranch_scc1 m_nn9
    s_waitcnt vmcnt(0)
    v_cmp_eq_u32 vcc, 0, v160
    v_mov_b32 v162, 163836
    s_nop 0
    v_cndmask_b32 v160, v160, v163, vcc
    s_mov_b64 exec, 1
    ds_write_b32 v162, v160
    s_mov_b64 exec, -1
m_nn9:
    s_nop 7
    s_cmp_lg_u32 s49, 0
    s_cbranch_scc1 m_xhi10
    ds_write_b128 v23, v[48:51] offset:0
    ds_write_b128 v23, v[52:55] offset:1024
    ds_write_b128 v23, v[56:59] offset:2048
    ds_write_b128 v23, v[60:63] offset:3072
    s_branch m_xj11
m_xhi10:
    ds_write_b128 v23, v[32:35] offset:0
    ds_write_b128 v23, v[36:39] offset:1024
    ds_write_b128 v23, v[40:43] offset:2048
    ds_write_b128 v23, v[44:47] offset:3072
    s_nop 1
    v_pk_add_f32 v[32:33], v[48:49], 0 op_sel_hi:[1,0]
    v_pk_add_f32 v[34:35], v[50:51], 0 op_sel_hi:[1,0]
    v_pk_add_f32 v[36:37], v[52:53], 0 op_sel_hi:[1,0]
    v_pk_add_f32 v[38:39], v[54:55], 0 op_sel_hi:[1,0]
    v_pk_add_f32 v[40:41], v[56:57], 0 op_sel_hi:[1,0]
    v_pk_add_f32 v[42:43], v[58:59], 0 op_sel_hi:[1,0]
    v_pk_add_f32 v[44:45], v[60:61], 0 op_sel_hi:[1,0]
    v_pk_add_f32 v[46:47], v[62:63], 0 op_sel_hi:[1,0]
m_xj11:
    v_mov_b32 v4, 163836
    s_waitcnt lgkmcnt(0)
    s_barrier
    v_mfma_f32_16x16x32_bf16 v[64:67], v[96:99], v[104:107], 0
    ds_read_b128 v[48:51], v24 offset:0
    ds_read_b128 v[52:55], v24 offset:1024
    v_mfma_f32_16x16x32_bf16 v[68:71], v[100:103], v[104:107], 0
    ds_read_b128 v[56:59], v24 offset:2048
    ds_read_b128 v[60:63], v24 offset:3072
    v_mfma_f32_16x16x32_bf16 v[72:75], v[96:99], v[108:111], 0
    ds_read_b32 v5, v4
    ds_read_b64_tr_b16 v[120:121], v11 offset:24576
    v_mfma_f32_16x16x32_bf16 v[76:79], v[100:103], v[108:111], 0
    ds_read_b64_tr_b16 v[122:123], v11 offset:25088
    ds_read_b128 v[128:131], v8 offset:24576
    v_mfma_f32_16x16x32_bf16 v[80:83], v[96:99], v[112:115], 0
    ds_read_b64_tr_b16 v[124:125], v12 offset:24576
    ds_read_b64_tr_b16 v[126:127], v12 offset:25088
    v_mfma_f32_16x16x32_bf16 v[84:87], v[100:103], v[112:115], 0
    ds_read_b128 v[132:135], v8 offset:26624
    ds_read_b128 v[136:139], v8 offset:28672
    v_mfma_f32_16x16x32_bf16 v[88:91], v[96:99], v[116:119], 0
    ds_read_b128 v[140:143], v8 offset:30720
    v_mfma_f32_16x16x32_bf16 v[92:95], v[100:103], v[116:119], 0
    s_waitcnt lgkmcnt(0)
    s_barrier
    v_mfma_f32_16x16x32_bf16 v[64:67], v[120:123], v[128:131], v[64:67]
    ds_read_b64_tr_b16 v[96:97], v15 offset:0
    ds_read_b64_tr_b16 v[98:99], v15 offset:512
    v_pk_add_f32 v[32:33], v[32:33], v[48:49]
    v_pk_add_f32 v[34:35], v[34:35], v[50:51]
    v_pk_add_f32 v[36:37], v[36:37], v[52:53]
    v_pk_add_f32 v[38:39], v[38:39], v[54:55]
    v_pk_add_f32 v[40:41], v[40:41], v[56:57]
    v_pk_add_f32 v[42:43], v[42:43], v[58:59]
    v_pk_add_f32 v[44:45], v[44:45], v[60:61]
    v_pk_add_f32 v[46:47], v[46:47], v[62:63]
    v_cvt_pk_bf16_f32 v48, v32, v33
    v_cvt_pk_bf16_f32 v49, v34, v35
    v_lshlrev_b32 v32, 16, v48
    v_and_b32 v33, 0xffff0000, v48
    v_lshlrev_b32 v34, 16, v49
    v_and_b32 v35, 0xffff0000, v49
    v_cvt_pk_bf16_f32 v50, v36, v37
    v_cvt_pk_bf16_f32 v51, v38, v39
    v_lshlrev_b32 v36, 16, v50
    v_and_b32 v37, 0xffff0000, v50
    v_lshlrev_b32 v38, 16, v51
    v_and_b32 v39, 0xffff0000, v51
    v_cvt_pk_bf16_f32 v52, v40, v41
    v_cvt_pk_bf16_f32 v53, v42, v43
    v_lshlrev_b32 v40, 16, v52
    v_and_b32 v41, 0xffff0000, v52
    v_lshlrev_b32 v42, 16, v53
    v_and_b32 v43, 0xffff0000, v53
    v_cvt_pk_bf16_f32 v54, v44, v45
    v_cvt_pk_bf16_f32 v55, v46, v47
    v_lshlrev_b32 v44, 16, v54
    v_and_b32 v45, 0xffff0000, v54
    v_lshlrev_b32 v46, 16, v55
    v_and_b32 v47, 0xffff0000, v55
    v_pk_mul_f32 v[48:49], v[32:33], v[32:33]
    v_pk_mul_f32 v[50:51], v[34:35], v[34:35]
    v_pk_mul_f32 v[52:53], v[36:37], v[36:37]
    v_pk_mul_f32 v[54:55], v[38:39], v[38:39]
    v_pk_mul_f32 v[56:57], v[40:41], v[40:41]
    v_pk_mul_f32 v[58:59], v[42:43], v[42:43]
    v_pk_mul_f32 v[60:61], v[44:45], v[44:45]
    v_pk_mul_f32 v[62:63], v[46:47], v[46:47]
    v_mfma_f32_16x16x32_bf16 v[68:71], v[124:127], v[128:131], v[68:71]
    ds_read_b128 v[104:107], v9 offset:0
    ds_read_b64_tr_b16 v[100:101], v16 offset:0
    v_pk_fma_f32 v[48:49], v[48:49], s[58:59], v[30:31]
    v_pk_fma_f32 v[50:51], v[50:51], s[58:59], v[30:31]
    v_pk_fma_f32 v[52:53], v[52:53], s[58:59], v[30:31]
    v_pk_fma_f32 v[54:55], v[54:55], s[58:59], v[30:31]
    v_pk_fma_f32 v[56:57], v[56:57], s[58:59], v[30:31]
    v_pk_fma_f32 v[58:59], v[58:59], s[58:59], v[30:31]
    v_pk_fma_f32 v[60:61], v[60:61], s[58:59], v[30:31]
    v_pk_fma_f32 v[62:63], v[62:63], s[58:59], v[30:31]
    v_pk_mul_f32 v[48:49], v[48:49], v[32:33]
    v_pk_mul_f32 v[50:51], v[50:51], v[34:35]
    v_pk_mul_f32 v[52:53], v[52:53], v[36:37]
    v_pk_mul_f32 v[54:55], v[54:55], v[38:39]
    v_pk_mul_f32 v[56:57], v[56:57], v[40:41]
    v_pk_mul_f32 v[58:59], v[58:59], v[42:43]
    v_pk_mul_f32 v[60:61], v[60:61], v[44:45]
    v_pk_mul_f32 v[62:63], v[62:63], v[46:47]
    v_exp_f32 v48, v48
    v_exp_f32 v49, v49
    v_exp_f32 v50, v50
    v_exp_f32 v51, v51
    v_exp_f32 v52, v52
    v_exp_f32 v53, v53
    v_exp_f32 v54, v54
    v_exp_f32 v55, v55
    v_exp_f32 v56, v56
    v_exp_f32 v57, v57
    v_exp_f32 v58, v58
    v_exp_f32 v59, v59
    v_exp_f32 v60, v60
    v_exp_f32 v61, v61
    v_exp_f32 v62, v62
    v_exp_f32 v63, v63
    v_pk_add_f32 v[48:49], v[48:49], 1.0 op_sel_hi:[1,0]
    v_pk_add_f32 v[50:51], v[50:51], 1.0 op_sel_hi:[1,0]
    v_pk_add_f32 v[52:53], v[52:53], 1.0 op_sel_hi:[1,0]
    v_pk_add_f32 v[54:55], v[54:55], 1.0 op_sel_hi:[1,0]
    v_pk_add_f32 v[56:57], v[56:57], 1.0 op_sel_hi:[1,0]
    v_pk_add_f32 v[58:59], v[58:59], 1.0 op_sel_hi:[1,0]
    v_pk_add_f32 v[60:61], v[60:61], 1.0 op_sel_hi:[1,0]
    v_pk_add_f32 v[62:63], v[62:63], 1.0 op_sel_hi:[1,0]
    v_mfma_f32_16x16x32_bf16 v[72:75], v[120:123], v[132:135], v[72:75]
    ds_read_b64_tr_b16 v[102:103], v16 offset:512
    ds_read_b128 v[108:111], v9 offset:2048
    v_rcp_f32 v48, v48
    v_rcp_f32 v49, v49
    v_rcp_f32 v50, v50
    v_rcp_f32 v51, v51
    v_rcp_f32 v52, v52
    v_rcp_f32 v53, v53
    v_rcp_f32 v54, v54
    v_rcp_f32 v55, v55
    v_rcp_f32 v56, v56
    v_rcp_f32 v57, v57
    v_rcp_f32 v58, v58
    v_rcp_f32 v59, v59
    v_rcp_f32 v60, v60
    v_rcp_f32 v61, v61
    v_rcp_f32 v62, v62
    v_rcp_f32 v63, v63
    v_pk_mul_f32 v[32:33], v[32:33], v[48:49]
    v_pk_mul_f32 v[34:35], v[34:35], v[50:51]
    v_pk_mul_f32 v[36:37], v[36:37], v[52:53]
    v_pk_mul_f32 v[38:39], v[38:39], v[54:55]
    v_pk_mul_f32 v[40:41], v[40:41], v[56:57]
    v_pk_mul_f32 v[42:43], v[42:43], v[58:59]
    v_pk_mul_f32 v[44:45], v[44:45], v[60:61]
    v_pk_mul_f32 v[46:47], v[46:47], v[62:63]
    v_cvt_pk_bf16_f32 v48, v32, v33
    v_cvt_pk_bf16_f32 v49, v34, v35
    v_lshlrev_b32 v32, 16, v48
    v_and_b32 v33, 0xffff0000, v48
    v_lshlrev_b32 v34, 16, v49
    v_and_b32 v35, 0xffff0000, v49
    v_cvt_pk_bf16_f32 v50, v36, v37
    v_cvt_pk_bf16_f32 v51, v38, v39
    v_lshlrev_b32 v36, 16, v50
    v_and_b32 v37, 0xffff0000, v50
    v_lshlrev_b32 v38, 16, v51
    v_and_b32 v39, 0xffff0000, v51
    v_cvt_pk_bf16_f32 v52, v40, v41
    v_cvt_pk_bf16_f32 v53, v42, v43
    v_lshlrev_b32 v40, 16, v52
    v_and_b32 v41, 0xffff0000, v52
    v_mfma_f32_16x16x32_bf16 v[76:79], v[124:127], v[132:135], v[76:79]
    ds_read_b128 v[112:115], v9 offset:4096
    ds_read_b128 v[116:119], v9 offset:6144
    v_lshlrev_b32 v42, 16, v53
    v_and_b32 v43, 0xffff0000, v53
    v_cvt_pk_bf16_f32 v54, v44, v45
    v_cvt_pk_bf16_f32 v55, v46, v47
    v_lshlrev_b32 v44, 16, v54
    v_and_b32 v45, 0xffff0000, v54
    v_lshlrev_b32 v46, 16, v55
    v_and_b32 v47, 0xffff0000, v55
    v_pk_add_f32 v[144:145], v[32:33], v[36:37]
    v_pk_add_f32 v[148:149], v[40:41], v[44:45]
    v_pk_add_f32 v[146:147], v[34:35], v[38:39]
    v_pk_add_f32 v[150:151], v[42:43], v[46:47]
    v_pk_add_f32 v[144:145], v[144:145], v[148:149]
    v_pk_add_f32 v[146:147], v[146:147], v[150:151]
    s_nop 0
    v_add_f32_dpp v144, v144, v144 row_ror:8 row_mask:0xf bank_mask:0xf
    v_add_f32_dpp v145, v145, v145 row_ror:8 row_mask:0xf bank_mask:0xf
    v_add_f32_dpp v146, v146, v146 row_ror:8 row_mask:0xf bank_mask:0xf
    v_add_f32_dpp v147, v147, v147 row_ror:8 row_mask:0xf bank_mask:0xf
    v_add_f32_dpp v144, v144, v144 row_ror:4 row_mask:0xf bank_mask:0xf
    v_add_f32_dpp v145, v145, v145 row_ror:4 row_mask:0xf bank_mask:0xf
    v_add_f32_dpp v146, v146, v146 row_ror:4 row_mask:0xf bank_mask:0xf
    v_add_f32_dpp v147, v147, v147 row_ror:4 row_mask:0xf bank_mask:0xf
    v_add_f32_dpp v144, v144, v144 row_ror:2 row_mask:0xf bank_mask:0xf
    v_add_f32_dpp v145, v145, v145 row_ror:2 row_mask:0xf bank_mask:0xf
    v_add_f32_dpp v146, v146, v146 row_ror:2 row_mask:0xf bank_mask:0xf
    v_add_f32_dpp v147, v147, v147 row_ror:2 row_mask:0xf bank_mask:0xf
    v_add_f32_dpp v144, v144, v144 row_ror:1 row_mask:0xf bank_mask:0xf
    v_add_f32_dpp v145, v145, v145 row_ror:1 row_mask:0xf bank_mask:0xf
    v_add_f32_dpp v146, v146, v146 row_ror:1 row_mask:0xf bank_mask:0xf
    v_add_f32_dpp v147, v147, v147 row_ror:1 row_mask:0xf bank_mask:0xf
    v_mul_f32 v144, 0x3c800000, v144
    v_mul_f32 v145, 0x3c800000, v145
    v_mul_f32 v146, 0x3c800000, v146
    v_mul_f32 v147, 0x3c800000, v147
    v_pk_add_f32 v[48:49], v[32:33], v[144:145] neg_lo:[0,1] neg_hi:[0,1]
    v_pk_add_f32 v[50:51], v[34:35], v[146:147] neg_lo:[0,1] neg_hi:[0,1]
    v_pk_add_f32 v[52:53], v[36:37], v[144:145] neg_lo:[0,1] neg_hi:[0,1]
    v_pk_add_f32 v[54:55], v[38:39], v[146:147] neg_lo:[0,1] neg_hi:[0,1]
    v_pk_add_f32 v[56:57], v[40:41], v[144:145] neg_lo:[0,1] neg_hi:[0,1]
    v_mfma_f32_16x16x32_bf16 v[80:83], v[120:123], v[136:139], v[80:83]
    v_pk_add_f32 v[58:59], v[42:43], v[146:147] neg_lo:[0,1] neg_hi:[0,1]
    v_pk_add_f32 v[60:61], v[44:45], v[144:145] neg_lo:[0,1] neg_hi:[0,1]
    v_pk_add_f32 v[62:63], v[46:47], v[146:147] neg_lo:[0,1] neg_hi:[0,1]
    v_pk_mul_f32 v[148:149], v[48:49], v[48:49]
    v_pk_mul_f32 v[150:151], v[50:51], v[50:51]
    v_pk_fma_f32 v[148:149], v[52:53], v[52:53], v[148:149]
    v_pk_fma_f32 v[150:151], v[54:55], v[54:55], v[150:151]
    v_pk_fma_f32 v[148:149], v[56:57], v[56:57], v[148:149]
    v_pk_fma_f32 v[150:151], v[58:59], v[58:59], v[150:151]
    v_pk_fma_f32 v[148:149], v[60:61], v[60:61], v[148:149]
    v_pk_fma_f32 v[150:151], v[62:63], v[62:63], v[150:151]
    s_nop 0
    v_add_f32_dpp v148, v148, v148 row_ror:8 row_mask:0xf bank_mask:0xf
    v_add_f32_dpp v149, v149, v149 row_ror:8 row_mask:0xf bank_mask:0xf
    v_add_f32_dpp v150, v150, v150 row_ror:8 row_mask:0xf bank_mask:0xf
    v_add_f32_dpp v151, v151, v151 row_ror:8 row_mask:0xf bank_mask:0xf
    v_add_f32_dpp v148, v148, v148 row_ror:4 row_mask:0xf bank_mask:0xf
    v_add_f32_dpp v149, v149, v149 row_ror:4 row_mask:0xf bank_mask:0xf
    v_add_f32_dpp v150, v150, v150 row_ror:4 row_mask:0xf bank_mask:0xf
    v_add_f32_dpp v151, v151, v151 row_ror:4 row_mask:0xf bank_mask:0xf
    v_add_f32_dpp v148, v148, v148 row_ror:2 row_mask:0xf bank_mask:0xf
    v_add_f32_dpp v149, v149, v149 row_ror:2 row_mask:0xf bank_mask:0xf
    v_add_f32_dpp v150, v150, v150 row_ror:2 row_mask:0xf bank_mask:0xf
    v_add_f32_dpp v151, v151, v151 row_ror:2 row_mask:0xf bank_mask:0xf
    v_add_f32_dpp v148, v148, v148 row_ror:1 row_mask:0xf bank_mask:0xf
    v_add_f32_dpp v149, v149, v149 row_ror:1 row_mask:0xf bank_mask:0xf
    v_add_f32_dpp v150, v150, v150 row_ror:1 row_mask:0xf bank_mask:0xf
    v_add_f32_dpp v151, v151, v151 row_ror:1 row_mask:0xf bank_mask:0xf
    v_cndmask_b32 v152, v144, v145, s[60:61]
    v_cndmask_b32 v153, v148, v149, s[60:61]
    v_cndmask_b32 v152, v152, v146, s[62:63]
    v_cndmask_b32 v153, v153, v150, s[62:63]
    v_cndmask_b32 v152, v152, v147, s[64:65]
    v_cndmask_b32 v153, v153, v151, s[64:65]
    v_mov_b32 v154, v5
    v_mov_b32 v155, v5
    s_mov_b64 exec, s[66:67]
    buffer_store_dwordx4 v[152:155], v27, s[32:35], 0 offen sc1
    s_mov_b64 exec, -1
    v_mfma_f32_16x16x32_bf16 v[84:87], v[124:127], v[136:139], v[84:87]
    v_mfma_f32_16x16x32_bf16 v[88:91], v[120:123], v[140:143], v[88:91]
    v_mfma_f32_16x16x32_bf16 v[92:95], v[124:127], v[140:143], v[92:95]
    s_waitcnt lgkmcnt(0)
    s_barrier
    v_mfma_f32_16x16x32_bf16 v[64:67], v[96:99], v[104:107], v[64:67]
    ds_read_b64_tr_b16 v[120:121], v15 offset:24576
    ds_read_b64_tr_b16 v[122:123], v15 offset:25088
    v_mfma_f32_16x16x32_bf16 v[68:71], v[100:103], v[104:107], v[68:71]
    ds_read_b128 v[128:131], v9 offset:24576
    ds_read_b64_tr_b16 v[124:125], v16 offset:24576
    v_mfma_f32_16x16x32_bf16 v[72:75], v[96:99], v[108:111], v[72:75]
    ds_read_b64_tr_b16 v[126:127], v16 offset:25088
    ds_read_b128 v[132:135], v9 offset:26624
    v_mfma_f32_16x16x32_bf16 v[76:79], v[100:103], v[108:111], v[76:79]
    ds_read_b128 v[136:139], v9 offset:28672
    ds_read_b128 v[140:143], v9 offset:30720
    v_mfma_f32_16x16x32_bf16 v[80:83], v[96:99], v[112:115], v[80:83]
    v_mfma_f32_16x16x32_bf16 v[84:87], v[100:103], v[112:115], v[84:87]
    v_mfma_f32_16x16x32_bf16 v[88:91], v[96:99], v[116:119], v[88:91]
    v_mfma_f32_16x16x32_bf16 v[92:95], v[100:103], v[116:119], v[92:95]
    s_waitcnt lgkmcnt(0)
    s_barrier
    v_mfma_f32_16x16x32_bf16 v[64:67], v[120:123], v[128:131], v[64:67]
    ds_read_b64_tr_b16 v[96:97], v19 offset:0
    ds_read_b64_tr_b16 v[98:99], v19 offset:512
    v_mfma_f32_16x16x32_bf16 v[68:71], v[124:127], v[128:131], v[68:71]
    ds_read_b128 v[104:107], v10 offset:0
    ds_read_b64_tr_b16 v[100:101], v20 offset:0
    v_mfma_f32_16x16x32_bf16 v[72:75], v[120:123], v[132:135], v[72:75]
    ds_read_b64_tr_b16 v[102:103], v20 offset:512
    ds_read_b128 v[108:111], v10 offset:2048
    v_mfma_f32_16x16x32_bf16 v[76:79], v[124:127], v[132:135], v[76:79]
    ds_read_b128 v[112:115], v10 offset:4096
    ds_read_b128 v[116:119], v10 offset:6144
    v_mfma_f32_16x16x32_bf16 v[80:83], v[120:123], v[136:139], v[80:83]
    v_mfma_f32_16x16x32_bf16 v[84:87], v[124:127], v[136:139], v[84:87]
    v_mfma_f32_16x16x32_bf16 v[88:91], v[120:123], v[140:143], v[88:91]
    v_mfma_f32_16x16x32_bf16 v[92:95], v[124:127], v[140:143], v[92:95]
    s_waitcnt lgkmcnt(0)
    s_barrier
    v_mfma_f32_16x16x32_bf16 v[64:67], v[96:99], v[104:107], v[64:67]
    ds_read_b64_tr_b16 v[120:121], v11 offset:0
    ds_read_b64_tr_b16 v[122:123], v11 offset:512
    v_mfma_f32_16x16x32_bf16 v[68:71], v[100:103], v[104:107], v[68:71]
    ds_read_b128 v[128:131], v8 offset:0
    ds_read_b64_tr_b16 v[124:125], v12 offset:0
    v_mfma_f32_16x16x32_bf16 v[72:75], v[96:99], v[108:111], v[72:75]
    ds_read_b64_tr_b16 v[126:127], v12 offset:512
    ds_read_b128 v[132:135], v8 offset:2048
    v_mfma_f32_16x16x32_bf16 v[76:79], v[100:103], v[108:111], v[76:79]
    ds_read_b128 v[136:139], v8 offset:4096
    ds_read_b128 v[140:143], v8 offset:6144
    v_mfma_f32_16x16x32_bf16 v[80:83], v[96:99], v[112:115], v[80:83]
    v_mfma_f32_16x16x32_bf16 v[84:87], v[100:103], v[112:115], v[84:87]
    v_mfma_f32_16x16x32_bf16 v[88:91], v[96:99], v[116:119], v[88:91]
    v_mfma_f32_16x16x32_bf16 v[92:95], v[100:103], v[116:119], v[92:95]
    v_mov_b32 v152, 0
    v_mov_b32 v153, 0
    v_mov_b32 v154, v5
    v_mov_b32 v156, 0
    v_mov_b32 v157, 0
    v_mov_b32 v158, v5
    v_mov_b32 v160, 0
    v_mov_b32 v161, 0
    v_mov_b32 v162, v5
    v_mov_b32 v164, 0
    v_mov_b32 v165, 0
    v_mov_b32 v166, v5
    s_mov_b64 exec, s[68:69]
    buffer_load_dwordx4 v[152:155], v28, s[32:35], 0 offen offset:0 sc1
    buffer_load_dwordx4 v[156:159], v28, s[32:35], 0 offen offset:16 sc1
    buffer_load_dwordx4 v[160:163], v28, s[32:35], 0 offen offset:32 sc1
    buffer_load_dwordx4 v[164:167], v28, s[32:35], 0 offen offset:48 sc1
    s_mov_b64 exec, -1
    s_waitcnt lgkmcnt(0)
    s_barrier
    v_mfma_f32_16x16x32_bf16 v[64:67], v[120:123], v[128:131], v[64:67]
    ds_read_b64_tr_b16 v[96:97], v11 offset:24576
    ds_read_b64_tr_b16 v[98:99], v11 offset:25088
    v_mfma_f32_16x16x32_bf16 v[68:71], v[124:127], v[128:131], v[68:71]
    ds_read_b128 v[104:107], v8 offset:24576
    ds_read_b64_tr_b16 v[100:101], v12 offset:24576
    v_mfma_f32_16x16x32_bf16 v[72:75], v[120:123], v[132:135], v[72:75]
    ds_read_b64_tr_b16 v[102:103], v12 offset:25088
    ds_read_b128 v[108:111], v8 offset:26624
    v_mfma_f32_16x16x32_bf16 v[76:79], v[124:127], v[132:135], v[76:79]
    ds_read_b128 v[112:115], v8 offset:28672
    ds_read_b128 v[116:119], v8 offset:30720
    v_mfma_f32_16x16x32_bf16 v[80:83], v[120:123], v[136:139], v[80:83]
    v_mfma_f32_16x16x32_bf16 v[84:87], v[124:127], v[136:139], v[84:87]
    v_mfma_f32_16x16x32_bf16 v[88:91], v[120:123], v[140:143], v[88:91]
    v_mfma_f32_16x16x32_bf16 v[92:95], v[124:127], v[140:143], v[92:95]
    s_waitcnt lgkmcnt(0)
    s_barrier
    v_mfma_f32_16x16x32_bf16 v[64:67], v[96:99], v[104:107], v[64:67]
    ds_read_b64_tr_b16 v[120:121], v15 offset:0
    ds_read_b64_tr_b16 v[122:123], v15 offset:512
    v_mfma_f32_16x16x32_bf16 v[68:71], v[100:103], v[104:107], v[68:71]
    ds_read_b128 v[128:131], v9 offset:0
    ds_read_b64_tr_b16 v[124:125], v16 offset:0
    v_mfma_f32_16x16x32_bf16 v[72:75], v[96:99], v[108:111], v[72:75]
    ds_read_b64_tr_b16 v[126:127], v16 offset:512
    ds_read_b128 v[132:135], v9 offset:2048
    v_mfma_f32_16x16x32_bf16 v[76:79], v[100:103], v[108:111], v[76:79]
    ds_read_b128 v[136:139], v9 offset:4096
    ds_read_b128 v[140:143], v9 offset:6144
    v_mfma_f32_16x16x32_bf16 v[80:83], v[96:99], v[112:115], v[80:83]
    v_mfma_f32_16x16x32_bf16 v[84:87], v[100:103], v[112:115], v[84:87]
    v_mfma_f32_16x16x32_bf16 v[88:91], v[96:99], v[116:119], v[88:91]
    v_mfma_f32_16x16x32_bf16 v[92:95], v[100:103], v[116:119], v[92:95]
    s_mov_b32 s76, 100000
m_stchk12:
    s_waitcnt vmcnt(0)
    v_xor_b32 v144, v154, v5
    v_xor_b32 v145, v158, v5
    v_xor_b32 v146, v162, v5
    v_xor_b32 v147, v166, v5
    v_or3_b32 v144, v144, v145, v146
    v_or_b32 v144, v144, v147
    v_cmp_ne_u32 vcc, 0, v144
    s_sub_u32 s76, s76, 1
    s_cbranch_scc1 m_stok13
    s_cmp_eq_u64 vcc, 0
    s_cbranch_scc1 m_stok13
    s_mov_b64 exec, s[68:69]
    buffer_load_dwordx4 v[152:155], v28, s[32:35], 0 offen offset:0 sc1
    buffer_load_dwordx4 v[156:159], v28, s[32:35], 0 offen offset:16 sc1
    buffer_load_dwordx4 v[160:163], v28, s[32:35], 0 offen offset:32 sc1
    buffer_load_dwordx4 v[164:167], v28, s[32:35], 0 offen offset:48 sc1
    s_mov_b64 exec, -1
    s_branch m_stchk12
m_stok13:
    v_mov_b32 v144, v152
    v_mov_b32 v145, v156
    v_mov_b32 v146, v160
    v_mov_b32 v147, v164
    s_nop 0
    v_add_f32_dpp v144, v144, v144 row_ror:8 row_mask:0xf bank_mask:0xf
    v_add_f32_dpp v145, v145, v145 row_ror:8 row_mask:0xf bank_mask:0xf
    v_add_f32_dpp v146, v146, v146 row_ror:8 row_mask:0xf bank_mask:0xf
    v_add_f32_dpp v147, v147, v147 row_ror:8 row_mask:0xf bank_mask:0xf
    v_add_f32_dpp v144, v144, v144 row_ror:4 row_mask:0xf bank_mask:0xf
    v_add_f32_dpp v145, v145, v145 row_ror:4 row_mask:0xf bank_mask:0xf
    v_add_f32_dpp v146, v146, v146 row_ror:4 row_mask:0xf bank_mask:0xf
    v_add_f32_dpp v147, v147, v147 row_ror:4 row_mask:0xf bank_mask:0xf
    v_add_f32_dpp v144, v144, v144 row_ror:2 row_mask:0xf bank_mask:0xf
    v_add_f32_dpp v145, v145, v145 row_ror:2 row_mask:0xf bank_mask:0xf
    v_add_f32_dpp v146, v146, v146 row_ror:2 row_mask:0xf bank_mask:0xf
    v_add_f32_dpp v147, v147, v147 row_ror:2 row_mask:0xf bank_mask:0xf
    v_add_f32_dpp v144, v144, v144 row_ror:1 row_mask:0xf bank_mask:0xf
    v_add_f32_dpp v145, v145, v145 row_ror:1 row_mask:0xf bank_mask:0xf
    v_add_f32_dpp v146, v146, v146 row_ror:1 row_mask:0xf bank_mask:0xf
    v_add_f32_dpp v147, v147, v147 row_ror:1 row_mask:0xf bank_mask:0xf
    s_mov_b32 s46, 0x3daaaaab
    v_mul_f32 v144, s46, v144
    v_mul_f32 v145, s46, v145
    v_mul_f32 v146, s46, v146
    v_mul_f32 v147, s46, v147
    v_sub_f32 v152, v152, v144
    v_sub_f32 v156, v156, v145
    v_sub_f32 v160, v160, v146
    v_sub_f32 v164, v164, v147
    v_mul_f32 v152, v152, v152
    v_mul_f32 v156, v156, v156
    v_mul_f32 v160, v160, v160
    v_mul_f32 v164, v164, v164
    v_fma_f32 v148, v152, v29, v153
    v_fma_f32 v149, v156, v29, v157
    v_fma_f32 v150, v160, v29, v161
    v_fma_f32 v151, v164, v29, v165
    s_nop 0
    v_add_f32_dpp v148, v148, v148 row_ror:8 row_mask:0xf bank_mask:0xf
    v_add_f32_dpp v149, v149, v149 row_ror:8 row_mask:0xf bank_mask:0xf
    v_add_f32_dpp v150, v150, v150 row_ror:8 row_mask:0xf bank_mask:0xf
    v_add_f32_dpp v151, v151, v151 row_ror:8 row_mask:0xf bank_mask:0xf
    v_add_f32_dpp v148, v148, v148 row_ror:4 row_mask:0xf bank_mask:0xf
    v_add_f32_dpp v149, v149, v149 row_ror:4 row_mask:0xf bank_mask:0xf
    v_add_f32_dpp v150, v150, v150 row_ror:4 row_mask:0xf bank_mask:0xf
    v_add_f32_dpp v151, v151, v151 row_ror:4 row_mask:0xf bank_mask:0xf
    v_add_f32_dpp v148, v148, v148 row_ror:2 row_mask:0xf bank_mask:0xf
    v_add_f32_dpp v149, v149, v149 row_ror:2 row_mask:0xf bank_mask:0xf
    v_add_f32_dpp v150, v150, v150 row_ror:2 row_mask:0xf bank_mask:0xf
    v_add_f32_dpp v151, v151, v151 row_ror:2 row_mask:0xf bank_mask:0xf
    v_add_f32_dpp v148, v148, v148 row_ror:1 row_mask:0xf bank_mask:0xf
    v_add_f32_dpp v149, v149, v149 row_ror:1 row_mask:0xf bank_mask:0xf
    v_add_f32_dpp v150, v150, v150 row_ror:1 row_mask:0xf bank_mask:0xf
    v_add_f32_dpp v151, v151, v151 row_ror:1 row_mask:0xf bank_mask:0xf
    s_mov_b32 s46, 0x3aaaaaab
    v_mul_f32 v148, s46, v148
    v_mul_f32 v149, s46, v149
    v_mul_f32 v150, s46, v150
    v_mul_f32 v151, s46, v151
    v_cvt_pk_bf16_f32 v48, v144, v145
    v_cvt_pk_bf16_f32 v49, v146, v147
    v_lshlrev_b32 v144, 16, v48
    v_and_b32 v145, 0xffff0000, v48
    v_lshlrev_b32 v146, 16, v49
    v_and_b32 v147, 0xffff0000, v49
    v_cvt_pk_bf16_f32 v50, v148, v149
    v_cvt_pk_bf16_f32 v51, v150, v151
    v_lshlrev_b32 v148, 16, v50
    v_and_b32 v149, 0xffff0000, v50
    v_lshlrev_b32 v150, 16, v51
    v_and_b32 v151, 0xffff0000, v51
    v_add_f32 v148, 0x3727c5ac, v148
    v_add_f32 v149, 0x3727c5ac, v149
    v_add_f32 v150, 0x3727c5ac, v150
    v_add_f32 v151, 0x3727c5ac, v151
    v_cvt_pk_bf16_f32 v48, v148, v149
    v_cvt_pk_bf16_f32 v49, v150, v151
    v_lshlrev_b32 v148, 16, v48
    v_and_b32 v149, 0xffff0000, v48
    v_lshlrev_b32 v150, 16, v49
    v_and_b32 v151, 0xffff0000, v49
    v_sqrt_f32 v148, v148
    v_sqrt_f32 v149, v149
    v_sqrt_f32 v150, v150
    v_sqrt_f32 v151, v151
    s_nop 0
    v_cvt_pk_bf16_f32 v48, v148, v149
    v_cvt_pk_bf16_f32 v49, v150, v151
    v_lshlrev_b32 v148, 16, v48
    v_and_b32 v149, 0xffff0000, v48
    v_lshlrev_b32 v150, 16, v49
    v_and_b32 v151, 0xffff0000, v49
    v_rcp_f32 v148, v148
    v_rcp_f32 v149, v149
    v_rcp_f32 v150, v150
    v_rcp_f32 v151, v151
    v_pk_add_f32 v[32:33], v[32:33], v[144:145] neg_lo:[0,1] neg_hi:[0,1]
    v_pk_add_f32 v[34:35], v[34:35], v[146:147] neg_lo:[0,1] neg_hi:[0,1]
    v_pk_add_f32 v[36:37], v[36:37], v[144:145] neg_lo:[0,1] neg_hi:[0,1]
    v_pk_add_f32 v[38:39], v[38:39], v[146:147] neg_lo:[0,1] neg_hi:[0,1]
    v_pk_add_f32 v[40:41], v[40:41], v[144:145] neg_lo:[0,1] neg_hi:[0,1]
    v_pk_add_f32 v[42:43], v[42:43], v[146:147] neg_lo:[0,1] neg_hi:[0,1]
    v_pk_add_f32 v[44:45], v[44:45], v[144:145] neg_lo:[0,1] neg_hi:[0,1]
    v_pk_add_f32 v[46:47], v[46:47], v[146:147] neg_lo:[0,1] neg_hi:[0,1]
    v_cvt_pk_bf16_f32 v48, v32, v33
    v_cvt_pk_bf16_f32 v49, v34, v35
    v_lshlrev_b32 v32, 16, v48
    v_and_b32 v33, 0xffff0000, v48
    v_lshlrev_b32 v34, 16, v49
    v_and_b32 v35, 0xffff0000, v49
    v_cvt_pk_bf16_f32 v50, v36, v37
    v_cvt_pk_bf16_f32 v51, v38, v39
    v_lshlrev_b32 v36, 16, v50
    v_and_b32 v37, 0xffff0000, v50
    v_lshlrev_b32 v38, 16, v51
    v_and_b32 v39, 0xffff0000, v51
    v_cvt_pk_bf16_f32 v52, v40, v41
    v_cvt_pk_bf16_f32 v53, v42, v43
    v_lshlrev_b32 v40, 16, v52
    v_and_b32 v41, 0xffff0000, v52
    v_lshlrev_b32 v42, 16, v53
    v_and_b32 v43, 0xffff0000, v53
    v_cvt_pk_bf16_f32 v54, v44, v45
    v_cvt_pk_bf16_f32 v55, v46, v47
    v_lshlrev_b32 v44, 16, v54
    v_and_b32 v45, 0xffff0000, v54
    v_lshlrev_b32 v46, 16, v55
    v_and_b32 v47, 0xffff0000, v55
    v_pk_mul_f32 v[32:33], v[32:33], v[148:149]
    v_pk_mul_f32 v[34:35], v[34:35], v[150:151]
    v_pk_mul_f32 v[36:37], v[36:37], v[148:149]
    v_pk_mul_f32 v[38:39], v[38:39], v[150:151]
    v_pk_mul_f32 v[40:41], v[40:41], v[148:149]
    v_pk_mul_f32 v[42:43], v[42:43], v[150:151]
    v_pk_mul_f32 v[44:45], v[44:45], v[148:149]
    v_pk_mul_f32 v[46:47], v[46:47], v[150:151]
    s_mov_b32 s46, 131072
    v_cvt_pk_bf16_f32 v56, v32, v33
    v_cvt_pk_bf16_f32 v57, v34, v35
    v_cvt_pk_bf16_f32 v58, v36, v37
    v_cvt_pk_bf16_f32 v59, v38, v39
    s_nop 1
    v_permlane16_swap_b32 v56, v58
    v_permlane16_swap_b32 v57, v59
    buffer_store_dwordx4 v[56:59], v25, s[28:31], 0 offen offset:0 sc1
    v_cvt_pk_bf16_f32 v60, v40, v41
    v_cvt_pk_bf16_f32 v61, v42, v43
    v_cvt_pk_bf16_f32 v62, v44, v45
    v_cvt_pk_bf16_f32 v63, v46, v47
    s_nop 1
    v_permlane16_swap_b32 v60, v62
    v_permlane16_swap_b32 v61, v63
    buffer_store_dwordx4 v[60:63], v25, s[28:31], s46 offen offset:0 sc1
    s_waitcnt lgkmcnt(0)
    s_barrier
    v_mfma_f32_16x16x32_bf16 v[64:67], v[120:123], v[128:131], v[64:67]
    ds_read_b64_tr_b16 v[96:97], v15 offset:24576
    ds_read_b64_tr_b16 v[98:99], v15 offset:25088
    v_mfma_f32_16x16x32_bf16 v[68:71], v[124:127], v[128:131], v[68:71]
    ds_read_b128 v[104:107], v9 offset:24576
    ds_read_b64_tr_b16 v[100:101], v16 offset:24576
    v_mfma_f32_16x16x32_bf16 v[72:75], v[120:123], v[132:135], v[72:75]
    ds_read_b64_tr_b16 v[102:103], v16 offset:25088
    ds_read_b128 v[108:111], v9 offset:26624
    v_mfma_f32_16x16x32_bf16 v[76:79], v[124:127], v[132:135], v[76:79]
    ds_read_b128 v[112:115], v9 offset:28672
    ds_read_b128 v[116:119], v9 offset:30720
    v_mfma_f32_16x16x32_bf16 v[80:83], v[120:123], v[136:139], v[80:83]
    v_mfma_f32_16x16x32_bf16 v[84:87], v[124:127], v[136:139], v[84:87]
    v_mfma_f32_16x16x32_bf16 v[88:91], v[120:123], v[140:143], v[88:91]
    v_mfma_f32_16x16x32_bf16 v[92:95], v[124:127], v[140:143], v[92:95]
    s_waitcnt lgkmcnt(0)
    s_barrier
    v_mfma_f32_16x16x32_bf16 v[64:67], v[96:99], v[104:107], v[64:67]
    ds_read_b64_tr_b16 v[120:121], v19 offset:0
    ds_read_b64_tr_b16 v[122:123], v19 offset:512
    v_mfma_f32_16x16x32_bf16 v[68:71], v[100:103], v[104:107], v[68:71]
    ds_read_b128 v[128:131], v10 offset:0
    ds_read_b64_tr_b16 v[124:125], v20 offset:0
    v_mfma_f32_16x16x32_bf16 v[72:75], v[96:99], v[108:111], v[72:75]
    ds_read_b64_tr_b16 v[126:127], v20 offset:512
    ds_read_b128 v[132:135], v10 offset:2048
    v_mfma_f32_16x16x32_bf16 v[76:79], v[100:103], v[108:111], v[76:79]
    ds_read_b128 v[136:139], v10 offset:4096
    ds_read_b128 v[140:143], v10 offset:6144
    v_mfma_f32_16x16x32_bf16 v[80:83], v[96:99], v[112:115], v[80:83]
    v_mfma_f32_16x16x32_bf16 v[84:87], v[100:103], v[112:115], v[84:87]
    v_mfma_f32_16x16x32_bf16 v[88:91], v[96:99], v[116:119], v[88:91]
    v_mfma_f32_16x16x32_bf16 v[92:95], v[100:103], v[116:119], v[92:95]
    s_waitcnt vmcnt(0)
    v_mov_b32 v144, 163824
    v_mov_b32 v145, 1
    s_mov_b64 exec, 1
    ds_add_rtn_u32 v145, v144, v145
    s_waitcnt lgkmcnt(0)
    s_mov_b64 exec, -1
    v_readfirstlane_b32 s46, v145
    s_cmp_lg_u32 s46, 7
    s_cbranch_scc1 m_sig14
    v_mov_b32 v144, 163836
    ds_read_b32 v144, v144
    s_waitcnt lgkmcnt(0)
    v_readfirstlane_b32 s97, v144
    s_nop 1
    s_lshl_b32 s76, s45, 1
    s_cmp_ge_u32 s76, 6
    s_cselect_b32 s77, 1, 0
    s_mul_i32 s60, s77, 6
    s_sub_u32 s76, s76, s60
    s_lshl_b32 s76, s76, 5
    s_add_u32 s76, s76, s77
    v_and_b32 v146, 1, v1
    v_lshlrev_b32 v144, 5, v146
    v_bfe_u32 v146, v1, 1, 2
    v_lshl_add_u32 v144, v146, 3, v144
    v_bfe_u32 v146, v1, 3, 2
    v_lshl_add_u32 v144, v146, 1, v144
    v_add_u32 v144, s76, v144
    v_lshlrev_b32 v144, 10, v144
    s_lshl_b32 s76, s44, 2
    s_add_u32 s76, s76, 128
    v_add_u32 v144, s76, v144
    s_mov_b32 vcc_lo, -1
    s_mov_b32 vcc_hi, 0
    v_mov_b32 v145, s97
    s_mov_b64 exec, vcc
    buffer_store_dword v145, v144, s[88:91], 0 offen sc1
    s_mov_b64 exec, -1
m_sig14:
    s_waitcnt lgkmcnt(0)
    v_mfma_f32_16x16x32_bf16 v[64:67], v[120:123], v[128:131], v[64:67]
    v_mfma_f32_16x16x32_bf16 v[68:71], v[124:127], v[128:131], v[68:71]
    v_mfma_f32_16x16x32_bf16 v[72:75], v[120:123], v[132:135], v[72:75]
    v_mfma_f32_16x16x32_bf16 v[76:79], v[124:127], v[132:135], v[76:79]
    v_mfma_f32_16x16x32_bf16 v[80:83], v[120:123], v[136:139], v[80:83]
    v_mfma_f32_16x16x32_bf16 v[84:87], v[124:127], v[136:139], v[84:87]
    v_mfma_f32_16x16x32_bf16 v[88:91], v[120:123], v[140:143], v[88:91]
    v_mfma_f32_16x16x32_bf16 v[92:95], v[124:127], v[140:143], v[92:95]
    s_nop 7
    s_cmp_lg_u32 s49, 0
    s_cbranch_scc1 m_xhi15
    ds_write_b128 v23, v[80:83] offset:0
    ds_write_b128 v23, v[84:87] offset:1024
    ds_write_b128 v23, v[88:91] offset:2048
    ds_write_b128 v23, v[92:95] offset:3072
    s_branch m_xj16
m_xhi15:
    ds_write_b128 v23, v[64:67] offset:0
    ds_write_b128 v23, v[68:71] offset:1024
    ds_write_b128 v23, v[72:75] offset:2048
    ds_write_b128 v23, v[76:79] offset:3072
    s_nop 1
    v_pk_add_f32 v[64:65], v[80:81], 0 op_sel_hi:[1,0]
    v_pk_add_f32 v[66:67], v[82:83], 0 op_sel_hi:[1,0]
    v_pk_add_f32 v[68:69], v[84:85], 0 op_sel_hi:[1,0]
    v_pk_add_f32 v[70:71], v[86:87], 0 op_sel_hi:[1,0]
    v_pk_add_f32 v[72:73], v[88:89], 0 op_sel_hi:[1,0]
    v_pk_add_f32 v[74:75], v[90:91], 0 op_sel_hi:[1,0]
    v_pk_add_f32 v[76:77], v[92:93], 0 op_sel_hi:[1,0]
    v_pk_add_f32 v[78:79], v[94:95], 0 op_sel_hi:[1,0]
m_xj16:
    s_waitcnt lgkmcnt(0)
    s_barrier
    ds_read_b128 v[80:83], v24 offset:0
    ds_read_b128 v[84:87], v24 offset:1024
    ds_read_b128 v[88:91], v24 offset:2048
    ds_read_b128 v[92:95], v24 offset:3072
    s_waitcnt lgkmcnt(0)
    v_pk_add_f32 v[64:65], v[64:65], v[80:81]
    v_pk_add_f32 v[66:67], v[66:67], v[82:83]
    v_pk_add_f32 v[68:69], v[68:69], v[84:85]
    v_pk_add_f32 v[70:71], v[70:71], v[86:87]
    v_pk_add_f32 v[72:73], v[72:73], v[88:89]
    v_pk_add_f32 v[74:75], v[74:75], v[90:91]
    v_pk_add_f32 v[76:77], v[76:77], v[92:93]
    v_pk_add_f32 v[78:79], v[78:79], v[94:95]
    v_cvt_pk_bf16_f32 v80, v64, v65
    v_cvt_pk_bf16_f32 v81, v66, v67
    v_lshlrev_b32 v64, 16, v80
    v_and_b32 v65, 0xffff0000, v80
    v_lshlrev_b32 v66, 16, v81
    v_and_b32 v67, 0xffff0000, v81
    v_cvt_pk_bf16_f32 v82, v68, v69
    v_cvt_pk_bf16_f32 v83, v70, v71
    v_lshlrev_b32 v68, 16, v82
    v_and_b32 v69, 0xffff0000, v82
    v_lshlrev_b32 v70, 16, v83
    v_and_b32 v71, 0xffff0000, v83
    v_cvt_pk_bf16_f32 v84, v72, v73
    v_cvt_pk_bf16_f32 v85, v74, v75
    v_lshlrev_b32 v72, 16, v84
    v_and_b32 v73, 0xffff0000, v84
    v_lshlrev_b32 v74, 16, v85
    v_and_b32 v75, 0xffff0000, v85
    v_cvt_pk_bf16_f32 v86, v76, v77
    v_cvt_pk_bf16_f32 v87, v78, v79
    v_lshlrev_b32 v76, 16, v86
    v_and_b32 v77, 0xffff0000, v86
    v_lshlrev_b32 v78, 16, v87
    v_and_b32 v79, 0xffff0000, v87
    v_pk_mul_f32 v[80:81], v[64:65], v[64:65]
    v_pk_mul_f32 v[82:83], v[66:67], v[66:67]
    v_pk_mul_f32 v[84:85], v[68:69], v[68:69]
    v_pk_mul_f32 v[86:87], v[70:71], v[70:71]
    v_pk_mul_f32 v[88:89], v[72:73], v[72:73]
    v_pk_mul_f32 v[90:91], v[74:75], v[74:75]
    v_pk_mul_f32 v[92:93], v[76:77], v[76:77]
    v_pk_mul_f32 v[94:95], v[78:79], v[78:79]
    v_pk_fma_f32 v[80:81], v[80:81], s[58:59], v[30:31]
    v_pk_fma_f32 v[82:83], v[82:83], s[58:59], v[30:31]
    v_pk_fma_f32 v[84:85], v[84:85], s[58:59], v[30:31]
    v_pk_fma_f32 v[86:87], v[86:87], s[58:59], v[30:31]
    v_pk_fma_f32 v[88:89], v[88:89], s[58:59], v[30:31]
    v_pk_fma_f32 v[90:91], v[90:91], s[58:59], v[30:31]
    v_pk_fma_f32 v[92:93], v[92:93], s[58:59], v[30:31]
    v_pk_fma_f32 v[94:95], v[94:95], s[58:59], v[30:31]
    v_pk_mul_f32 v[80:81], v[80:81], v[64:65]
    v_pk_mul_f32 v[82:83], v[82:83], v[66:67]
    v_pk_mul_f32 v[84:85], v[84:85], v[68:69]
    v_pk_mul_f32 v[86:87], v[86:87], v[70:71]
    v_pk_mul_f32 v[88:89], v[88:89], v[72:73]
    v_pk_mul_f32 v[90:91], v[90:91], v[74:75]
    v_pk_mul_f32 v[92:93], v[92:93], v[76:77]
    v_pk_mul_f32 v[94:95], v[94:95], v[78:79]
    v_exp_f32 v80, v80
    v_exp_f32 v81, v81
    v_exp_f32 v82, v82
    v_exp_f32 v83, v83
    v_exp_f32 v84, v84
    v_exp_f32 v85, v85
    v_exp_f32 v86, v86
    v_exp_f32 v87, v87
    v_exp_f32 v88, v88
    v_exp_f32 v89, v89
    v_exp_f32 v90, v90
    v_exp_f32 v91, v91
    v_exp_f32 v92, v92
    v_exp_f32 v93, v93
    v_exp_f32 v94, v94
    v_exp_f32 v95, v95
    v_pk_add_f32 v[80:81], v[80:81], 1.0 op_sel_hi:[1,0]
    v_pk_add_f32 v[82:83], v[82:83], 1.0 op_sel_hi:[1,0]
    v_pk_add_f32 v[84:85], v[84:85], 1.0 op_sel_hi:[1,0]
    v_pk_add_f32 v[86:87], v[86:87], 1.0 op_sel_hi:[1,0]
    v_pk_add_f32 v[88:89], v[88:89], 1.0 op_sel_hi:[1,0]
    v_pk_add_f32 v[90:91], v[90:91], 1.0 op_sel_hi:[1,0]
    v_pk_add_f32 v[92:93], v[92:93], 1.0 op_sel_hi:[1,0]
    v_pk_add_f32 v[94:95], v[94:95], 1.0 op_sel_hi:[1,0]
    v_rcp_f32 v80, v80
    v_rcp_f32 v81, v81
    v_rcp_f32 v82, v82
    v_rcp_f32 v83, v83
    v_rcp_f32 v84, v84
    v_rcp_f32 v85, v85
    v_rcp_f32 v86, v86
    v_rcp_f32 v87, v87
    v_rcp_f32 v88, v88
    v_rcp_f32 v89, v89
    v_rcp_f32 v90, v90
    v_rcp_f32 v91, v91
    v_rcp_f32 v92, v92
    v_rcp_f32 v93, v93
    v_rcp_f32 v94, v94
    v_rcp_f32 v95, v95
    v_pk_mul_f32 v[64:65], v[64:65], v[80:81]
    v_pk_mul_f32 v[66:67], v[66:67], v[82:83]
    v_pk_mul_f32 v[68:69], v[68:69], v[84:85]
    v_pk_mul_f32 v[70:71], v[70:71], v[86:87]
    v_pk_mul_f32 v[72:73], v[72:73], v[88:89]
    v_pk_mul_f32 v[74:75], v[74:75], v[90:91]
    v_pk_mul_f32 v[76:77], v[76:77], v[92:93]
    v_pk_mul_f32 v[78:79], v[78:79], v[94:95]
    v_cvt_pk_bf16_f32 v24, v64, v65
    v_cvt_pk_bf16_f32 v25, v66, v67
    v_cvt_pk_bf16_f32 v26, v68, v69
    v_cvt_pk_bf16_f32 v27, v70, v71
    v_cvt_pk_bf16_f32 v28, v72, v73
    v_cvt_pk_bf16_f32 v29, v74, v75
    v_cvt_pk_bf16_f32 v30, v76, v77
    v_cvt_pk_bf16_f32 v31, v78, v79
    v_lshlrev_b32 v2, 4, v1
    s_and_b32 s46, s96, 3
    s_lshl_b32 s46, s46, 11
    s_add_u32 s46, s46, 147456
    v_add_u32 v23, s46, v2
    s_cmp_ge_u32 s96, 4
    s_cbranch_scc1 m_lz17
    v_lshrrev_b32 v4, 1, v6
    v_xor_b32 v4, v4, v7
    v_lshlrev_b32 v4, 4, v4
    v_lshl_add_u32 v4, v6, 7, v4
    s_and_b32 s46, s96, 1
    s_lshl_b32 s46, s46, 12
    s_lshr_b32 s47, s96, 1
    s_lshl_b32 s47, s47, 13
    s_add_u32 s47, s47, 8192
    v_add_u32 v8, s46, v4
    v_add_u32 v14, s47, v4
    v_xor_b32 v9, 64, v8
    v_xor_b32 v15, 64, v14
    v_add_u32 v10, 49152, v8
    v_add_u32 v11, 49152, v9
    v_add_u32 v16, 49152, v14
    v_add_u32 v17, 49152, v15
    v_add_u32 v12, 98304, v8
    v_add_u32 v13, 98304, v9
    v_add_u32 v18, 98304, v14
    v_add_u32 v19, 98304, v15
    s_lshr_b32 s47, s96, 1
    s_lshl_b32 s47, s47, 6
    v_add_u32 v20, s47, v6
    v_lshlrev_b32 v21, 1, v20
    v_mul_u32_u24 v4, 1536, v20
    s_and_b32 s46, s96, 1
    s_lshl_b32 s46, s46, 6
    v_add_u32 v4, s46, v4
    v_lshl_add_u32 v20, v7, 3, v4
    v_and_b32 v2, 1, v7
    v_lshl_add_u32 v4, v2, 5, v4
    v_lshrrev_b32 v2, 1, v7
    v_lshl_add_u32 v22, v2, 4, v4
    v_mov_b32 v40, 0
    v_mov_b32 v41, 0
    v_mov_b32 v42, 0
    v_mov_b32 v43, 0
    v_mov_b32 v44, 0
    v_mov_b32 v45, 0
    v_mov_b32 v46, 0
    v_mov_b32 v47, 0
    v_mov_b32 v48, 0
    v_mov_b32 v49, 0
    v_mov_b32 v50, 0
    v_mov_b32 v51, 0
    v_mov_b32 v52, 0
    v_mov_b32 v53, 0
    v_mov_b32 v54, 0
    v_mov_b32 v55, 0
    v_mov_b32 v56, 0
    v_mov_b32 v57, 0
    v_mov_b32 v58, 0
    v_mov_b32 v59, 0
    v_mov_b32 v60, 0
    v_mov_b32 v61, 0
    v_mov_b32 v62, 0
    v_mov_b32 v63, 0
    v_mov_b32 v64, 0
    v_mov_b32 v65, 0
    v_mov_b32 v66, 0
    v_mov_b32 v67, 0
    v_mov_b32 v68, 0
    v_mov_b32 v69, 0
    v_mov_b32 v70, 0
    v_mov_b32 v71, 0
    s_mul_i32 s46, s70, 196608
    s_lshl_b32 s47, s71, 7
    s_add_u32 s46, s46, s47
    s_add_u32 s47, s46, 0
    s_add_u32 s16, s94, s47
    s_addc_u32 s17, s95, 0
    s_mov_b32 s18, 0x2fa80
    s_mov_b32 s19, 0x00020000
    s_add_u32 s47, s46, 6291456
    s_add_u32 s20, s94, s47
    s_addc_u32 s21, s95, 0
    s_mov_b32 s22, 0x2fa80
    s_mov_b32 s23, 0x00020000
    s_lshl_b32 s46, s70, 8
    s_add_u32 s24, s10, s46
    s_addc_u32 s25, s11, 0
    s_mov_b32 s26, 0x100
    s_mov_b32 s27, 0x00020000
    buffer_load_ushort v2, v21, s[24:27], 0 offen offset:0
    buffer_load_ushort v3, v21, s[24:27], 0 offen offset:32
    buffer_load_ushort v4, v21, s[24:27], 0 offen offset:64
    buffer_load_ushort v5, v21, s[24:27], 0 offen offset:96
    s_barrier
    ds_read_b128 v[32:35], v23
    ds_read_b128 v[36:39], v23 offset:1024
    ds_read_b128 v[72:75], v12 offset:0
    ds_read_b128 v[80:83], v18 offset:0
    ds_read_b128 v[76:79], v12 offset:2048
    ds_read_b128 v[84:87], v18 offset:2048
    ds_read_b128 v[88:91], v18 offset:4096
    ds_read_b128 v[92:95], v18 offset:6144
    ds_read_b128 v[96:99], v13 offset:0
    ds_read_b128 v[104:107], v19 offset:0
    ds_read_b128 v[100:103], v13 offset:2048
    ds_read_b128 v[108:111], v19 offset:2048
    ds_read_b128 v[112:115], v19 offset:4096
    ds_read_b128 v[116:119], v19 offset:6144
    s_mov_b32 s48, 4
m_cloop18:
    s_waitcnt lgkmcnt(0)
    s_barrier
    v_mfma_f32_16x16x32_bf16 v[40:43], v[72:75], v[80:83], v[40:43]
    ds_read_b128 v[120:123], v12 offset:24576
    v_mfma_f32_16x16x32_bf16 v[44:47], v[76:79], v[80:83], v[44:47]
    ds_read_b128 v[128:131], v18 offset:24576
    v_mfma_f32_16x16x32_bf16 v[48:51], v[72:75], v[84:87], v[48:51]
    ds_read_b128 v[124:127], v12 offset:26624
    v_mfma_f32_16x16x32_bf16 v[52:55], v[76:79], v[84:87], v[52:55]
    ds_read_b128 v[132:135], v18 offset:26624
    v_mfma_f32_16x16x32_bf16 v[56:59], v[72:75], v[88:91], v[56:59]
    ds_read_b128 v[136:139], v18 offset:28672
    v_mfma_f32_16x16x32_bf16 v[60:63], v[76:79], v[88:91], v[60:63]
    ds_read_b128 v[140:143], v18 offset:30720
    v_mfma_f32_16x16x32_bf16 v[64:67], v[72:75], v[92:95], v[64:67]
    ds_read_b128 v[144:147], v13 offset:24576
    v_mfma_f32_16x16x32_bf16 v[68:71], v[76:79], v[92:95], v[68:71]
    ds_read_b128 v[152:155], v19 offset:24576
    v_mfma_f32_16x16x32_bf16 v[40:43], v[96:99], v[104:107], v[40:43]
    ds_read_b128 v[148:151], v13 offset:26624
    v_mfma_f32_16x16x32_bf16 v[44:47], v[100:103], v[104:107], v[44:47]
    ds_read_b128 v[156:159], v19 offset:26624
    v_mfma_f32_16x16x32_bf16 v[48:51], v[96:99], v[108:111], v[48:51]
    ds_read_b128 v[160:163], v19 offset:28672
    v_mfma_f32_16x16x32_bf16 v[52:55], v[100:103], v[108:111], v[52:55]
    ds_read_b128 v[164:167], v19 offset:30720
    v_mfma_f32_16x16x32_bf16 v[56:59], v[96:99], v[112:115], v[56:59]
    v_mfma_f32_16x16x32_bf16 v[60:63], v[100:103], v[112:115], v[60:63]
    v_mfma_f32_16x16x32_bf16 v[64:67], v[96:99], v[116:119], v[64:67]
    v_mfma_f32_16x16x32_bf16 v[68:71], v[100:103], v[116:119], v[68:71]
    s_waitcnt lgkmcnt(0)
    s_barrier
    v_mfma_f32_16x16x32_bf16 v[40:43], v[120:123], v[128:131], v[40:43]
    ds_read_b128 v[72:75], v8 offset:0
    v_mfma_f32_16x16x32_bf16 v[44:47], v[124:127], v[128:131], v[44:47]
    ds_read_b128 v[80:83], v14 offset:0
    v_mfma_f32_16x16x32_bf16 v[48:51], v[120:123], v[132:135], v[48:51]
    ds_read_b128 v[76:79], v8 offset:2048
    v_mfma_f32_16x16x32_bf16 v[52:55], v[124:127], v[132:135], v[52:55]
    ds_read_b128 v[84:87], v14 offset:2048
    v_mfma_f32_16x16x32_bf16 v[56:59], v[120:123], v[136:139], v[56:59]
    ds_read_b128 v[88:91], v14 offset:4096
    v_mfma_f32_16x16x32_bf16 v[60:63], v[124:127], v[136:139], v[60:63]
    ds_read_b128 v[92:95], v14 offset:6144
    v_mfma_f32_16x16x32_bf16 v[64:67], v[120:123], v[140:143], v[64:67]
    ds_read_b128 v[96:99], v9 offset:0
    v_mfma_f32_16x16x32_bf16 v[68:71], v[124:127], v[140:143], v[68:71]
    ds_read_b128 v[104:107], v15 offset:0
    v_mfma_f32_16x16x32_bf16 v[40:43], v[144:147], v[152:155], v[40:43]
    ds_read_b128 v[100:103], v9 offset:2048
    v_mfma_f32_16x16x32_bf16 v[44:47], v[148:151], v[152:155], v[44:47]
    ds_read_b128 v[108:111], v15 offset:2048
    v_mfma_f32_16x16x32_bf16 v[48:51], v[144:147], v[156:159], v[48:51]
    ds_read_b128 v[112:115], v15 offset:4096
    v_mfma_f32_16x16x32_bf16 v[52:55], v[148:151], v[156:159], v[52:55]
    ds_read_b128 v[116:119], v15 offset:6144
    v_mfma_f32_16x16x32_bf16 v[56:59], v[144:147], v[160:163], v[56:59]
    v_mfma_f32_16x16x32_bf16 v[60:63], v[148:151], v[160:163], v[60:63]
    v_mfma_f32_16x16x32_bf16 v[64:67], v[144:147], v[164:167], v[64:67]
    v_mfma_f32_16x16x32_bf16 v[68:71], v[148:151], v[164:167], v[68:71]
    s_waitcnt lgkmcnt(0)
    s_barrier
    v_mfma_f32_16x16x32_bf16 v[40:43], v[72:75], v[80:83], v[40:43]
    ds_read_b128 v[120:123], v8 offset:24576
    v_mfma_f32_16x16x32_bf16 v[44:47], v[76:79], v[80:83], v[44:47]
    ds_read_b128 v[128:131], v14 offset:24576
    v_mfma_f32_16x16x32_bf16 v[48:51], v[72:75], v[84:87], v[48:51]
    ds_read_b128 v[124:127], v8 offset:26624
    v_mfma_f32_16x16x32_bf16 v[52:55], v[76:79], v[84:87], v[52:55]
    ds_read_b128 v[132:135], v14 offset:26624
    v_mfma_f32_16x16x32_bf16 v[56:59], v[72:75], v[88:91], v[56:59]
    ds_read_b128 v[136:139], v14 offset:28672
    v_mfma_f32_16x16x32_bf16 v[60:63], v[76:79], v[88:91], v[60:63]
    ds_read_b128 v[140:143], v14 offset:30720
    v_mfma_f32_16x16x32_bf16 v[64:67], v[72:75], v[92:95], v[64:67]
    ds_read_b128 v[144:147], v9 offset:24576
    v_mfma_f32_16x16x32_bf16 v[68:71], v[76:79], v[92:95], v[68:71]
    ds_read_b128 v[152:155], v15 offset:24576
    v_mfma_f32_16x16x32_bf16 v[40:43], v[96:99], v[104:107], v[40:43]
    ds_read_b128 v[148:151], v9 offset:26624
    v_mfma_f32_16x16x32_bf16 v[44:47], v[100:103], v[104:107], v[44:47]
    ds_read_b128 v[156:159], v15 offset:26624
    v_mfma_f32_16x16x32_bf16 v[48:51], v[96:99], v[108:111], v[48:51]
    ds_read_b128 v[160:163], v15 offset:28672
    v_mfma_f32_16x16x32_bf16 v[52:55], v[100:103], v[108:111], v[52:55]
    ds_read_b128 v[164:167], v15 offset:30720
    v_mfma_f32_16x16x32_bf16 v[56:59], v[96:99], v[112:115], v[56:59]
    v_mfma_f32_16x16x32_bf16 v[60:63], v[100:103], v[112:115], v[60:63]
    v_mfma_f32_16x16x32_bf16 v[64:67], v[96:99], v[116:119], v[64:67]
    v_mfma_f32_16x16x32_bf16 v[68:71], v[100:103], v[116:119], v[68:71]
    s_waitcnt lgkmcnt(0)
    s_barrier
    v_mfma_f32_16x16x32_bf16 v[40:43], v[120:123], v[128:131], v[40:43]
    ds_read_b128 v[72:75], v10 offset:0
    v_mfma_f32_16x16x32_bf16 v[44:47], v[124:127], v[128:131], v[44:47]
    ds_read_b128 v[80:83], v16 offset:0
    v_mfma_f32_16x16x32_bf16 v[48:51], v[120:123], v[132:135], v[48:51]
    ds_read_b128 v[76:79], v10 offset:2048
    v_mfma_f32_16x16x32_bf16 v[52:55], v[124:127], v[132:135], v[52:55]
    ds_read_b128 v[84:87], v16 offset:2048
    v_mfma_f32_16x16x32_bf16 v[56:59], v[120:123], v[136:139], v[56:59]
    ds_read_b128 v[88:91], v16 offset:4096
    v_mfma_f32_16x16x32_bf16 v[60:63], v[124:127], v[136:139], v[60:63]
    ds_read_b128 v[92:95], v16 offset:6144
    v_mfma_f32_16x16x32_bf16 v[64:67], v[120:123], v[140:143], v[64:67]
    ds_read_b128 v[96:99], v11 offset:0
    v_mfma_f32_16x16x32_bf16 v[68:71], v[124:127], v[140:143], v[68:71]
    ds_read_b128 v[104:107], v17 offset:0
    v_mfma_f32_16x16x32_bf16 v[40:43], v[144:147], v[152:155], v[40:43]
    ds_read_b128 v[100:103], v11 offset:2048
    v_mfma_f32_16x16x32_bf16 v[44:47], v[148:151], v[152:155], v[44:47]
    ds_read_b128 v[108:111], v17 offset:2048
    v_mfma_f32_16x16x32_bf16 v[48:51], v[144:147], v[156:159], v[48:51]
    ds_read_b128 v[112:115], v17 offset:4096
    v_mfma_f32_16x16x32_bf16 v[52:55], v[148:151], v[156:159], v[52:55]
    ds_read_b128 v[116:119], v17 offset:6144
    v_mfma_f32_16x16x32_bf16 v[56:59], v[144:147], v[160:163], v[56:59]
    v_mfma_f32_16x16x32_bf16 v[60:63], v[148:151], v[160:163], v[60:63]
    v_mfma_f32_16x16x32_bf16 v[64:67], v[144:147], v[164:167], v[64:67]
    v_mfma_f32_16x16x32_bf16 v[68:71], v[148:151], v[164:167], v[68:71]
    s_waitcnt lgkmcnt(0)
    s_barrier
    v_mfma_f32_16x16x32_bf16 v[40:43], v[72:75], v[80:83], v[40:43]
    ds_read_b128 v[120:123], v10 offset:24576
    v_mfma_f32_16x16x32_bf16 v[44:47], v[76:79], v[80:83], v[44:47]
    ds_read_b128 v[128:131], v16 offset:24576
    v_mfma_f32_16x16x32_bf16 v[48:51], v[72:75], v[84:87], v[48:51]
    ds_read_b128 v[124:127], v10 offset:26624
    v_mfma_f32_16x16x32_bf16 v[52:55], v[76:79], v[84:87], v[52:55]
    ds_read_b128 v[132:135], v16 offset:26624
    v_mfma_f32_16x16x32_bf16 v[56:59], v[72:75], v[88:91], v[56:59]
    ds_read_b128 v[136:139], v16 offset:28672
    v_mfma_f32_16x16x32_bf16 v[60:63], v[76:79], v[88:91], v[60:63]
    ds_read_b128 v[140:143], v16 offset:30720
    v_mfma_f32_16x16x32_bf16 v[64:67], v[72:75], v[92:95], v[64:67]
    ds_read_b128 v[144:147], v11 offset:24576
    v_mfma_f32_16x16x32_bf16 v[68:71], v[76:79], v[92:95], v[68:71]
    ds_read_b128 v[152:155], v17 offset:24576
    v_mfma_f32_16x16x32_bf16 v[40:43], v[96:99], v[104:107], v[40:43]
    ds_read_b128 v[148:151], v11 offset:26624
    v_mfma_f32_16x16x32_bf16 v[44:47], v[100:103], v[104:107], v[44:47]
    ds_read_b128 v[156:159], v17 offset:26624
    v_mfma_f32_16x16x32_bf16 v[48:51], v[96:99], v[108:111], v[48:51]
    ds_read_b128 v[160:163], v17 offset:28672
    v_mfma_f32_16x16x32_bf16 v[52:55], v[100:103], v[108:111], v[52:55]
    ds_read_b128 v[164:167], v17 offset:30720
    v_mfma_f32_16x16x32_bf16 v[56:59], v[96:99], v[112:115], v[56:59]
    v_mfma_f32_16x16x32_bf16 v[60:63], v[100:103], v[112:115], v[60:63]
    v_mfma_f32_16x16x32_bf16 v[64:67], v[96:99], v[116:119], v[64:67]
    v_mfma_f32_16x16x32_bf16 v[68:71], v[100:103], v[116:119], v[68:71]
    s_waitcnt lgkmcnt(0)
    s_barrier
    v_mfma_f32_16x16x32_bf16 v[40:43], v[120:123], v[128:131], v[40:43]
    ds_read_b128 v[72:75], v12 offset:0
    v_mfma_f32_16x16x32_bf16 v[44:47], v[124:127], v[128:131], v[44:47]
    ds_read_b128 v[80:83], v18 offset:0
    v_mfma_f32_16x16x32_bf16 v[48:51], v[120:123], v[132:135], v[48:51]
    ds_read_b128 v[76:79], v12 offset:2048
    v_mfma_f32_16x16x32_bf16 v[52:55], v[124:127], v[132:135], v[52:55]
    ds_read_b128 v[84:87], v18 offset:2048
    v_mfma_f32_16x16x32_bf16 v[56:59], v[120:123], v[136:139], v[56:59]
    ds_read_b128 v[88:91], v18 offset:4096
    v_mfma_f32_16x16x32_bf16 v[60:63], v[124:127], v[136:139], v[60:63]
    ds_read_b128 v[92:95], v18 offset:6144
    v_mfma_f32_16x16x32_bf16 v[64:67], v[120:123], v[140:143], v[64:67]
    ds_read_b128 v[96:99], v13 offset:0
    v_mfma_f32_16x16x32_bf16 v[68:71], v[124:127], v[140:143], v[68:71]
    ds_read_b128 v[104:107], v19 offset:0
    v_mfma_f32_16x16x32_bf16 v[40:43], v[144:147], v[152:155], v[40:43]
    ds_read_b128 v[100:103], v13 offset:2048
    v_mfma_f32_16x16x32_bf16 v[44:47], v[148:151], v[152:155], v[44:47]
    ds_read_b128 v[108:111], v19 offset:2048
    v_mfma_f32_16x16x32_bf16 v[48:51], v[144:147], v[156:159], v[48:51]
    ds_read_b128 v[112:115], v19 offset:4096
    v_mfma_f32_16x16x32_bf16 v[52:55], v[148:151], v[156:159], v[52:55]
    ds_read_b128 v[116:119], v19 offset:6144
    v_mfma_f32_16x16x32_bf16 v[56:59], v[144:147], v[160:163], v[56:59]
    v_mfma_f32_16x16x32_bf16 v[60:63], v[148:151], v[160:163], v[60:63]
    v_mfma_f32_16x16x32_bf16 v[64:67], v[144:147], v[164:167], v[64:67]
    v_mfma_f32_16x16x32_bf16 v[68:71], v[148:151], v[164:167], v[68:71]
    s_sub_u32 s48, s48, 1
    s_cmp_lg_u32 s48, 0
    s_cbranch_scc1 m_cloop18
    s_waitcnt lgkmcnt(0)
    s_barrier
    v_mfma_f32_16x16x32_bf16 v[40:43], v[72:75], v[80:83], v[40:43]
    ds_read_b128 v[120:123], v12 offset:24576
    v_mfma_f32_16x16x32_bf16 v[44:47], v[76:79], v[80:83], v[44:47]
    ds_read_b128 v[128:131], v18 offset:24576
    v_mfma_f32_16x16x32_bf16 v[48:51], v[72:75], v[84:87], v[48:51]
    ds_read_b128 v[124:127], v12 offset:26624
    v_mfma_f32_16x16x32_bf16 v[52:55], v[76:79], v[84:87], v[52:55]
    ds_read_b128 v[132:135], v18 offset:26624
    v_mfma_f32_16x16x32_bf16 v[56:59], v[72:75], v[88:91], v[56:59]
    ds_read_b128 v[136:139], v18 offset:28672
    v_mfma_f32_16x16x32_bf16 v[60:63], v[76:79], v[88:91], v[60:63]
    ds_read_b128 v[140:143], v18 offset:30720
    v_mfma_f32_16x16x32_bf16 v[64:67], v[72:75], v[92:95], v[64:67]
    ds_read_b128 v[144:147], v13 offset:24576
    v_mfma_f32_16x16x32_bf16 v[68:71], v[76:79], v[92:95], v[68:71]
    ds_read_b128 v[152:155], v19 offset:24576
    v_mfma_f32_16x16x32_bf16 v[40:43], v[96:99], v[104:107], v[40:43]
    ds_read_b128 v[148:151], v13 offset:26624
    v_mfma_f32_16x16x32_bf16 v[44:47], v[100:103], v[104:107], v[44:47]
    ds_read_b128 v[156:159], v19 offset:26624
    v_mfma_f32_16x16x32_bf16 v[48:51], v[96:99], v[108:111], v[48:51]
    ds_read_b128 v[160:163], v19 offset:28672
    v_mfma_f32_16x16x32_bf16 v[52:55], v[100:103], v[108:111], v[52:55]
    ds_read_b128 v[164:167], v19 offset:30720
    v_mfma_f32_16x16x32_bf16 v[56:59], v[96:99], v[112:115], v[56:59]
    v_mfma_f32_16x16x32_bf16 v[60:63], v[100:103], v[112:115], v[60:63]
    v_mfma_f32_16x16x32_bf16 v[64:67], v[96:99], v[116:119], v[64:67]
    v_mfma_f32_16x16x32_bf16 v[68:71], v[100:103], v[116:119], v[68:71]
    s_waitcnt lgkmcnt(0)
    s_barrier
    v_mfma_f32_16x16x32_bf16 v[40:43], v[120:123], v[128:131], v[40:43]
    ds_read_b128 v[72:75], v8 offset:0
    v_mfma_f32_16x16x32_bf16 v[44:47], v[124:127], v[128:131], v[44:47]
    ds_read_b128 v[80:83], v14 offset:0
    v_mfma_f32_16x16x32_bf16 v[48:51], v[120:123], v[132:135], v[48:51]
    ds_read_b128 v[76:79], v8 offset:2048
    v_mfma_f32_16x16x32_bf16 v[52:55], v[124:127], v[132:135], v[52:55]
    ds_read_b128 v[84:87], v14 offset:2048
    v_mfma_f32_16x16x32_bf16 v[56:59], v[120:123], v[136:139], v[56:59]
    ds_read_b128 v[88:91], v14 offset:4096
    v_mfma_f32_16x16x32_bf16 v[60:63], v[124:127], v[136:139], v[60:63]
    ds_read_b128 v[92:95], v14 offset:6144
    v_mfma_f32_16x16x32_bf16 v[64:67], v[120:123], v[140:143], v[64:67]
    ds_read_b128 v[96:99], v9 offset:0
    v_mfma_f32_16x16x32_bf16 v[68:71], v[124:127], v[140:143], v[68:71]
    ds_read_b128 v[104:107], v15 offset:0
    v_mfma_f32_16x16x32_bf16 v[40:43], v[144:147], v[152:155], v[40:43]
    ds_read_b128 v[100:103], v9 offset:2048
    v_mfma_f32_16x16x32_bf16 v[44:47], v[148:151], v[152:155], v[44:47]
    ds_read_b128 v[108:111], v15 offset:2048
    v_mfma_f32_16x16x32_bf16 v[48:51], v[144:147], v[156:159], v[48:51]
    ds_read_b128 v[112:115], v15 offset:4096
    v_mfma_f32_16x16x32_bf16 v[52:55], v[148:151], v[156:159], v[52:55]
    ds_read_b128 v[116:119], v15 offset:6144
    v_mfma_f32_16x16x32_bf16 v[56:59], v[144:147], v[160:163], v[56:59]
    v_mfma_f32_16x16x32_bf16 v[60:63], v[148:151], v[160:163], v[60:63]
    v_mfma_f32_16x16x32_bf16 v[64:67], v[144:147], v[164:167], v[64:67]
    v_mfma_f32_16x16x32_bf16 v[68:71], v[148:151], v[164:167], v[68:71]
    s_waitcnt lgkmcnt(0)
    s_barrier
    v_mfma_f32_16x16x32_bf16 v[40:43], v[72:75], v[80:83], v[40:43]
    ds_read_b128 v[120:123], v8 offset:24576
    v_mfma_f32_16x16x32_bf16 v[44:47], v[76:79], v[80:83], v[44:47]
    ds_read_b128 v[128:131], v14 offset:24576
    v_mfma_f32_16x16x32_bf16 v[48:51], v[72:75], v[84:87], v[48:51]
    ds_read_b128 v[124:127], v8 offset:26624
    v_mfma_f32_16x16x32_bf16 v[52:55], v[76:79], v[84:87], v[52:55]
    ds_read_b128 v[132:135], v14 offset:26624
    v_mfma_f32_16x16x32_bf16 v[56:59], v[72:75], v[88:91], v[56:59]
    ds_read_b128 v[136:139], v14 offset:28672
    v_mfma_f32_16x16x32_bf16 v[60:63], v[76:79], v[88:91], v[60:63]
    ds_read_b128 v[140:143], v14 offset:30720
    v_mfma_f32_16x16x32_bf16 v[64:67], v[72:75], v[92:95], v[64:67]
    ds_read_b128 v[144:147], v9 offset:24576
    v_mfma_f32_16x16x32_bf16 v[68:71], v[76:79], v[92:95], v[68:71]
    ds_read_b128 v[152:155], v15 offset:24576
    v_mfma_f32_16x16x32_bf16 v[40:43], v[96:99], v[104:107], v[40:43]
    ds_read_b128 v[148:151], v9 offset:26624
    v_mfma_f32_16x16x32_bf16 v[44:47], v[100:103], v[104:107], v[44:47]
    ds_read_b128 v[156:159], v15 offset:26624
    v_mfma_f32_16x16x32_bf16 v[48:51], v[96:99], v[108:111], v[48:51]
    ds_read_b128 v[160:163], v15 offset:28672
    v_mfma_f32_16x16x32_bf16 v[52:55], v[100:103], v[108:111], v[52:55]
    ds_read_b128 v[164:167], v15 offset:30720
    v_mfma_f32_16x16x32_bf16 v[56:59], v[96:99], v[112:115], v[56:59]
    v_mfma_f32_16x16x32_bf16 v[60:63], v[100:103], v[112:115], v[60:63]
    v_mfma_f32_16x16x32_bf16 v[64:67], v[96:99], v[116:119], v[64:67]
    v_mfma_f32_16x16x32_bf16 v[68:71], v[100:103], v[116:119], v[68:71]
    s_waitcnt lgkmcnt(0)
    s_barrier
    v_mfma_f32_16x16x32_bf16 v[40:43], v[120:123], v[128:131], v[40:43]
    ds_read_b128 v[72:75], v10 offset:0
    v_mfma_f32_16x16x32_bf16 v[44:47], v[124:127], v[128:131], v[44:47]
    ds_read_b128 v[80:83], v16 offset:0
    v_mfma_f32_16x16x32_bf16 v[48:51], v[120:123], v[132:135], v[48:51]
    ds_read_b128 v[76:79], v10 offset:2048
    v_mfma_f32_16x16x32_bf16 v[52:55], v[124:127], v[132:135], v[52:55]
    ds_read_b128 v[84:87], v16 offset:2048
    v_mfma_f32_16x16x32_bf16 v[56:59], v[120:123], v[136:139], v[56:59]
    ds_read_b128 v[88:91], v16 offset:4096
    v_mfma_f32_16x16x32_bf16 v[60:63], v[124:127], v[136:139], v[60:63]
    ds_read_b128 v[92:95], v16 offset:6144
    v_mfma_f32_16x16x32_bf16 v[64:67], v[120:123], v[140:143], v[64:67]
    ds_read_b128 v[96:99], v11 offset:0
    v_mfma_f32_16x16x32_bf16 v[68:71], v[124:127], v[140:143], v[68:71]
    ds_read_b128 v[104:107], v17 offset:0
    v_mfma_f32_16x16x32_bf16 v[40:43], v[144:147], v[152:155], v[40:43]
    ds_read_b128 v[100:103], v11 offset:2048
    v_mfma_f32_16x16x32_bf16 v[44:47], v[148:151], v[152:155], v[44:47]
    ds_read_b128 v[108:111], v17 offset:2048
    v_mfma_f32_16x16x32_bf16 v[48:51], v[144:147], v[156:159], v[48:51]
    ds_read_b128 v[112:115], v17 offset:4096
    v_mfma_f32_16x16x32_bf16 v[52:55], v[148:151], v[156:159], v[52:55]
    ds_read_b128 v[116:119], v17 offset:6144
    v_mfma_f32_16x16x32_bf16 v[56:59], v[144:147], v[160:163], v[56:59]
    v_mfma_f32_16x16x32_bf16 v[60:63], v[148:151], v[160:163], v[60:63]
    v_mfma_f32_16x16x32_bf16 v[64:67], v[144:147], v[164:167], v[64:67]
    v_mfma_f32_16x16x32_bf16 v[68:71], v[148:151], v[164:167], v[68:71]
    s_waitcnt lgkmcnt(0)
    s_barrier
    v_mfma_f32_16x16x32_bf16 v[40:43], v[72:75], v[80:83], v[40:43]
    ds_read_b128 v[120:123], v10 offset:24576
    v_mfma_f32_16x16x32_bf16 v[44:47], v[76:79], v[80:83], v[44:47]
    ds_read_b128 v[128:131], v16 offset:24576
    v_mfma_f32_16x16x32_bf16 v[48:51], v[72:75], v[84:87], v[48:51]
    ds_read_b128 v[124:127], v10 offset:26624
    v_mfma_f32_16x16x32_bf16 v[52:55], v[76:79], v[84:87], v[52:55]
    ds_read_b128 v[132:135], v16 offset:26624
    v_mfma_f32_16x16x32_bf16 v[56:59], v[72:75], v[88:91], v[56:59]
    ds_read_b128 v[136:139], v16 offset:28672
    v_mfma_f32_16x16x32_bf16 v[60:63], v[76:79], v[88:91], v[60:63]
    ds_read_b128 v[140:143], v16 offset:30720
    v_mfma_f32_16x16x32_bf16 v[64:67], v[72:75], v[92:95], v[64:67]
    ds_read_b128 v[144:147], v11 offset:24576
    v_mfma_f32_16x16x32_bf16 v[68:71], v[76:79], v[92:95], v[68:71]
    ds_read_b128 v[152:155], v17 offset:24576
    v_mfma_f32_16x16x32_bf16 v[40:43], v[96:99], v[104:107], v[40:43]
    ds_read_b128 v[148:151], v11 offset:26624
    v_mfma_f32_16x16x32_bf16 v[44:47], v[100:103], v[104:107], v[44:47]
    ds_read_b128 v[156:159], v17 offset:26624
    v_mfma_f32_16x16x32_bf16 v[48:51], v[96:99], v[108:111], v[48:51]
    ds_read_b128 v[160:163], v17 offset:28672
    v_mfma_f32_16x16x32_bf16 v[52:55], v[100:103], v[108:111], v[52:55]
    ds_read_b128 v[164:167], v17 offset:30720
    v_mfma_f32_16x16x32_bf16 v[56:59], v[96:99], v[112:115], v[56:59]
    v_mfma_f32_16x16x32_bf16 v[60:63], v[100:103], v[112:115], v[60:63]
    v_mfma_f32_16x16x32_bf16 v[64:67], v[96:99], v[116:119], v[64:67]
    v_mfma_f32_16x16x32_bf16 v[68:71], v[100:103], v[116:119], v[68:71]
    s_waitcnt lgkmcnt(0)
    s_barrier
    v_mfma_f32_16x16x32_bf16 v[40:43], v[120:123], v[128:131], v[40:43]
    ds_read_b128 v[72:75], v12 offset:0
    v_mfma_f32_16x16x32_bf16 v[44:47], v[124:127], v[128:131], v[44:47]
    ds_read_b128 v[80:83], v18 offset:0
    v_mfma_f32_16x16x32_bf16 v[48:51], v[120:123], v[132:135], v[48:51]
    ds_read_b128 v[76:79], v12 offset:2048
    v_mfma_f32_16x16x32_bf16 v[52:55], v[124:127], v[132:135], v[52:55]
    ds_read_b128 v[84:87], v18 offset:2048
    v_mfma_f32_16x16x32_bf16 v[56:59], v[120:123], v[136:139], v[56:59]
    ds_read_b128 v[88:91], v18 offset:4096
    v_mfma_f32_16x16x32_bf16 v[60:63], v[124:127], v[136:139], v[60:63]
    ds_read_b128 v[92:95], v18 offset:6144
    v_mfma_f32_16x16x32_bf16 v[64:67], v[120:123], v[140:143], v[64:67]
    ds_read_b128 v[96:99], v13 offset:0
    v_mfma_f32_16x16x32_bf16 v[68:71], v[124:127], v[140:143], v[68:71]
    ds_read_b128 v[104:107], v19 offset:0
    v_mfma_f32_16x16x32_bf16 v[40:43], v[144:147], v[152:155], v[40:43]
    ds_read_b128 v[100:103], v13 offset:2048
    v_mfma_f32_16x16x32_bf16 v[44:47], v[148:151], v[152:155], v[44:47]
    ds_read_b128 v[108:111], v19 offset:2048
    v_mfma_f32_16x16x32_bf16 v[48:51], v[144:147], v[156:159], v[48:51]
    ds_read_b128 v[112:115], v19 offset:4096
    v_mfma_f32_16x16x32_bf16 v[52:55], v[148:151], v[156:159], v[52:55]
    ds_read_b128 v[116:119], v19 offset:6144
    v_mfma_f32_16x16x32_bf16 v[56:59], v[144:147], v[160:163], v[56:59]
    v_mfma_f32_16x16x32_bf16 v[60:63], v[148:151], v[160:163], v[60:63]
    v_mfma_f32_16x16x32_bf16 v[64:67], v[144:147], v[164:167], v[64:67]
    v_mfma_f32_16x16x32_bf16 v[68:71], v[148:151], v[164:167], v[68:71]
    s_waitcnt lgkmcnt(0)
    s_barrier
    v_mfma_f32_16x16x32_bf16 v[40:43], v[72:75], v[80:83], v[40:43]
    ds_read_b128 v[120:123], v12 offset:24576
    v_mfma_f32_16x16x32_bf16 v[44:47], v[76:79], v[80:83], v[44:47]
    ds_read_b128 v[128:131], v18 offset:24576
    v_mfma_f32_16x16x32_bf16 v[48:51], v[72:75], v[84:87], v[48:51]
    ds_read_b128 v[124:127], v12 offset:26624
    v_mfma_f32_16x16x32_bf16 v[52:55], v[76:79], v[84:87], v[52:55]
    ds_read_b128 v[132:135], v18 offset:26624
    v_mfma_f32_16x16x32_bf16 v[56:59], v[72:75], v[88:91], v[56:59]
    ds_read_b128 v[136:139], v18 offset:28672
    v_mfma_f32_16x16x32_bf16 v[60:63], v[76:79], v[88:91], v[60:63]
    ds_read_b128 v[140:143], v18 offset:30720
    v_mfma_f32_16x16x32_bf16 v[64:67], v[72:75], v[92:95], v[64:67]
    ds_read_b128 v[144:147], v13 offset:24576
    v_mfma_f32_16x16x32_bf16 v[68:71], v[76:79], v[92:95], v[68:71]
    ds_read_b128 v[152:155], v19 offset:24576
    v_mfma_f32_16x16x32_bf16 v[40:43], v[96:99], v[104:107], v[40:43]
    ds_read_b128 v[148:151], v13 offset:26624
    v_mfma_f32_16x16x32_bf16 v[44:47], v[100:103], v[104:107], v[44:47]
    ds_read_b128 v[156:159], v19 offset:26624
    v_mfma_f32_16x16x32_bf16 v[48:51], v[96:99], v[108:111], v[48:51]
    ds_read_b128 v[160:163], v19 offset:28672
    v_mfma_f32_16x16x32_bf16 v[52:55], v[100:103], v[108:111], v[52:55]
    ds_read_b128 v[164:167], v19 offset:30720
    v_mfma_f32_16x16x32_bf16 v[56:59], v[96:99], v[112:115], v[56:59]
    v_mfma_f32_16x16x32_bf16 v[60:63], v[100:103], v[112:115], v[60:63]
    v_mfma_f32_16x16x32_bf16 v[64:67], v[96:99], v[116:119], v[64:67]
    v_mfma_f32_16x16x32_bf16 v[68:71], v[100:103], v[116:119], v[68:71]
    s_waitcnt lgkmcnt(0)
    v_mfma_f32_16x16x32_bf16 v[40:43], v[120:123], v[128:131], v[40:43]
    v_mfma_f32_16x16x32_bf16 v[44:47], v[124:127], v[128:131], v[44:47]
    v_mfma_f32_16x16x32_bf16 v[48:51], v[120:123], v[132:135], v[48:51]
    v_mfma_f32_16x16x32_bf16 v[52:55], v[124:127], v[132:135], v[52:55]
    v_mfma_f32_16x16x32_bf16 v[56:59], v[120:123], v[136:139], v[56:59]
    v_mfma_f32_16x16x32_bf16 v[60:63], v[124:127], v[136:139], v[60:63]
    v_mfma_f32_16x16x32_bf16 v[64:67], v[120:123], v[140:143], v[64:67]
    v_mfma_f32_16x16x32_bf16 v[68:71], v[124:127], v[140:143], v[68:71]
    v_mfma_f32_16x16x32_bf16 v[40:43], v[144:147], v[152:155], v[40:43]
    v_mfma_f32_16x16x32_bf16 v[44:47], v[148:151], v[152:155], v[44:47]
    v_mfma_f32_16x16x32_bf16 v[48:51], v[144:147], v[156:159], v[48:51]
    v_mfma_f32_16x16x32_bf16 v[52:55], v[148:151], v[156:159], v[52:55]
    v_mfma_f32_16x16x32_bf16 v[56:59], v[144:147], v[160:163], v[56:59]
    v_mfma_f32_16x16x32_bf16 v[60:63], v[148:151], v[160:163], v[60:63]
    v_mfma_f32_16x16x32_bf16 v[64:67], v[144:147], v[164:167], v[64:67]
    v_mfma_f32_16x16x32_bf16 v[68:71], v[148:151], v[164:167], v[68:71]
    s_waitcnt vmcnt(0)
    v_lshlrev_b32 v2, 16, v2
    v_lshlrev_b32 v3, 16, v3
    v_lshlrev_b32 v4, 16, v4
    v_lshlrev_b32 v5, 16, v5
    s_nop 3
    v_cvt_pk_bf16_f32 v72, v40, v41
    v_cvt_pk_bf16_f32 v73, v42, v43
    v_lshlrev_b32 v40, 16, v72
    v_and_b32 v41, 0xffff0000, v72
    v_lshlrev_b32 v42, 16, v73
    v_and_b32 v43, 0xffff0000, v73
    v_pk_add_f32 v[40:41], v[40:41], v[2:3] op_sel_hi:[1,0]
    v_pk_add_f32 v[42:43], v[42:43], v[2:3] op_sel_hi:[1,0]
    v_cvt_pk_bf16_f32 v72, v40, v41
    v_cvt_pk_bf16_f32 v73, v42, v43
    v_lshlrev_b32 v40, 16, v72
    v_and_b32 v41, 0xffff0000, v72
    v_lshlrev_b32 v42, 16, v73
    v_and_b32 v43, 0xffff0000, v73
    v_lshlrev_b32 v74, 16, v24
    v_and_b32 v75, 0xffff0000, v24
    v_lshlrev_b32 v76, 16, v25
    v_and_b32 v77, 0xffff0000, v25
    v_pk_mul_f32 v[40:41], v[40:41], v[74:75]
    v_pk_mul_f32 v[42:43], v[42:43], v[76:77]
    v_cvt_pk_bf16_f32 v104, v40, v41
    v_cvt_pk_bf16_f32 v105, v42, v43
    v_cvt_pk_bf16_f32 v80, v44, v45
    v_cvt_pk_bf16_f32 v81, v46, v47
    v_lshlrev_b32 v44, 16, v80
    v_and_b32 v45, 0xffff0000, v80
    v_lshlrev_b32 v46, 16, v81
    v_and_b32 v47, 0xffff0000, v81
    v_pk_add_f32 v[44:45], v[44:45], v[2:3] op_sel_hi:[1,0]
    v_pk_add_f32 v[46:47], v[46:47], v[2:3] op_sel_hi:[1,0]
    v_cvt_pk_bf16_f32 v80, v44, v45
    v_cvt_pk_bf16_f32 v81, v46, v47
    v_lshlrev_b32 v44, 16, v80
    v_and_b32 v45, 0xffff0000, v80
    v_lshlrev_b32 v46, 16, v81
    v_and_b32 v47, 0xffff0000, v81
    v_lshlrev_b32 v82, 16, v26
    v_and_b32 v83, 0xffff0000, v26
    v_lshlrev_b32 v84, 16, v27
    v_and_b32 v85, 0xffff0000, v27
    v_pk_mul_f32 v[44:45], v[44:45], v[82:83]
    v_pk_mul_f32 v[46:47], v[46:47], v[84:85]
    v_cvt_pk_bf16_f32 v106, v44, v45
    v_cvt_pk_bf16_f32 v107, v46, v47
    s_mov_b32 s46, 0
    s_nop 0
    v_permlane16_swap_b32 v104, v106
    v_permlane16_swap_b32 v105, v107
    buffer_store_dwordx4 v[104:107], v22, s[20:23], s46 offen sc1
    v_cvt_pk_bf16_f32 v88, v48, v49
    v_cvt_pk_bf16_f32 v89, v50, v51
    v_lshlrev_b32 v48, 16, v88
    v_and_b32 v49, 0xffff0000, v88
    v_lshlrev_b32 v50, 16, v89
    v_and_b32 v51, 0xffff0000, v89
    v_pk_add_f32 v[48:49], v[48:49], v[2:3] op_sel:[0,1] op_sel_hi:[1,1]
    v_pk_add_f32 v[50:51], v[50:51], v[2:3] op_sel:[0,1] op_sel_hi:[1,1]
    v_cvt_pk_bf16_f32 v88, v48, v49
    v_cvt_pk_bf16_f32 v89, v50, v51
    v_lshlrev_b32 v48, 16, v88
    v_and_b32 v49, 0xffff0000, v88
    v_lshlrev_b32 v50, 16, v89
    v_and_b32 v51, 0xffff0000, v89
    v_lshlrev_b32 v90, 16, v28
    v_and_b32 v91, 0xffff0000, v28
    v_lshlrev_b32 v92, 16, v29
    v_and_b32 v93, 0xffff0000, v29
    v_pk_mul_f32 v[48:49], v[48:49], v[90:91]
    v_pk_mul_f32 v[50:51], v[50:51], v[92:93]
    v_cvt_pk_bf16_f32 v108, v48, v49
    v_cvt_pk_bf16_f32 v109, v50, v51
    v_cvt_pk_bf16_f32 v96, v52, v53
    v_cvt_pk_bf16_f32 v97, v54, v55
    v_lshlrev_b32 v52, 16, v96
    v_and_b32 v53, 0xffff0000, v96
    v_lshlrev_b32 v54, 16, v97
    v_and_b32 v55, 0xffff0000, v97
    v_pk_add_f32 v[52:53], v[52:53], v[2:3] op_sel:[0,1] op_sel_hi:[1,1]
    v_pk_add_f32 v[54:55], v[54:55], v[2:3] op_sel:[0,1] op_sel_hi:[1,1]
    v_cvt_pk_bf16_f32 v96, v52, v53
    v_cvt_pk_bf16_f32 v97, v54, v55
    v_lshlrev_b32 v52, 16, v96
    v_and_b32 v53, 0xffff0000, v96
    v_lshlrev_b32 v54, 16, v97
    v_and_b32 v55, 0xffff0000, v97
    v_lshlrev_b32 v98, 16, v30
    v_and_b32 v99, 0xffff0000, v30
    v_lshlrev_b32 v100, 16, v31
    v_and_b32 v101, 0xffff0000, v31
    v_pk_mul_f32 v[52:53], v[52:53], v[98:99]
    v_pk_mul_f32 v[54:55], v[54:55], v[100:101]
    v_cvt_pk_bf16_f32 v110, v52, v53
    v_cvt_pk_bf16_f32 v111, v54, v55
    s_mov_b32 s46, 24576
    s_nop 0
    v_permlane16_swap_b32 v108, v110
    v_permlane16_swap_b32 v109, v111
    buffer_store_dwordx4 v[108:111], v22, s[20:23], s46 offen sc1
    v_cvt_pk_bf16_f32 v72, v56, v57
    v_cvt_pk_bf16_f32 v73, v58, v59
    v_lshlrev_b32 v56, 16, v72
    v_and_b32 v57, 0xffff0000, v72
    v_lshlrev_b32 v58, 16, v73
    v_and_b32 v59, 0xffff0000, v73
    v_pk_add_f32 v[56:57], v[56:57], v[4:5] op_sel_hi:[1,0]
    v_pk_add_f32 v[58:59], v[58:59], v[4:5] op_sel_hi:[1,0]
    v_cvt_pk_bf16_f32 v72, v56, v57
    v_cvt_pk_bf16_f32 v73, v58, v59
    v_lshlrev_b32 v56, 16, v72
    v_and_b32 v57, 0xffff0000, v72
    v_lshlrev_b32 v58, 16, v73
    v_and_b32 v59, 0xffff0000, v73
    v_lshlrev_b32 v74, 16, v32
    v_and_b32 v75, 0xffff0000, v32
    v_lshlrev_b32 v76, 16, v33
    v_and_b32 v77, 0xffff0000, v33
    v_pk_mul_f32 v[56:57], v[56:57], v[74:75]
    v_pk_mul_f32 v[58:59], v[58:59], v[76:77]
    v_cvt_pk_bf16_f32 v112, v56, v57
    v_cvt_pk_bf16_f32 v113, v58, v59
    v_cvt_pk_bf16_f32 v80, v60, v61
    v_cvt_pk_bf16_f32 v81, v62, v63
    v_lshlrev_b32 v60, 16, v80
    v_and_b32 v61, 0xffff0000, v80
    v_lshlrev_b32 v62, 16, v81
    v_and_b32 v63, 0xffff0000, v81
    v_pk_add_f32 v[60:61], v[60:61], v[4:5] op_sel_hi:[1,0]
    v_pk_add_f32 v[62:63], v[62:63], v[4:5] op_sel_hi:[1,0]
    v_cvt_pk_bf16_f32 v80, v60, v61
    v_cvt_pk_bf16_f32 v81, v62, v63
    v_lshlrev_b32 v60, 16, v80
    v_and_b32 v61, 0xffff0000, v80
    v_lshlrev_b32 v62, 16, v81
    v_and_b32 v63, 0xffff0000, v81
    v_lshlrev_b32 v82, 16, v34
    v_and_b32 v83, 0xffff0000, v34
    v_lshlrev_b32 v84, 16, v35
    v_and_b32 v85, 0xffff0000, v35
    v_pk_mul_f32 v[60:61], v[60:61], v[82:83]
    v_pk_mul_f32 v[62:63], v[62:63], v[84:85]
    v_cvt_pk_bf16_f32 v114, v60, v61
    v_cvt_pk_bf16_f32 v115, v62, v63
    s_mov_b32 s46, 49152
    s_nop 0
    v_permlane16_swap_b32 v112, v114
    v_permlane16_swap_b32 v113, v115
    buffer_store_dwordx4 v[112:115], v22, s[20:23], s46 offen sc1
    v_cvt_pk_bf16_f32 v88, v64, v65
    v_cvt_pk_bf16_f32 v89, v66, v67
    v_lshlrev_b32 v64, 16, v88
    v_and_b32 v65, 0xffff0000, v88
    v_lshlrev_b32 v66, 16, v89
    v_and_b32 v67, 0xffff0000, v89
    v_pk_add_f32 v[64:65], v[64:65], v[4:5] op_sel:[0,1] op_sel_hi:[1,1]
    v_pk_add_f32 v[66:67], v[66:67], v[4:5] op_sel:[0,1] op_sel_hi:[1,1]
    v_cvt_pk_bf16_f32 v88, v64, v65
    v_cvt_pk_bf16_f32 v89, v66, v67
    v_lshlrev_b32 v64, 16, v88
    v_and_b32 v65, 0xffff0000, v88
    v_lshlrev_b32 v66, 16, v89
    v_and_b32 v67, 0xffff0000, v89
    v_lshlrev_b32 v90, 16, v36
    v_and_b32 v91, 0xffff0000, v36
    v_lshlrev_b32 v92, 16, v37
    v_and_b32 v93, 0xffff0000, v37
    v_pk_mul_f32 v[64:65], v[64:65], v[90:91]
    v_pk_mul_f32 v[66:67], v[66:67], v[92:93]
    v_cvt_pk_bf16_f32 v116, v64, v65
    v_cvt_pk_bf16_f32 v117, v66, v67
    v_cvt_pk_bf16_f32 v96, v68, v69
    v_cvt_pk_bf16_f32 v97, v70, v71
    v_lshlrev_b32 v68, 16, v96
    v_and_b32 v69, 0xffff0000, v96
    v_lshlrev_b32 v70, 16, v97
    v_and_b32 v71, 0xffff0000, v97
    v_pk_add_f32 v[68:69], v[68:69], v[4:5] op_sel:[0,1] op_sel_hi:[1,1]
    v_pk_add_f32 v[70:71], v[70:71], v[4:5] op_sel:[0,1] op_sel_hi:[1,1]
    v_cvt_pk_bf16_f32 v96, v68, v69
    v_cvt_pk_bf16_f32 v97, v70, v71
    v_lshlrev_b32 v68, 16, v96
    v_and_b32 v69, 0xffff0000, v96
    v_lshlrev_b32 v70, 16, v97
    v_and_b32 v71, 0xffff0000, v97
    v_lshlrev_b32 v98, 16, v38
    v_and_b32 v99, 0xffff0000, v38
    v_lshlrev_b32 v100, 16, v39
    v_and_b32 v101, 0xffff0000, v39
    v_pk_mul_f32 v[68:69], v[68:69], v[98:99]
    v_pk_mul_f32 v[70:71], v[70:71], v[100:101]
    v_cvt_pk_bf16_f32 v118, v68, v69
    v_cvt_pk_bf16_f32 v119, v70, v71
    s_mov_b32 s46, 73728
    s_nop 0
    v_permlane16_swap_b32 v116, v118
    v_permlane16_swap_b32 v117, v119
    buffer_store_dwordx4 v[116:119], v22, s[20:23], s46 offen sc1
    s_waitcnt vmcnt(0)
    v_mov_b32 v8, 163828
    v_mov_b32 v9, 1
    s_mov_b64 exec, 1
    ds_add_rtn_u32 v9, v8, v9
    s_waitcnt lgkmcnt(0)
    s_mov_b64 exec, -1
    v_readfirstlane_b32 s46, v9
    s_cmp_lg_u32 s46, 3
    s_cbranch_scc1 m_sig19
    v_mov_b32 v8, 163836
    ds_read_b32 v8, v8
    s_waitcnt lgkmcnt(0)
    v_readfirstlane_b32 s97, v8
    s_nop 1
    s_lshl_b32 s76, s70, 1
    s_and_b32 s77, s76, 3
    s_lshl_b32 s77, s77, 3
    s_lshr_b32 s76, s76, 2
    s_add_u32 s76, s76, s77
    v_and_b32 v10, 7, v1
    v_lshlrev_b32 v8, 5, v10
    v_and_b32 v10, 8, v1
    v_add3_u32 v8, v8, v10, s76
    v_lshlrev_b32 v8, 10, v8
    s_lshl_b32 s76, s71, 2
    s_add_u32 s76, s76, 256
    v_add_u32 v8, s76, v8
    s_mov_b64 vcc, 0xffff
    v_mov_b32 v9, s97
    s_mov_b64 exec, vcc
    buffer_store_dword v9, v8, s[88:91], 0 offen sc1
    s_mov_b64 exec, -1
m_sig19:
    s_branch f_phase3
m_lz17:
    ds_write_b128 v23, v[24:27]
    ds_write_b128 v23, v[28:31] offset:1024
    s_sub_u32 s54, s96, 4
    v_lshrrev_b32 v2, 3, v1
    v_and_b32 v3, 7, v1
    v_lshrrev_b32 v4, 1, v2
    v_xor_b32 v3, v3, v4
    v_lshlrev_b32 v3, 4, v3
    v_lshl_add_u32 v3, v2, 12, v3
    v_xor_b32 v4, 64, v3
    s_lshl_b32 s46, s54, 16
    v_add_u32 v8, s46, v3
    s_add_u32 s46, s46, 31744
    v_add_u32 v9, s46, v4
    s_lshl_b32 s52, s54, 11
    s_lshl_b32 s46, s71, 18
    s_add_u32 s46, s46, 3145728
    s_add_u32 s16, s94, s46
    s_addc_u32 s17, s95, 0
    s_mov_b32 s18, 0x40000
    s_mov_b32 s19, 0x00020000
    s_lshr_b32 s75, s2, 3
    s_lshl_b32 s75, s75, 7
    v_mov_b32 v32, 163836
    ds_read_b32 v32, v32
    s_waitcnt lgkmcnt(0)
    v_readfirstlane_b32 s97, v32
    s_nop 1
    s_add_u32 s75, s75, 256
    s_and_b32 s75, s75, 0xfff
    s_waitcnt lgkmcnt(0)
    s_barrier
    s_add_u32 m0, s52, 0
    s_nop 0
    buffer_load_dwordx4 v8, s[16:19], s75 offen offset:0 sc1 lds
    buffer_load_dwordx4 v9, s[16:19], s75 offen offset:1024 sc1 lds
    s_add_u32 s75, s75, 128
    s_and_b32 s75, s75, 0xfff
    s_add_u32 m0, s52, 24576
    s_nop 0
    buffer_load_dwordx4 v8, s[16:19], s75 offen offset:0 sc1 lds
    buffer_load_dwordx4 v9, s[16:19], s75 offen offset:1024 sc1 lds
    s_add_u32 s75, s75, 128
    s_and_b32 s75, s75, 0xfff
    s_add_u32 s75, s75, 256
    s_and_b32 s75, s75, 0xfff
    s_waitcnt vmcnt(4)
    s_barrier
    s_add_u32 m0, s52, 98304
    s_nop 0
    buffer_load_dwordx4 v8, s[16:19], s75 offen offset:0 sc1 lds
    buffer_load_dwordx4 v9, s[16:19], s75 offen offset:1024 sc1 lds
    s_add_u32 s75, s75, 128
    s_and_b32 s75, s75, 0xfff
    s_waitcnt vmcnt(4)
    s_barrier
    s_add_u32 m0, s52, 122880
    s_nop 0
    buffer_load_dwordx4 v8, s[16:19], s75 offen offset:0 sc1 lds
    buffer_load_dwordx4 v9, s[16:19], s75 offen offset:1024 sc1 lds
    s_add_u32 s75, s75, 128
    s_and_b32 s75, s75, 0xfff
    s_waitcnt vmcnt(4)
    s_barrier
    s_add_u32 m0, s52, 0
    s_nop 0
    buffer_load_dwordx4 v8, s[16:19], s75 offen offset:0 sc1 lds
    buffer_load_dwordx4 v9, s[16:19], s75 offen offset:1024 sc1 lds
    s_add_u32 s75, s75, 128
    s_and_b32 s75, s75, 0xfff
    s_waitcnt vmcnt(6)
    s_barrier
    s_add_u32 m0, s52, 24576
    s_nop 0
    buffer_load_dwordx4 v8, s[16:19], s75 offen offset:0 sc1 lds
    buffer_load_dwordx4 v9, s[16:19], s75 offen offset:1024 sc1 lds
    s_add_u32 s75, s75, 128
    s_and_b32 s75, s75, 0xfff
    s_waitcnt vmcnt(8)
    s_barrier
    s_add_u32 m0, s52, 49152
    s_nop 0
    buffer_load_dwordx4 v8, s[16:19], s75 offen offset:0 sc1 lds
    buffer_load_dwordx4 v9, s[16:19], s75 offen offset:1024 sc1 lds
    s_add_u32 s75, s75, 128
    s_and_b32 s75, s75, 0xfff
    s_waitcnt vmcnt(8)
    s_barrier
    s_add_u32 m0, s52, 73728
    s_nop 0
    buffer_load_dwordx4 v8, s[16:19], s75 offen offset:0 sc1 lds
    buffer_load_dwordx4 v9, s[16:19], s75 offen offset:1024 sc1 lds
    s_add_u32 s75, s75, 128
    s_and_b32 s75, s75, 0xfff
    s_mov_b32 s76, 2
m_lzloop20:
    s_waitcnt vmcnt(8)
    s_barrier
    s_add_u32 m0, s52, 98304
    s_nop 0
    buffer_load_dwordx4 v8, s[16:19], s75 offen offset:0 sc1 lds
    buffer_load_dwordx4 v9, s[16:19], s75 offen offset:1024 sc1 lds
    s_add_u32 s75, s75, 128
    s_and_b32 s75, s75, 0xfff
    s_waitcnt vmcnt(8)
    s_barrier
    s_add_u32 m0, s52, 122880
    s_nop 0
    buffer_load_dwordx4 v8, s[16:19], s75 offen offset:0 sc1 lds
    buffer_load_dwordx4 v9, s[16:19], s75 offen offset:1024 sc1 lds
    s_add_u32 s75, s75, 128
    s_and_b32 s75, s75, 0xfff
    s_waitcnt vmcnt(8)
    s_barrier
    s_add_u32 m0, s52, 0
    s_nop 0
    buffer_load_dwordx4 v8, s[16:19], s75 offen offset:0 sc1 lds
    buffer_load_dwordx4 v9, s[16:19], s75 offen offset:1024 sc1 lds
    s_add_u32 s75, s75, 128
    s_and_b32 s75, s75, 0xfff
    s_waitcnt vmcnt(8)
    s_barrier
    s_add_u32 m0, s52, 24576
    s_nop 0
    buffer_load_dwordx4 v8, s[16:19], s75 offen offset:0 sc1 lds
    buffer_load_dwordx4 v9, s[16:19], s75 offen offset:1024 sc1 lds
    s_add_u32 s75, s75, 128
    s_and_b32 s75, s75, 0xfff
    s_waitcnt vmcnt(8)
    s_barrier
    s_add_u32 m0, s52, 49152
    s_nop 0
    buffer_load_dwordx4 v8, s[16:19], s75 offen offset:0 sc1 lds
    buffer_load_dwordx4 v9, s[16:19], s75 offen offset:1024 sc1 lds
    s_add_u32 s75, s75, 128
    s_and_b32 s75, s75, 0xfff
    s_waitcnt vmcnt(8)
    s_barrier
    s_add_u32 m0, s52, 73728
    s_nop 0
    buffer_load_dwordx4 v8, s[16:19], s75 offen offset:0 sc1 lds
    buffer_load_dwordx4 v9, s[16:19], s75 offen offset:1024 sc1 lds
    s_add_u32 s75, s75, 128
    s_and_b32 s75, s75, 0xfff
    s_sub_u32 s76, s76, 1
    s_cmp_lg_u32 s76, 0
    s_cbranch_scc1 m_lzloop20
    s_waitcnt vmcnt(8)
    s_barrier
    s_add_u32 m0, s52, 98304
    s_nop 0
    buffer_load_dwordx4 v8, s[16:19], s75 offen offset:0 sc1 lds
    buffer_load_dwordx4 v9, s[16:19], s75 offen offset:1024 sc1 lds
    s_add_u32 s75, s75, 128
    s_and_b32 s75, s75, 0xfff
    s_waitcnt vmcnt(8)
    s_barrier
    s_add_u32 m0, s52, 122880
    s_nop 0
    buffer_load_dwordx4 v8, s[16:19], s75 offen offset:0 sc1 lds
    buffer_load_dwordx4 v9, s[16:19], s75 offen offset:1024 sc1 lds
    s_add_u32 s75, s75, 128
    s_and_b32 s75, s75, 0xfff
    s_waitcnt vmcnt(8)
    s_barrier
    s_add_u32 m0, s52, 0
    s_nop 0
    buffer_load_dwordx4 v8, s[16:19], s75 offen offset:0 sc1 lds
    buffer_load_dwordx4 v9, s[16:19], s75 offen offset:1024 sc1 lds
    s_add_u32 s75, s75, 128
    s_and_b32 s75, s75, 0xfff
    s_waitcnt vmcnt(8)
    s_barrier
    s_add_u32 m0, s52, 24576
    s_nop 0
    buffer_load_dwordx4 v8, s[16:19], s75 offen offset:0 sc1 lds
    buffer_load_dwordx4 v9, s[16:19], s75 offen offset:1024 sc1 lds
    s_add_u32 s75, s75, 128
    s_and_b32 s75, s75, 0xfff
    s_waitcnt vmcnt(8)
    s_barrier
    s_add_u32 m0, s52, 49152
    s_nop 0
    buffer_load_dwordx4 v8, s[16:19], s75 offen offset:0 sc1 lds
    buffer_load_dwordx4 v9, s[16:19], s75 offen offset:1024 sc1 lds
    s_add_u32 s75, s75, 128
    s_and_b32 s75, s75, 0xfff
    s_waitcnt vmcnt(8)
    s_barrier
    s_add_u32 m0, s52, 73728
    s_nop 0
    buffer_load_dwordx4 v8, s[16:19], s75 offen offset:0 sc1 lds
    buffer_load_dwordx4 v9, s[16:19], s75 offen offset:1024 sc1 lds
    s_add_u32 s75, s75, 128
    s_and_b32 s75, s75, 0xfff
    s_waitcnt vmcnt(8)
    s_barrier
    s_add_u32 m0, s52, 98304
    s_nop 0
    buffer_load_dwordx4 v8, s[16:19], s75 offen offset:0 sc1 lds
    buffer_load_dwordx4 v9, s[16:19], s75 offen offset:1024 sc1 lds
    s_add_u32 s75, s75, 128
    s_and_b32 s75, s75, 0xfff
    s_waitcnt vmcnt(8)
    s_barrier
    s_add_u32 m0, s52, 122880
    s_nop 0
    buffer_load_dwordx4 v8, s[16:19], s75 offen offset:0 sc1 lds
    buffer_load_dwordx4 v9, s[16:19], s75 offen offset:1024 sc1 lds
    s_add_u32 s75, s75, 128
    s_and_b32 s75, s75, 0xfff
    s_waitcnt vmcnt(8)
    s_barrier
    s_waitcnt vmcnt(6)
    s_barrier
    s_waitcnt vmcnt(4)
    s_barrier
    s_waitcnt vmcnt(2)
    s_barrier
    s_waitcnt vmcnt(0)
    s_barrier
    s_branch f_phase3
f_aux:
    s_sub_u32 s3, s2, 192
    s_cmp_ge_u32 s96, 10
    s_cbranch_scc1 a_xw1
    s_load_dwordx8 s[4:11], s[0:1], 8
    s_load_dwordx8 s[12:19], s[0:1], 40
    s_load_dwordx2 s[20:21], s[0:1], 88
    s_load_dwordx2 s[60:61], s[0:1], 0
    s_load_dwordx2 s[62:63], s[0:1], 80
    v_lshlrev_b32 v5, 1, v1
    s_mul_i32 s23, s3, 10
    s_add_u32 s23, s23, s96
    s_mul_i32 s26, s96, 14464
    s_mul_i32 s24, s23, 384
    v_mov_b32 v16, 0
    v_mov_b32 v17, 0
    v_mov_b32 v18, 0
    v_mov_b32 v19, 0
    v_mov_b32 v20, 0
    v_mov_b32 v21, 0
    v_mov_b32 v22, 0
    v_mov_b32 v23, 0
    v_mov_b32 v24, 0
    v_mov_b32 v25, 0
    v_mov_b32 v26, 0
    v_mov_b32 v27, 0
    v_mov_b32 v28, 0
    v_mov_b32 v29, 0
    v_mov_b32 v30, 0
    v_mov_b32 v31, 0
    v_mov_b32 v32, 0
    v_mov_b32 v33, 0
    s_lshr_b32 s25, s23, 1
    s_lshl_b32 s25, s25, 2
    s_waitcnt lgkmcnt(0)
    s_load_dword s28, s[16:17], s25
    s_load_dword s31, s[18:19], s25
    s_add_u32 s32, s4, s24
    s_addc_u32 s33, s5, 0
    s_mov_b32 s34, 0x180
    s_mov_b32 s35, 0x00020000
    s_add_u32 s36, s6, s24
    s_addc_u32 s37, s7, 0
    s_mov_b32 s38, 0x180
    s_mov_b32 s39, 0x00020000
    s_add_u32 s40, s8, s24
    s_addc_u32 s41, s9, 0
    s_mov_b32 s42, 0x180
    s_mov_b32 s43, 0x00020000
    s_add_u32 s44, s10, s24
    s_addc_u32 s45, s11, 0
    s_mov_b32 s46, 0x180
    s_mov_b32 s47, 0x00020000
    s_add_u32 s48, s12, s24
    s_addc_u32 s49, s13, 0
    s_mov_b32 s50, 0x180
    s_mov_b32 s51, 0x00020000
    s_add_u32 s52, s14, s24
    s_addc_u32 s53, s15, 0
    s_mov_b32 s54, 0x180
    s_mov_b32 s55, 0x00020000
    buffer_load_short_d16_hi v16, v5, s[32:35], 0 offen offset:0
    buffer_load_short_d16_hi v17, v5, s[36:39], 0 offen offset:0
    buffer_load_short_d16_hi v18, v5, s[40:43], 0 offen offset:0
    buffer_load_short_d16_hi v19, v5, s[44:47], 0 offen offset:0
    buffer_load_short_d16_hi v20, v5, s[48:51], 0 offen offset:0
    buffer_load_short_d16_hi v21, v5, s[52:55], 0 offen offset:0
    buffer_load_short_d16_hi v22, v5, s[32:35], 0 offen offset:128
    buffer_load_short_d16_hi v23, v5, s[36:39], 0 offen offset:128
    buffer_load_short_d16_hi v24, v5, s[40:43], 0 offen offset:128
    buffer_load_short_d16_hi v25, v5, s[44:47], 0 offen offset:128
    buffer_load_short_d16_hi v26, v5, s[48:51], 0 offen offset:128
    buffer_load_short_d16_hi v27, v5, s[52:55], 0 offen offset:128
    buffer_load_short_d16_hi v28, v5, s[32:35], 0 offen offset:256
    buffer_load_short_d16_hi v29, v5, s[36:39], 0 offen offset:256
    buffer_load_short_d16_hi v30, v5, s[40:43], 0 offen offset:256
    buffer_load_short_d16_hi v31, v5, s[44:47], 0 offen offset:256
    buffer_load_short_d16_hi v32, v5, s[48:51], 0 offen offset:256
    buffer_load_short_d16_hi v33, v5, s[52:55], 0 offen offset:256
    s_mul_i32 s24, s23, 3072
    s_add_u32 s64, s62, s24
    s_addc_u32 s65, s63, 0
    s_mov_b32 s66, 0xc00
    s_mov_b32 s67, 0x00020000
    s_lshl_b32 s24, s23, 12
    s_add_u32 s68, s60, s24
    s_addc_u32 s69, s61, 0
    s_mov_b32 s70, 0x1000
    s_mov_b32 s71, 0x00020000
    v_lshlrev_b32 v2, 4, v1
    buffer_load_dwordx4 v[160:163], v2, s[64:67], 0 offen offset:0
    buffer_load_dwordx4 v[160:163], v2, s[64:67], 0 offen offset:1024
    buffer_load_dwordx4 v[160:163], v2, s[64:67], 0 offen offset:2048
    buffer_load_dwordx4 v[160:163], v2, s[68:71], 0 offen offset:0
    buffer_load_dwordx4 v[160:163], v2, s[68:71], 0 offen offset:1024
    buffer_load_dwordx4 v[160:163], v2, s[68:71], 0 offen offset:2048
    buffer_load_dwordx4 v[160:163], v2, s[68:71], 0 offen offset:3072
    s_mul_i32 s24, s23, 3136
    s_add_u32 s24, s24, 17825792
    s_add_u32 s56, s94, s24
    s_addc_u32 s57, s95, 0
    s_mov_b32 s58, 0xc40
    s_mov_b32 s59, 0x00020000
    s_add_u32 s88, s94, 0x1400000
    s_addc_u32 s89, s95, 0
    s_mov_b32 s90, 0x40000
    s_mov_b32 s91, 0x00020000
    s_mul_i32 s24, s23, 4224
    s_add_u32 s24, s24, 9437184
    s_add_u32 s72, s94, s24
    s_addc_u32 s73, s95, 0
    s_mov_b32 s74, 0x40
    s_mov_b32 s75, 0x00020000
    v_mov_b32 v3, 0
    v_lshlrev_b32 v2, 2, v1
    buffer_store_dword v3, v2, s[72:75], 0 offen sc1
    v_lshlrev_b32 v6, 2, v1
    v_add_u32 v6, s26, v6
    v_and_b32 v2, 31, v1
    v_mul_u32_u24 v2, 272, v2
    v_lshrrev_b32 v3, 5, v1
    v_lshl_add_u32 v2, v3, 4, v2
    v_add_u32 v7, s26, v2
    v_mov_b32 v36, 0
    v_mov_b32 v37, 0
    v_mov_b32 v38, 0
    v_mov_b32 v39, 0
    v_mov_b32 v40, 0
    v_mov_b32 v41, 0
    v_mov_b32 v42, 0
    v_mov_b32 v43, 0
    v_mov_b32 v44, 0
    v_mov_b32 v45, 0
    v_mov_b32 v46, 0
    v_mov_b32 v47, 0
    v_mov_b32 v48, 0
    v_mov_b32 v49, 0
    v_mov_b32 v50, 0
    v_mov_b32 v51, 0
    s_waitcnt lgkmcnt(0)
    s_lshl_b32 s25, s28, 16
    s_and_b32 s28, s28, 0xffff0000
    s_lshl_b32 s30, s31, 16
    s_and_b32 s31, s31, 0xffff0000
    s_bitcmp1_b32 s23, 0
    s_cselect_b32 s25, s28, s25
    s_cselect_b32 s30, s31, s30
    s_mov_b32 s31, s30
    v_mov_b32 v2, s25
    s_mov_b32 s24, 0x3fb8aa3b
    v_mul_f32 v3, s24, v2
    v_fma_f32 v4, v2, s24, -v3
    v_fmac_f32 v4, 0x32a57060, v2
    v_exp_f32 v3, v3
    v_mul_f32 v4, 0x3f317218, v4
    v_fma_f32 v8, v3, v4, v3
    v_cvt_pk_bf16_f32 v8, v8, v8
    v_lshlrev_b32 v8, 16, v8
    v_lshlrev_b32 v5, 4, v1
    s_mov_b32 s27, 0
    s_waitcnt vmcnt(8)
a_kg2:
    v_mul_f32 v52, v8, v16
    v_mul_f32 v53, v8, v17
    v_pk_mul_f32 v[64:65], v[18:19], v[8:9] op_sel_hi:[1,0]
    v_mul_f32 v52, 0x3fb8aa3b, v52
    v_mul_f32 v53, 0x3e22f983, v53
    v_pk_mul_f32 v[66:67], v[20:21], v[64:65] op_sel:[0,0] op_sel_hi:[0,1]
    v_pk_fma_f32 v[68:69], v[20:21], v[64:65], v[66:67] op_sel:[1,1,0] op_sel_hi:[1,0,1] neg_lo:[0,1,0]
    v_pk_add_f32 v[16:17], v[22:23], 0 op_sel_hi:[1,0]
    v_pk_add_f32 v[18:19], v[24:25], 0 op_sel_hi:[1,0]
    v_pk_add_f32 v[20:21], v[26:27], 0 op_sel_hi:[1,0]
    v_pk_add_f32 v[22:23], v[28:29], 0 op_sel_hi:[1,0]
    v_pk_add_f32 v[24:25], v[30:31], 0 op_sel_hi:[1,0]
    v_pk_add_f32 v[26:27], v[32:33], 0 op_sel_hi:[1,0]
    v_exp_f32 v64, v52
    v_fract_f32 v65, v53
    v_cos_f32 v54, v65
    v_sin_f32 v55, v65
    s_nop 0
    v_pk_mul_f32 v[54:55], v[54:55], v[64:65] op_sel_hi:[1,0]
    v_mul_f32 v66, 0x41000000, v52
    v_mul_f32 v67, 0x41000000, v53
    v_exp_f32 v66, v66
    v_fract_f32 v67, v67
    v_cos_f32 v56, v67
    v_sin_f32 v57, v67
    s_nop 0
    v_pk_mul_f32 v[56:57], v[56:57], v[66:67] op_sel_hi:[1,0]
    v_mul_f32 v64, 0x41800000, v52
    v_mul_f32 v65, 0x41800000, v53
    v_exp_f32 v64, v64
    v_fract_f32 v65, v65
    v_cos_f32 v58, v65
    v_sin_f32 v59, v65
    s_nop 0
    v_pk_mul_f32 v[58:59], v[58:59], v[64:65] op_sel_hi:[1,0]
    v_mul_f32 v66, 0x43800000, v52
    v_mul_f32 v67, 0x43800000, v53
    v_exp_f32 v66, v66
    v_fract_f32 v67, v67
    v_cos_f32 v60, v67
    v_sin_f32 v61, v67
    s_nop 0
    v_pk_mul_f32 v[60:61], v[60:61], v[66:67] op_sel_hi:[1,0]
    v_mul_f32 v64, 0x44000000, v52
    v_mul_f32 v65, 0x44000000, v53
    v_exp_f32 v64, v64
    v_fract_f32 v65, v65
    v_cos_f32 v62, v65
    v_sin_f32 v63, v65
    s_nop 0
    v_pk_mul_f32 v[62:63], v[62:63], v[64:65] op_sel_hi:[1,0]
    v_cvt_pk_bf16_f32 v100, v68, -v69
    ds_write_b32 v6, v100 offset:0
    v_mov_b32 v103, 0x3f80
    ds_write_b32 v6, v103 offset:5712
    v_cvt_pk_bf16_f32 v101, v56, v57
    ds_write_b32 v6, v101 offset:5984
    v_cvt_pk_bf16_f32 v102, v58, v59
    ds_write_b32 v6, v102 offset:6256
    v_pk_mul_f32 v[64:65], v[56:57], v[58:59] op_sel:[0,0] op_sel_hi:[0,1]
    v_pk_fma_f32 v[96:97], v[56:57], v[58:59], v[64:65] op_sel:[1,1,0] op_sel_hi:[1,0,1] neg_lo:[0,1,0]
    v_cvt_pk_bf16_f32 v103, v96, v97
    ds_write_b32 v6, v103 offset:6528
    v_pk_mul_f32 v[104:105], v[68:69], v[54:55] op_sel:[0,0] op_sel_hi:[0,1]
    v_pk_fma_f32 v[70:71], v[68:69], v[54:55], v[104:105] op_sel:[1,1,0] op_sel_hi:[1,0,1] neg_lo:[0,1,0]
    v_cvt_pk_bf16_f32 v100, v70, -v71
    ds_write_b32 v6, v100 offset:272
    v_pk_mul_f32 v[66:67], v[58:59], v[58:59] op_sel:[0,0] op_sel_hi:[0,1]
    v_pk_fma_f32 v[98:99], v[58:59], v[58:59], v[66:67] op_sel:[1,1,0] op_sel_hi:[1,0,1] neg_lo:[0,1,0]
    v_cvt_pk_bf16_f32 v101, v98, v99
    ds_write_b32 v6, v101 offset:6800
    v_pk_mul_f32 v[104:105], v[70:71], v[54:55] op_sel:[0,0] op_sel_hi:[0,1]
    v_pk_fma_f32 v[72:73], v[70:71], v[54:55], v[104:105] op_sel:[1,1,0] op_sel_hi:[1,0,1] neg_lo:[0,1,0]
    v_cvt_pk_bf16_f32 v102, v72, -v73
    ds_write_b32 v6, v102 offset:544
    v_pk_mul_f32 v[64:65], v[96:97], v[58:59] op_sel:[0,0] op_sel_hi:[0,1]
    v_pk_fma_f32 v[96:97], v[96:97], v[58:59], v[64:65] op_sel:[1,1,0] op_sel_hi:[1,0,1] neg_lo:[0,1,0]
    v_cvt_pk_bf16_f32 v103, v96, v97
    ds_write_b32 v6, v103 offset:7072
    v_pk_mul_f32 v[104:105], v[72:73], v[54:55] op_sel:[0,0] op_sel_hi:[0,1]
    v_pk_fma_f32 v[74:75], v[72:73], v[54:55], v[104:105] op_sel:[1,1,0] op_sel_hi:[1,0,1] neg_lo:[0,1,0]
    v_cvt_pk_bf16_f32 v100, v74, -v75
    ds_write_b32 v6, v100 offset:816
    v_pk_mul_f32 v[66:67], v[98:99], v[58:59] op_sel:[0,0] op_sel_hi:[0,1]
    v_pk_fma_f32 v[98:99], v[98:99], v[58:59], v[66:67] op_sel:[1,1,0] op_sel_hi:[1,0,1] neg_lo:[0,1,0]
    v_cvt_pk_bf16_f32 v101, v98, v99
    ds_write_b32 v6, v101 offset:7344
    v_pk_mul_f32 v[104:105], v[74:75], v[54:55] op_sel:[0,0] op_sel_hi:[0,1]
    v_pk_fma_f32 v[76:77], v[74:75], v[54:55], v[104:105] op_sel:[1,1,0] op_sel_hi:[1,0,1] neg_lo:[0,1,0]
    v_cvt_pk_bf16_f32 v102, v76, -v77
    ds_write_b32 v6, v102 offset:1088
    v_pk_mul_f32 v[64:65], v[96:97], v[58:59] op_sel:[0,0] op_sel_hi:[0,1]
    v_pk_fma_f32 v[96:97], v[96:97], v[58:59], v[64:65] op_sel:[1,1,0] op_sel_hi:[1,0,1] neg_lo:[0,1,0]
    v_cvt_pk_bf16_f32 v103, v96, v97
    ds_write_b32 v6, v103 offset:7616
    v_pk_mul_f32 v[104:105], v[76:77], v[54:55] op_sel:[0,0] op_sel_hi:[0,1]
    v_pk_fma_f32 v[78:79], v[76:77], v[54:55], v[104:105] op_sel:[1,1,0] op_sel_hi:[1,0,1] neg_lo:[0,1,0]
    v_cvt_pk_bf16_f32 v100, v78, -v79
    ds_write_b32 v6, v100 offset:1360
    v_pk_mul_f32 v[66:67], v[98:99], v[58:59] op_sel:[0,0] op_sel_hi:[0,1]
    v_pk_fma_f32 v[98:99], v[98:99], v[58:59], v[66:67] op_sel:[1,1,0] op_sel_hi:[1,0,1] neg_lo:[0,1,0]
    v_cvt_pk_bf16_f32 v101, v98, v99
    ds_write_b32 v6, v101 offset:7888
    v_pk_mul_f32 v[104:105], v[78:79], v[54:55] op_sel:[0,0] op_sel_hi:[0,1]
    v_pk_fma_f32 v[80:81], v[78:79], v[54:55], v[104:105] op_sel:[1,1,0] op_sel_hi:[1,0,1] neg_lo:[0,1,0]
    v_cvt_pk_bf16_f32 v102, v80, -v81
    ds_write_b32 v6, v102 offset:1632
    v_pk_mul_f32 v[64:65], v[96:97], v[58:59] op_sel:[0,0] op_sel_hi:[0,1]
    v_pk_fma_f32 v[96:97], v[96:97], v[58:59], v[64:65] op_sel:[1,1,0] op_sel_hi:[1,0,1] neg_lo:[0,1,0]
    v_cvt_pk_bf16_f32 v103, v96, v97
    ds_write_b32 v6, v103 offset:8160
    v_pk_mul_f32 v[104:105], v[80:81], v[54:55] op_sel:[0,0] op_sel_hi:[0,1]
    v_pk_fma_f32 v[82:83], v[80:81], v[54:55], v[104:105] op_sel:[1,1,0] op_sel_hi:[1,0,1] neg_lo:[0,1,0]
    v_cvt_pk_bf16_f32 v100, v82, -v83
    ds_write_b32 v6, v100 offset:1904
    v_pk_mul_f32 v[66:67], v[98:99], v[58:59] op_sel:[0,0] op_sel_hi:[0,1]
    v_pk_fma_f32 v[98:99], v[98:99], v[58:59], v[66:67] op_sel:[1,1,0] op_sel_hi:[1,0,1] neg_lo:[0,1,0]
    v_cvt_pk_bf16_f32 v101, v98, v99
    ds_write_b32 v6, v101 offset:8432
    v_pk_mul_f32 v[104:105], v[82:83], v[54:55] op_sel:[0,0] op_sel_hi:[0,1]
    v_pk_fma_f32 v[84:85], v[82:83], v[54:55], v[104:105] op_sel:[1,1,0] op_sel_hi:[1,0,1] neg_lo:[0,1,0]
    v_cvt_pk_bf16_f32 v102, v84, -v85
    ds_write_b32 v6, v102 offset:5440
    v_pk_mul_f32 v[64:65], v[96:97], v[58:59] op_sel:[0,0] op_sel_hi:[0,1]
    v_pk_fma_f32 v[96:97], v[96:97], v[58:59], v[64:65] op_sel:[1,1,0] op_sel_hi:[1,0,1] neg_lo:[0,1,0]
    v_cvt_pk_bf16_f32 v103, v96, v97
    ds_write_b32 v6, v103 offset:8704
    v_pk_mul_f32 v[104:105], v[72:73], v[60:61] op_sel:[0,0] op_sel_hi:[0,1]
    v_pk_fma_f32 v[94:95], v[72:73], v[60:61], v[104:105] op_sel:[1,1,0] op_sel_hi:[1,0,1] neg_lo:[0,1,0]
    v_cvt_pk_bf16_f32 v100, v94, -v95
    ds_write_b32 v6, v100 offset:2176
    v_pk_mul_f32 v[66:67], v[98:99], v[58:59] op_sel:[0,0] op_sel_hi:[0,1]
    v_pk_fma_f32 v[98:99], v[98:99], v[58:59], v[66:67] op_sel:[1,1,0] op_sel_hi:[1,0,1] neg_lo:[0,1,0]
    v_cvt_pk_bf16_f32 v101, v98, v99
    ds_write_b32 v6, v101 offset:8976
    v_pk_mul_f32 v[104:105], v[76:77], v[60:61] op_sel:[0,0] op_sel_hi:[0,1]
    v_pk_fma_f32 v[94:95], v[76:77], v[60:61], v[104:105] op_sel:[1,1,0] op_sel_hi:[1,0,1] neg_lo:[0,1,0]
    v_cvt_pk_bf16_f32 v102, v94, -v95
    ds_write_b32 v6, v102 offset:2720
    v_pk_mul_f32 v[64:65], v[96:97], v[58:59] op_sel:[0,0] op_sel_hi:[0,1]
    v_pk_fma_f32 v[96:97], v[96:97], v[58:59], v[64:65] op_sel:[1,1,0] op_sel_hi:[1,0,1] neg_lo:[0,1,0]
    v_cvt_pk_bf16_f32 v103, v96, v97
    ds_write_b32 v6, v103 offset:9248
    v_pk_mul_f32 v[104:105], v[80:81], v[60:61] op_sel:[0,0] op_sel_hi:[0,1]
    v_pk_fma_f32 v[94:95], v[80:81], v[60:61], v[104:105] op_sel:[1,1,0] op_sel_hi:[1,0,1] neg_lo:[0,1,0]
    v_cvt_pk_bf16_f32 v100, v94, -v95
    ds_write_b32 v6, v100 offset:2448
    v_pk_mul_f32 v[66:67], v[98:99], v[58:59] op_sel:[0,0] op_sel_hi:[0,1]
    v_pk_fma_f32 v[98:99], v[98:99], v[58:59], v[66:67] op_sel:[1,1,0] op_sel_hi:[1,0,1] neg_lo:[0,1,0]
    v_cvt_pk_bf16_f32 v101, v98, v99
    ds_write_b32 v6, v101 offset:9520
    v_pk_mul_f32 v[104:105], v[84:85], v[60:61] op_sel:[0,0] op_sel_hi:[0,1]
    v_pk_fma_f32 v[94:95], v[84:85], v[60:61], v[104:105] op_sel:[1,1,0] op_sel_hi:[1,0,1] neg_lo:[0,1,0]
    v_cvt_pk_bf16_f32 v102, v94, -v95
    ds_write_b32 v6, v102 offset:2992
    v_pk_mul_f32 v[64:65], v[96:97], v[58:59] op_sel:[0,0] op_sel_hi:[0,1]
    v_pk_fma_f32 v[96:97], v[96:97], v[58:59], v[64:65] op_sel:[1,1,0] op_sel_hi:[1,0,1] neg_lo:[0,1,0]
    v_cvt_pk_bf16_f32 v103, v96, v97
    ds_write_b32 v6, v103 offset:9792
    v_pk_mul_f32 v[104:105], v[76:77], v[62:63] op_sel:[0,0] op_sel_hi:[0,1]
    v_pk_fma_f32 v[86:87], v[76:77], v[62:63], v[104:105] op_sel:[1,1,0] op_sel_hi:[1,0,1] neg_lo:[0,1,0]
    v_cvt_pk_bf16_f32 v100, v86, -v87
    ds_write_b32 v6, v100 offset:3264
    v_pk_mul_f32 v[66:67], v[98:99], v[58:59] op_sel:[0,0] op_sel_hi:[0,1]
    v_pk_fma_f32 v[98:99], v[98:99], v[58:59], v[66:67] op_sel:[1,1,0] op_sel_hi:[1,0,1] neg_lo:[0,1,0]
    v_cvt_pk_bf16_f32 v101, v98, v99
    ds_write_b32 v6, v101 offset:10064
    v_pk_mul_f32 v[104:105], v[84:85], v[62:63] op_sel:[0,0] op_sel_hi:[0,1]
    v_pk_fma_f32 v[88:89], v[84:85], v[62:63], v[104:105] op_sel:[1,1,0] op_sel_hi:[1,0,1] neg_lo:[0,1,0]
    v_cvt_pk_bf16_f32 v102, v88, -v89
    ds_write_b32 v6, v102 offset:3536
    v_pk_mul_f32 v[64:65], v[96:97], v[58:59] op_sel:[0,0] op_sel_hi:[0,1]
    v_pk_fma_f32 v[96:97], v[96:97], v[58:59], v[64:65] op_sel:[1,1,0] op_sel_hi:[1,0,1] neg_lo:[0,1,0]
    v_cvt_pk_bf16_f32 v103, v96, v97
    ds_write_b32 v6, v103 offset:10336
    v_pk_mul_f32 v[104:105], v[86:87], v[60:61] op_sel:[0,0] op_sel_hi:[0,1]
    v_pk_fma_f32 v[94:95], v[86:87], v[60:61], v[104:105] op_sel:[1,1,0] op_sel_hi:[1,0,1] neg_lo:[0,1,0]
    v_cvt_pk_bf16_f32 v100, v94, -v95
    ds_write_b32 v6, v100 offset:3808
    v_pk_mul_f32 v[66:67], v[98:99], v[58:59] op_sel:[0,0] op_sel_hi:[0,1]
    v_pk_fma_f32 v[98:99], v[98:99], v[58:59], v[66:67] op_sel:[1,1,0] op_sel_hi:[1,0,1] neg_lo:[0,1,0]
    v_cvt_pk_bf16_f32 v101, v98, v99
    ds_write_b32 v6, v101 offset:10608
    v_pk_mul_f32 v[104:105], v[88:89], v[60:61] op_sel:[0,0] op_sel_hi:[0,1]
    v_pk_fma_f32 v[94:95], v[88:89], v[60:61], v[104:105] op_sel:[1,1,0] op_sel_hi:[1,0,1] neg_lo:[0,1,0]
    v_cvt_pk_bf16_f32 v102, v94, -v95
    ds_write_b32 v6, v102 offset:4080
    v_pk_mul_f32 v[64:65], v[96:97], v[58:59] op_sel:[0,0] op_sel_hi:[0,1]
    v_pk_fma_f32 v[96:97], v[96:97], v[58:59], v[64:65] op_sel:[1,1,0] op_sel_hi:[1,0,1] neg_lo:[0,1,0]
    v_cvt_pk_bf16_f32 v103, v96, v97
    ds_write_b32 v6, v103 offset:10880
    v_pk_mul_f32 v[104:105], v[88:89], v[62:63] op_sel:[0,0] op_sel_hi:[0,1]
    v_pk_fma_f32 v[90:91], v[88:89], v[62:63], v[104:105] op_sel:[1,1,0] op_sel_hi:[1,0,1] neg_lo:[0,1,0]
    v_cvt_pk_bf16_f32 v100, v90, -v91
    ds_write_b32 v6, v100 offset:4352
    v_pk_mul_f32 v[66:67], v[98:99], v[58:59] op_sel:[0,0] op_sel_hi:[0,1]
    v_pk_fma_f32 v[98:99], v[98:99], v[58:59], v[66:67] op_sel:[1,1,0] op_sel_hi:[1,0,1] neg_lo:[0,1,0]
    v_cvt_pk_bf16_f32 v101, v98, v99
    ds_write_b32 v6, v101 offset:11152
    v_pk_mul_f32 v[104:105], v[90:91], v[60:61] op_sel:[0,0] op_sel_hi:[0,1]
    v_pk_fma_f32 v[94:95], v[90:91], v[60:61], v[104:105] op_sel:[1,1,0] op_sel_hi:[1,0,1] neg_lo:[0,1,0]
    v_cvt_pk_bf16_f32 v102, v94, -v95
    ds_write_b32 v6, v102 offset:4624
    v_pk_mul_f32 v[64:65], v[96:97], v[58:59] op_sel:[0,0] op_sel_hi:[0,1]
    v_pk_fma_f32 v[96:97], v[96:97], v[58:59], v[64:65] op_sel:[1,1,0] op_sel_hi:[1,0,1] neg_lo:[0,1,0]
    v_cvt_pk_bf16_f32 v103, v96, v97
    ds_write_b32 v6, v103 offset:11424
    v_pk_mul_f32 v[104:105], v[90:91], v[62:63] op_sel:[0,0] op_sel_hi:[0,1]
    v_pk_fma_f32 v[92:93], v[90:91], v[62:63], v[104:105] op_sel:[1,1,0] op_sel_hi:[1,0,1] neg_lo:[0,1,0]
    v_cvt_pk_bf16_f32 v100, v92, -v93
    ds_write_b32 v6, v100 offset:4896
    v_pk_mul_f32 v[66:67], v[98:99], v[58:59] op_sel:[0,0] op_sel_hi:[0,1]
    v_pk_fma_f32 v[98:99], v[98:99], v[58:59], v[66:67] op_sel:[1,1,0] op_sel_hi:[1,0,1] neg_lo:[0,1,0]
    v_cvt_pk_bf16_f32 v101, v98, v99
    ds_write_b32 v6, v101 offset:11696
    v_pk_mul_f32 v[104:105], v[92:93], v[60:61] op_sel:[0,0] op_sel_hi:[0,1]
    v_pk_fma_f32 v[94:95], v[92:93], v[60:61], v[104:105] op_sel:[1,1,0] op_sel_hi:[1,0,1] neg_lo:[0,1,0]
    v_cvt_pk_bf16_f32 v102, v94, -v95
    ds_write_b32 v6, v102 offset:5168
    v_pk_mul_f32 v[64:65], v[96:97], v[58:59] op_sel:[0,0] op_sel_hi:[0,1]
    v_pk_fma_f32 v[96:97], v[96:97], v[58:59], v[64:65] op_sel:[1,1,0] op_sel_hi:[1,0,1] neg_lo:[0,1,0]
    v_cvt_pk_bf16_f32 v103, v96, v97
    ds_write_b32 v6, v103 offset:11968
    v_pk_mul_f32 v[66:67], v[98:99], v[58:59] op_sel:[0,0] op_sel_hi:[0,1]
    v_pk_fma_f32 v[98:99], v[98:99], v[58:59], v[66:67] op_sel:[1,1,0] op_sel_hi:[1,0,1] neg_lo:[0,1,0]
    v_cvt_pk_bf16_f32 v100, v98, v99
    ds_write_b32 v6, v100 offset:12240
    v_pk_mul_f32 v[64:65], v[96:97], v[58:59] op_sel:[0,0] op_sel_hi:[0,1]
    v_pk_fma_f32 v[96:97], v[96:97], v[58:59], v[64:65] op_sel:[1,1,0] op_sel_hi:[1,0,1] neg_lo:[0,1,0]
    v_cvt_pk_bf16_f32 v101, v96, v97
    ds_write_b32 v6, v101 offset:12512
    v_pk_mul_f32 v[66:67], v[98:99], v[58:59] op_sel:[0,0] op_sel_hi:[0,1]
    v_pk_fma_f32 v[98:99], v[98:99], v[58:59], v[66:67] op_sel:[1,1,0] op_sel_hi:[1,0,1] neg_lo:[0,1,0]
    v_cvt_pk_bf16_f32 v102, v98, v99
    ds_write_b32 v6, v102 offset:12784
    v_pk_mul_f32 v[64:65], v[96:97], v[58:59] op_sel:[0,0] op_sel_hi:[0,1]
    v_pk_fma_f32 v[96:97], v[96:97], v[58:59], v[64:65] op_sel:[1,1,0] op_sel_hi:[1,0,1] neg_lo:[0,1,0]
    v_cvt_pk_bf16_f32 v103, v96, v97
    ds_write_b32 v6, v103 offset:13056
    v_pk_mul_f32 v[66:67], v[98:99], v[58:59] op_sel:[0,0] op_sel_hi:[0,1]
    v_pk_fma_f32 v[98:99], v[98:99], v[58:59], v[66:67] op_sel:[1,1,0] op_sel_hi:[1,0,1] neg_lo:[0,1,0]
    v_cvt_pk_bf16_f32 v100, v98, v99
    ds_write_b32 v6, v100 offset:13328
    v_pk_mul_f32 v[64:65], v[96:97], v[58:59] op_sel:[0,0] op_sel_hi:[0,1]
    v_pk_fma_f32 v[96:97], v[96:97], v[58:59], v[64:65] op_sel:[1,1,0] op_sel_hi:[1,0,1] neg_lo:[0,1,0]
    v_cvt_pk_bf16_f32 v101, v96, v97
    ds_write_b32 v6, v101 offset:13600
    v_pk_mul_f32 v[66:67], v[98:99], v[58:59] op_sel:[0,0] op_sel_hi:[0,1]
    v_pk_fma_f32 v[98:99], v[98:99], v[58:59], v[66:67] op_sel:[1,1,0] op_sel_hi:[1,0,1] neg_lo:[0,1,0]
    v_cvt_pk_bf16_f32 v102, v98, v99
    ds_write_b32 v6, v102 offset:13872
    v_pk_mul_f32 v[64:65], v[96:97], v[58:59] op_sel:[0,0] op_sel_hi:[0,1]
    v_pk_fma_f32 v[96:97], v[96:97], v[58:59], v[64:65] op_sel:[1,1,0] op_sel_hi:[1,0,1] neg_lo:[0,1,0]
    v_cvt_pk_bf16_f32 v103, v96, v97
    ds_write_b32 v6, v103 offset:14144
    s_waitcnt lgkmcnt(0)
    ds_read_b128 v[104:107], v7 offset:0
    ds_read_b128 v[120:123], v7 offset:5712
    ds_read_b128 v[108:111], v7 offset:32
    ds_read_b128 v[124:127], v7 offset:5744
    ds_read_b128 v[112:115], v7 offset:64
    ds_read_b128 v[128:131], v7 offset:5776
    s_waitcnt lgkmcnt(4)
    v_mfma_f32_32x32x16_bf16 v[36:51], v[104:107], v[120:123], v[36:51]
    ds_read_b128 v[116:119], v7 offset:96
    ds_read_b128 v[132:135], v7 offset:5808
    s_waitcnt lgkmcnt(4)
    v_mfma_f32_32x32x16_bf16 v[36:51], v[108:111], v[124:127], v[36:51]
    ds_read_b128 v[104:107], v7 offset:128
    ds_read_b128 v[120:123], v7 offset:5840
    s_waitcnt lgkmcnt(4)
    v_mfma_f32_32x32x16_bf16 v[36:51], v[112:115], v[128:131], v[36:51]
    ds_read_b128 v[108:111], v7 offset:160
    ds_read_b128 v[124:127], v7 offset:5872
    s_waitcnt lgkmcnt(4)
    v_mfma_f32_32x32x16_bf16 v[36:51], v[116:119], v[132:135], v[36:51]
    ds_read_b128 v[112:115], v7 offset:192
    ds_read_b128 v[128:131], v7 offset:5904
    s_waitcnt lgkmcnt(4)
    v_mfma_f32_32x32x16_bf16 v[36:51], v[104:107], v[120:123], v[36:51]
    ds_read_b128 v[116:119], v7 offset:224
    ds_read_b128 v[132:135], v7 offset:5936
    s_waitcnt lgkmcnt(4)
    v_mfma_f32_32x32x16_bf16 v[36:51], v[108:111], v[124:127], v[36:51]
    s_waitcnt lgkmcnt(2)
    v_mfma_f32_32x32x16_bf16 v[36:51], v[112:115], v[128:131], v[36:51]
    s_waitcnt lgkmcnt(0)
    v_mfma_f32_32x32x16_bf16 v[36:51], v[116:119], v[132:135], v[36:51]
    s_add_u32 s27, s27, 1
    s_cmp_lt_u32 s27, 3
    s_cbranch_scc1 a_kg2
    v_mov_b32 v52, 0
    v_mov_b32 v53, 0
    v_mov_b32 v54, 0
    v_mov_b32 v55, 0
    v_add_u32 v7, s26, v5
    ds_write_b128 v7, v[52:55] offset:0
    ds_write_b128 v7, v[52:55] offset:1024
    ds_write_b128 v7, v[52:55] offset:2048
    v_and_b32 v2, 31, v1
    v_lshrrev_b32 v3, 5, v1
    v_lshlrev_b32 v56, 4, v2
    v_lshl_add_u32 v56, v3, 3, v56
    v_sub_u32 v56, s26, v56
    v_add_u32 v56, 568, v56
    v_lshlrev_b32 v57, 2, v2
    v_sub_u32 v57, s26, v57
    v_add_u32 v57, 252, v57
    v_lshlrev_b32 v58, 1, v2
    v_sub_u32 v58, s26, v58
    v_add_u32 v58, 126, v58
    v_lshrrev_b32 v59, 1, v2
    v_lshlrev_b32 v59, 1, v59
    v_sub_u32 v59, s26, v59
    v_and_b32 v3, 1, v2
    v_mul_u32_u24 v3, 160, v3
    v_add3_u32 v59, v59, v3, 30
    v_cvt_pk_bf16_f32 v60, v39, v38
    v_cvt_pk_bf16_f32 v61, v37, v36
    ds_write_b64 v56, v[60:61]
    v_cvt_pk_bf16_f32 v62, v41, v40
    v_cvt_pk_bf16_f32 v63, v43, v42
    v_cvt_pk_bf16_f32 v64, v44, v45
    v_cvt_pk_bf16_f32 v65, v46, v47
    v_cvt_pk_bf16_f32 v66, v44, v44
    s_mov_b32 exec_hi, 0
    ds_write_b32 v57, v62 offset:608
    ds_write_b32 v57, v63 offset:992
    ds_write_b16 v59, v64 offset:1984
    ds_write_b16_d16_hi v59, v64 offset:1952
    ds_write_b16 v59, v65 offset:1920
    ds_write_b16_d16_hi v59, v65 offset:1888
    s_mov_b32 exec_lo, 0x80000000
    ds_write_b16 v57, v63 offset:606
    s_mov_b32 exec_lo, 0
    s_mov_b32 exec_hi, -1
    ds_write_b16_d16_hi v58, v62 offset:1440
    ds_write_b16 v58, v62 offset:1696
    ds_write_b16_d16_hi v58, v63 offset:1376
    ds_write_b16 v58, v63 offset:1632
    s_mov_b32 exec_hi, 0x80000000
    v_mov_b32 v56, s26
    ds_write_b32 v56, v66 offset:60
    s_mov_b64 exec, -1
    v_add_u32 v57, 1888, v6
    ds_read2_b32 v[60:61], v6 offset0:0 offset1:1
    ds_read2_b32 v[62:63], v6 offset0:64 offset1:65
    ds_read2_b32 v[64:65], v6 offset0:128 offset1:129
    ds_read2_b32 v[66:67], v57 offset0:0 offset1:1
    ds_read2_b32 v[68:69], v57 offset0:64 offset1:65
    s_waitcnt lgkmcnt(4)
    v_alignbit_b32 v60, v61, v60, 16
    ds_write_b32 v6, v60 offset:2208
    s_waitcnt lgkmcnt(4)
    v_alignbit_b32 v62, v63, v62, 16
    ds_write_b32 v6, v62 offset:2464
    s_waitcnt lgkmcnt(4)
    v_alignbit_b32 v64, v65, v64, 16
    ds_write_b32 v6, v64 offset:2720
    s_waitcnt lgkmcnt(4)
    v_alignbit_b32 v66, v67, v66, 16
    ds_write_b32 v57, v66 offset:928
    s_waitcnt lgkmcnt(4)
    v_alignbit_b32 v68, v69, v68, 16
    ds_write_b32 v57, v68 offset:1184
    ds_read_b128 v[72:75], v7 offset:0
    ds_read_b128 v[76:79], v7 offset:1024
    ds_read_b128 v[80:83], v7 offset:2048
    ds_read_b128 v[84:87], v7 offset:3072
    s_waitcnt lgkmcnt(3)
    buffer_store_dwordx4 v[72:75], v5, s[56:59], 0 offen offset:0 sc1
    s_waitcnt lgkmcnt(2)
    buffer_store_dwordx4 v[76:79], v5, s[56:59], 0 offen offset:1024 sc1
    s_waitcnt lgkmcnt(1)
    buffer_store_dwordx4 v[80:83], v5, s[56:59], 0 offen offset:2048 sc1
    s_waitcnt lgkmcnt(0)
    buffer_store_dwordx4 v[84:87], v5, s[56:59], 0 offen offset:3072 sc1
    s_barrier
    s_mul_i32 s26, s96, 14944
    s_lshl_b32 s24, s23, 12
    s_add_u32 s24, s24, 12582912
    s_add_u32 s36, s94, s24
    s_addc_u32 s37, s95, 0
    s_mov_b32 s38, 0x1000
    s_mov_b32 s39, 0x00020000
    s_mul_i32 s24, s23, 4224
    s_add_u32 s24, s24, 9437184
    s_add_u32 s40, s94, s24
    s_addc_u32 s41, s95, 0
    s_mov_b32 s42, 0x1080
    s_mov_b32 s43, 0x00020000
    v_lshlrev_b32 v7, 4, v1
    v_and_b32 v2, 15, v1
    v_lshrrev_b32 v3, 4, v1
    v_add_u32 v21, s26, v7
    v_lshlrev_b32 v4, 4, v3
    v_lshl_add_u32 v5, v2, 1, v4
    v_and_b32 v19, 1, v2
    v_mul_u32_u24 v20, 2206, v19
    v_add_u32 v5, v5, v20
    v_sub_u32 v8, 2284, v5
    v_lshlrev_b32 v5, 3, v2
    v_sub_u32 v9, v4, v5
    v_add_u32 v9, 728, v9
    v_lshlrev_b32 v5, 2, v2
    v_sub_u32 v10, v4, v5
    v_add_u32 v10, 1436, v10
    v_and_b32 v5, 1, v3
    v_lshrrev_b32 v6, 1, v3
    v_mul_u32_u24 v11, 160, v6
    v_lshl_add_u32 v11, v5, 4, v11
    v_lshlrev_b32 v17, 1, v2
    v_sub_u32 v11, v11, v17
    v_add_u32 v11, 2844, v11
    v_mul_u32_u24 v20, 926, v19
    v_sub_u32 v11, v11, v20
    v_lshlrev_b32 v12, 5, v2
    v_sub_u32 v12, v12, v4
    v_add_u32 v12, s26, v12
    v_lshrrev_b32 v17, 2, v2
    v_and_b32 v18, 3, v2
    v_lshlrev_b32 v18, 3, v18
    v_add_u32 v18, s26, v18
    v_lshl_add_u32 v13, v3, 3, v17
    v_lshl_add_u32 v14, v13, 4, v18
    v_lshl_add_u32 v13, v13, 3, v18
    v_lshl_add_u32 v15, v5, 3, v17
    v_lshl_add_u32 v15, v15, 5, v18
    v_mul_u32_u24 v6, 2064, v6
    v_add_u32 v15, v6, v15
    v_lshl_add_u32 v16, v3, 2, v17
    v_lshl_add_u32 v16, v16, 5, v18
    v_lshlrev_b32 v20, 5, v2
    v_lshl_add_u32 v20, v3, 3, v20
    v_add_u32 v19, s26, v20
    v_mov_b32 v58, 0
    v_mov_b32 v59, 0
    v_mov_b32 v60, 0
    v_mov_b32 v61, 0
    v_mul_u32_u24 v4, 2080, v1
    v_add_u32 v4, -32, v4
    v_lshlrev_b32 v6, 4, v1
    v_cmp_gt_u32 vcc, 2, v1
    v_mov_b32 v5, 10848
    v_cmp_eq_u32 s[24:25], 5, v1
    v_cndmask_b32 v4, v4, v6, vcc
    s_nop 0
    v_cndmask_b32 v4, v4, v5, s[24:25]
    v_add_u32 v4, s26, v4
    s_mov_b64 exec, 0x3f
    ds_write_b128 v4, v[58:61]
    s_mov_b64 exec, -1
    s_waitcnt vmcnt(0)
    v_mov_b32 v4, 1696
    buffer_load_ushort v24, v4, s[56:59], 0 offen sc1
    buffer_load_dwordx4 v[144:147], v10, s[56:59], 0 offen offset:0 sc1
    buffer_load_dwordx4 v[148:151], v10, s[56:59], 0 offen offset:64 sc1
    buffer_load_dwordx4 v[152:155], v10, s[56:59], 0 offen offset:128 sc1
    buffer_load_dwordx4 v[156:159], v10, s[56:59], 0 offen offset:256 sc1
    buffer_load_dwordx4 v[160:163], v10, s[56:59], 0 offen offset:320 sc1
    buffer_load_dwordx4 v[164:167], v10, s[56:59], 0 offen offset:384 sc1
    v_mov_b32 v66, 163836
    ds_read_b32 v66, v66
    s_waitcnt lgkmcnt(0)
    v_readfirstlane_b32 s97, v66
    s_nop 1
    s_lshl_b32 s24, s2, 10
    s_add_u32 s24, s24, 384
    v_lshlrev_b32 v66, 2, v1
    v_cmp_gt_u32 vcc, 64, v1
    s_mov_b32 s76, 100000
    s_mov_b64 exec, vcc
a_poll3:
    s_sub_u32 s76, s76, 1
    s_cbranch_scc1 a_polld4
    buffer_load_dword v67, v66, s[88:91], s24 offen sc1
    s_waitcnt vmcnt(0)
    v_cmp_ne_u32 vcc, s97, v67
    s_nop 1
    s_cmp_eq_u64 vcc, 0
    s_cbranch_scc1 a_polld4
    s_sleep 1
    s_branch a_poll3
a_polld4:
    s_mov_b64 exec, -1
    v_mov_b32 v66, 163836
    ds_read_b32 v66, v66
    s_waitcnt lgkmcnt(0)
    v_readfirstlane_b32 s97, v66
    s_nop 1
    s_lshl_b32 s24, s2, 10
    s_add_u32 s24, s24, 768
    v_lshlrev_b32 v66, 2, v1
    v_cmp_gt_u32 vcc, 64, v1
    s_mov_b32 s76, 100000
    s_mov_b64 exec, vcc
a_poll5:
    s_sub_u32 s76, s76, 1
    s_cbranch_scc1 a_polld6
    buffer_load_dword v67, v66, s[88:91], s24 offen sc1
    s_waitcnt vmcnt(0)
    v_cmp_ne_u32 vcc, s97, v67
    s_nop 1
    s_cmp_eq_u64 vcc, 0
    s_cbranch_scc1 a_polld6
    s_sleep 1
    s_branch a_poll5
a_polld6:
    s_mov_b64 exec, -1
    v_mov_b32 v66, 163836
    ds_read_b32 v66, v66
    s_waitcnt lgkmcnt(0)
    v_readfirstlane_b32 s97, v66
    s_nop 1
    s_lshl_b32 s24, s2, 10
    s_add_u32 s24, s24, 640
    v_lshlrev_b32 v66, 2, v1
    v_cmp_gt_u32 vcc, 16, v1
    s_mov_b32 s76, 100000
    s_mov_b64 exec, vcc
a_poll7:
    s_sub_u32 s76, s76, 1
    s_cbranch_scc1 a_polld8
    buffer_load_dword v67, v66, s[88:91], s24 offen sc1
    s_waitcnt vmcnt(0)
    v_cmp_ne_u32 vcc, s97, v67
    s_nop 1
    s_cmp_eq_u64 vcc, 0
    s_cbranch_scc1 a_polld8
    s_sleep 1
    s_branch a_poll7
a_polld8:
    s_mov_b64 exec, -1
    buffer_load_dwordx4 v[26:29], v7, s[40:43], 0 offen offset:40 sc1
    buffer_load_dwordx4 v[30:33], v7, s[40:43], 0 offen offset:56 sc1
    buffer_load_dwordx4 v[34:37], v7, s[40:43], 0 offen offset:1064 sc1
    buffer_load_dwordx4 v[38:41], v7, s[40:43], 0 offen offset:1080 sc1
    buffer_load_dwordx4 v[42:45], v7, s[40:43], 0 offen offset:2088 sc1
    buffer_load_dwordx4 v[46:49], v7, s[40:43], 0 offen offset:2104 sc1
    buffer_load_dwordx4 v[50:53], v7, s[40:43], 0 offen offset:3112 sc1
    buffer_load_dwordx4 v[54:57], v7, s[40:43], 0 offen offset:3128 sc1
    s_mov_b32 s24, 64
    s_add_u32 m0, s26, 32
    s_nop 0
    buffer_load_dwordx4 v7, s[40:43], s24 offen offset:0 sc1 lds
    buffer_load_dwordx4 v7, s[40:43], s24 offen offset:1024 sc1 lds
    buffer_load_dwordx4 v7, s[40:43], s24 offen offset:2048 sc1 lds
    buffer_load_dwordx4 v7, s[40:43], s24 offen offset:3072 sc1 lds
    s_mov_b32 s24, 36
    s_add_u32 m0, s26, 10848
    s_nop 0
    buffer_load_dwordx4 v7, s[40:43], s24 offen offset:0 sc1 lds
    buffer_load_dwordx4 v7, s[40:43], s24 offen offset:1024 sc1 lds
    buffer_load_dwordx4 v7, s[40:43], s24 offen offset:2048 sc1 lds
    buffer_load_dwordx4 v7, s[40:43], s24 offen offset:3072 sc1 lds
    s_waitcnt vmcnt(12)
    v_lshlrev_b32 v58, 16, v26
    v_and_b32 v60, 0xffff0000, v26
    v_lshlrev_b32 v62, 16, v27
    v_and_b32 v64, 0xffff0000, v27
    v_lshlrev_b32 v66, 16, v28
    v_and_b32 v68, 0xffff0000, v28
    v_lshlrev_b32 v70, 16, v29
    v_and_b32 v72, 0xffff0000, v29
    v_lshlrev_b32 v74, 16, v30
    v_and_b32 v76, 0xffff0000, v30
    v_lshlrev_b32 v78, 16, v31
    v_and_b32 v80, 0xffff0000, v31
    v_lshlrev_b32 v82, 16, v32
    v_and_b32 v84, 0xffff0000, v32
    v_lshlrev_b32 v86, 16, v33
    v_and_b32 v88, 0xffff0000, v33
    v_lshlrev_b32 v59, 16, v34
    v_and_b32 v61, 0xffff0000, v34
    v_lshlrev_b32 v63, 16, v35
    v_and_b32 v65, 0xffff0000, v35
    v_lshlrev_b32 v67, 16, v36
    v_and_b32 v69, 0xffff0000, v36
    v_lshlrev_b32 v71, 16, v37
    v_and_b32 v73, 0xffff0000, v37
    v_lshlrev_b32 v75, 16, v38
    v_and_b32 v77, 0xffff0000, v38
    v_lshlrev_b32 v79, 16, v39
    v_and_b32 v81, 0xffff0000, v39
    v_lshlrev_b32 v83, 16, v40
    v_and_b32 v85, 0xffff0000, v40
    v_lshlrev_b32 v87, 16, v41
    v_and_b32 v89, 0xffff0000, v41
    buffer_load_dwordx4 v[34:37], v11, s[56:59], 0 offen offset:0 sc1
    buffer_load_dwordx4 v[38:41], v11, s[56:59], 0 offen offset:32 sc1
    buffer_load_dwordx4 v[26:29], v11, s[56:59], 0 offen offset:64 sc1
    buffer_load_dwordx4 v[30:33], v11, s[56:59], 0 offen offset:96 sc1
    v_pk_add_f32 v[90:91], v[58:59], v[60:61]
    v_pk_add_f32 v[92:93], v[60:61], v[62:63]
    v_pk_add_f32 v[94:95], v[62:63], v[64:65]
    v_pk_add_f32 v[96:97], v[64:65], v[66:67]
    v_pk_add_f32 v[98:99], v[66:67], v[68:69]
    v_pk_add_f32 v[100:101], v[68:69], v[70:71]
    v_pk_add_f32 v[102:103], v[70:71], v[72:73]
    v_pk_add_f32 v[104:105], v[72:73], v[74:75]
    v_pk_add_f32 v[106:107], v[74:75], v[76:77]
    v_pk_add_f32 v[108:109], v[76:77], v[78:79]
    v_pk_add_f32 v[110:111], v[78:79], v[80:81]
    v_pk_add_f32 v[112:113], v[80:81], v[82:83]
    v_pk_add_f32 v[114:115], v[82:83], v[84:85]
    v_pk_add_f32 v[116:117], v[84:85], v[86:87]
    v_pk_add_f32 v[118:119], v[86:87], v[88:89]
    v_cvt_pk_bf16_f32 v120, v98, v100
    v_cvt_pk_bf16_f32 v121, v102, v104
    v_cvt_pk_bf16_f32 v122, v106, v108
    v_cvt_pk_bf16_f32 v123, v110, v112
    ds_write_b128 v21, v[120:123] offset:8304
    v_cvt_pk_bf16_f32 v124, v99, v101
    v_cvt_pk_bf16_f32 v125, v103, v105
    v_cvt_pk_bf16_f32 v126, v107, v109
    v_cvt_pk_bf16_f32 v127, v111, v113
    ds_write_b128 v21, v[124:127] offset:9328
    v_pk_add_f32 v[62:63], v[90:91], v[62:63]
    v_pk_add_f32 v[64:65], v[92:93], v[64:65]
    v_pk_add_f32 v[66:67], v[94:95], v[66:67]
    v_pk_add_f32 v[68:69], v[96:97], v[68:69]
    v_pk_add_f32 v[70:71], v[98:99], v[70:71]
    v_pk_add_f32 v[72:73], v[100:101], v[72:73]
    v_pk_add_f32 v[74:75], v[102:103], v[74:75]
    v_pk_add_f32 v[76:77], v[104:105], v[76:77]
    v_pk_add_f32 v[78:79], v[106:107], v[78:79]
    v_pk_add_f32 v[80:81], v[108:109], v[80:81]
    v_pk_add_f32 v[82:83], v[110:111], v[82:83]
    v_cvt_pk_bf16_f32 v128, v68, v70
    v_cvt_pk_bf16_f32 v129, v72, v74
    v_cvt_pk_bf16_f32 v130, v76, v78
    v_cvt_pk_bf16_f32 v131, v80, v82
    v_cvt_pk_bf16_f32 v132, v69, v71
    v_cvt_pk_bf16_f32 v133, v73, v75
    v_cvt_pk_bf16_f32 v134, v77, v79
    v_cvt_pk_bf16_f32 v135, v81, v83
    v_pk_add_f32 v[82:83], v[80:81], v[114:115]
    v_pk_add_f32 v[80:81], v[78:79], v[112:113]
    v_pk_add_f32 v[78:79], v[76:77], v[110:111]
    v_pk_add_f32 v[76:77], v[74:75], v[108:109]
    v_pk_add_f32 v[74:75], v[72:73], v[106:107]
    v_pk_add_f32 v[72:73], v[70:71], v[104:105]
    v_pk_add_f32 v[70:71], v[68:69], v[102:103]
    v_pk_add_f32 v[68:69], v[66:67], v[100:101]
    v_pk_add_f32 v[66:67], v[64:65], v[98:99]
    v_pk_add_f32 v[64:65], v[62:63], v[96:97]
    v_cvt_pk_bf16_f32 v136, v68, v70
    v_cvt_pk_bf16_f32 v137, v72, v74
    v_cvt_pk_bf16_f32 v138, v76, v78
    v_cvt_pk_bf16_f32 v139, v80, v82
    v_cvt_pk_bf16_f32 v140, v69, v71
    v_cvt_pk_bf16_f32 v141, v73, v75
    v_cvt_pk_bf16_f32 v142, v77, v79
    v_cvt_pk_bf16_f32 v143, v81, v83
    v_pk_add_f32 v[82:83], v[80:81], v[116:117]
    v_pk_add_f32 v[80:81], v[78:79], v[114:115]
    v_pk_add_f32 v[78:79], v[76:77], v[112:113]
    v_pk_add_f32 v[76:77], v[74:75], v[110:111]
    v_pk_add_f32 v[74:75], v[72:73], v[108:109]
    v_pk_add_f32 v[72:73], v[70:71], v[106:107]
    v_pk_add_f32 v[70:71], v[68:69], v[104:105]
    v_pk_add_f32 v[68:69], v[66:67], v[102:103]
    v_pk_add_f32 v[66:67], v[64:65], v[100:101]
    v_cvt_pk_bf16_f32 v120, v68, v70
    v_cvt_pk_bf16_f32 v121, v72, v74
    v_cvt_pk_bf16_f32 v122, v76, v78
    v_cvt_pk_bf16_f32 v123, v80, v82
    ds_write_b128 v21, v[120:123] offset:4144
    v_cvt_pk_bf16_f32 v124, v69, v71
    v_cvt_pk_bf16_f32 v125, v73, v75
    v_cvt_pk_bf16_f32 v126, v77, v79
    v_cvt_pk_bf16_f32 v127, v81, v83
    ds_write_b128 v21, v[124:127] offset:5168
    v_pk_add_f32 v[82:83], v[80:81], v[118:119]
    v_pk_add_f32 v[80:81], v[78:79], v[116:117]
    v_pk_add_f32 v[78:79], v[76:77], v[114:115]
    v_pk_add_f32 v[76:77], v[74:75], v[112:113]
    v_pk_add_f32 v[74:75], v[72:73], v[110:111]
    v_pk_add_f32 v[72:73], v[70:71], v[108:109]
    v_pk_add_f32 v[70:71], v[68:69], v[106:107]
    v_pk_add_f32 v[68:69], v[66:67], v[104:105]
    v_cvt_pk_bf16_f32 v120, v68, v70
    v_cvt_pk_bf16_f32 v121, v72, v74
    v_cvt_pk_bf16_f32 v122, v76, v78
    v_cvt_pk_bf16_f32 v123, v80, v82
    ds_write_b128 v21, v[120:123] offset:6224
    v_cvt_pk_bf16_f32 v124, v69, v71
    v_cvt_pk_bf16_f32 v125, v73, v75
    v_cvt_pk_bf16_f32 v126, v77, v79
    v_cvt_pk_bf16_f32 v127, v81, v83
    ds_write_b128 v21, v[124:127] offset:7248
    s_waitcnt vmcnt(12)
    v_lshlrev_b32 v62, 16, v43
    v_and_b32 v64, 0xffff0000, v43
    v_lshlrev_b32 v66, 16, v44
    v_and_b32 v68, 0xffff0000, v44
    v_lshlrev_b32 v70, 16, v45
    v_and_b32 v72, 0xffff0000, v45
    v_lshlrev_b32 v74, 16, v46
    v_and_b32 v76, 0xffff0000, v46
    v_lshlrev_b32 v78, 16, v47
    v_and_b32 v80, 0xffff0000, v47
    v_lshlrev_b32 v82, 16, v48
    v_and_b32 v84, 0xffff0000, v48
    v_lshlrev_b32 v63, 16, v51
    v_and_b32 v65, 0xffff0000, v51
    v_lshlrev_b32 v67, 16, v52
    v_and_b32 v69, 0xffff0000, v52
    v_lshlrev_b32 v71, 16, v53
    v_and_b32 v73, 0xffff0000, v53
    v_lshlrev_b32 v75, 16, v54
    v_and_b32 v77, 0xffff0000, v54
    v_lshlrev_b32 v79, 16, v55
    v_and_b32 v81, 0xffff0000, v55
    v_lshlrev_b32 v83, 16, v56
    v_and_b32 v85, 0xffff0000, v56
    v_pk_add_f32 v[94:95], v[62:63], v[64:65]
    v_pk_add_f32 v[96:97], v[64:65], v[66:67]
    v_pk_add_f32 v[98:99], v[66:67], v[68:69]
    v_pk_add_f32 v[100:101], v[68:69], v[70:71]
    v_pk_add_f32 v[102:103], v[70:71], v[72:73]
    v_pk_add_f32 v[104:105], v[72:73], v[74:75]
    v_pk_add_f32 v[106:107], v[74:75], v[76:77]
    v_pk_add_f32 v[108:109], v[76:77], v[78:79]
    v_pk_add_f32 v[110:111], v[78:79], v[80:81]
    v_pk_add_f32 v[112:113], v[80:81], v[82:83]
    v_pk_add_f32 v[114:115], v[82:83], v[84:85]
    v_cvt_pk_bf16_f32 v120, v98, v100
    v_cvt_pk_bf16_f32 v121, v102, v104
    v_cvt_pk_bf16_f32 v122, v106, v108
    v_cvt_pk_bf16_f32 v123, v110, v112
    s_mov_b32 exec_lo, 0x1
    s_mov_b32 exec_hi, 0x0
    ds_write_b128 v21, v[120:123] offset:10352
    s_mov_b64 exec, -1
    v_pk_add_f32 v[66:67], v[94:95], v[66:67]
    v_pk_add_f32 v[68:69], v[96:97], v[68:69]
    v_pk_add_f32 v[70:71], v[98:99], v[70:71]
    v_pk_add_f32 v[72:73], v[100:101], v[72:73]
    v_pk_add_f32 v[74:75], v[102:103], v[74:75]
    v_pk_add_f32 v[76:77], v[104:105], v[76:77]
    v_pk_add_f32 v[78:79], v[106:107], v[78:79]
    v_pk_add_f32 v[80:81], v[108:109], v[80:81]
    v_pk_add_f32 v[82:83], v[110:111], v[82:83]
    v_cvt_pk_bf16_f32 v42, v68, v70
    v_cvt_pk_bf16_f32 v43, v72, v74
    v_cvt_pk_bf16_f32 v44, v76, v78
    v_cvt_pk_bf16_f32 v45, v80, v82
    v_cvt_pk_bf16_f32 v46, v69, v71
    v_cvt_pk_bf16_f32 v47, v73, v75
    v_cvt_pk_bf16_f32 v48, v77, v79
    v_cvt_pk_bf16_f32 v49, v81, v83
    v_pk_add_f32 v[82:83], v[80:81], v[114:115]
    v_pk_add_f32 v[80:81], v[78:79], v[112:113]
    v_pk_add_f32 v[78:79], v[76:77], v[110:111]
    v_pk_add_f32 v[76:77], v[74:75], v[108:109]
    v_pk_add_f32 v[74:75], v[72:73], v[106:107]
    v_pk_add_f32 v[72:73], v[70:71], v[104:105]
    v_pk_add_f32 v[70:71], v[68:69], v[102:103]
    v_pk_add_f32 v[68:69], v[66:67], v[100:101]
    v_cvt_pk_bf16_f32 v50, v68, v70
    v_cvt_pk_bf16_f32 v51, v72, v74
    v_cvt_pk_bf16_f32 v52, v76, v78
    v_cvt_pk_bf16_f32 v53, v80, v82
    v_mov_b32 v58, 0
    v_mov_b32 v59, 0
    v_mov_b32 v60, 0
    v_mov_b32 v61, 0
    v_mov_b32 v62, 0
    v_mov_b32 v63, 0
    v_mov_b32 v64, 0
    v_mov_b32 v65, 0
    v_mov_b32 v66, 0
    v_mov_b32 v67, 0
    v_mov_b32 v68, 0
    v_mov_b32 v69, 0
    v_mov_b32 v70, 0
    v_mov_b32 v71, 0
    v_mov_b32 v72, 0
    v_mov_b32 v73, 0
    v_mov_b32 v74, 0
    v_mov_b32 v75, 0
    v_mov_b32 v76, 0
    v_mov_b32 v77, 0
    v_mov_b32 v78, 0
    v_mov_b32 v79, 0
    v_mov_b32 v80, 0
    v_mov_b32 v81, 0
    v_mov_b32 v82, 0
    v_mov_b32 v83, 0
    v_mov_b32 v84, 0
    v_mov_b32 v85, 0
    v_mov_b32 v86, 0
    v_mov_b32 v87, 0
    v_mov_b32 v88, 0
    v_mov_b32 v89, 0
    v_lshlrev_b32 v5, 2, v3
    v_sub_u32 v5, v2, v5
    s_waitcnt vmcnt(0)
    v_lshlrev_b32 v25, 16, v24
    v_cmp_eq_u32 vcc, 0, v5
    v_mov_b32 v22, 0
    v_cmp_eq_u32 s[24:25], 1, v5
    v_cndmask_b32 v22, v22, v24, vcc
    s_nop 0
    v_cndmask_b32 v22, v22, v25, s[24:25]
    v_cmp_eq_u32 vcc, 2, v5
    v_mov_b32 v23, 0
    v_cmp_eq_u32 s[24:25], 3, v5
    v_cndmask_b32 v23, v23, v24, vcc
    s_nop 0
    v_cndmask_b32 v23, v23, v25, s[24:25]
    s_waitcnt lgkmcnt(0)
    ds_read_b64_tr_b16 v[90:91], v15 offset:4144
    ds_read_b64_tr_b16 v[92:93], v15 offset:4272
    ds_read_b64_tr_b16 v[94:95], v15 offset:4656
    ds_read_b64_tr_b16 v[96:97], v15 offset:4784
    ds_read_b64_tr_b16 v[98:99], v15 offset:5168
    ds_read_b64_tr_b16 v[100:101], v15 offset:5296
    ds_read_b64_tr_b16 v[102:103], v15 offset:5680
    ds_read_b64_tr_b16 v[104:105], v15 offset:5808
    ds_read_b64_tr_b16 v[106:107], v16 offset:8312
    ds_read_b64_tr_b16 v[110:111], v16 offset:8824
    ds_read_b64_tr_b16 v[114:115], v16 offset:9336
    ds_read_b64_tr_b16 v[118:119], v16 offset:9848
    v_mov_b32 v4, s26
    v_mov_b32 v122, 0
    v_mov_b32 v123, 0
    v_mov_b32 v124, 0
    v_mov_b32 v125, 0
    ds_write_b128 v4, v[122:125] offset:4128
    ds_write_b128 v4, v[122:125] offset:7744
    ds_write_b128 v21, v[128:131] offset:4144
    ds_write_b128 v21, v[132:135] offset:5168
    ds_write_b128 v21, v[42:45] offset:6192
    s_mov_b32 exec_lo, 0xffffffff
    s_mov_b32 exec_hi, 0x1
    ds_write_b128 v21, v[46:49] offset:7216
    s_mov_b64 exec, -1
    ds_write_b128 v21, v[136:139] offset:7760
    ds_write_b128 v21, v[140:143] offset:8784
    ds_write_b128 v21, v[50:53] offset:9808
    s_waitcnt lgkmcnt(9)
    v_mfma_f32_16x16x32_bf16 v[74:77], v[90:93], v[30:33], v[74:77]
    v_mfma_f32_16x16x32_bf16 v[78:81], v[90:93], v[26:29], v[78:81]
    v_mfma_f32_16x16x32_bf16 v[82:85], v[90:93], v[38:41], v[82:85]
    v_mfma_f32_16x16x32_bf16 v[86:89], v[90:93], v[34:37], v[86:89]
    v_mfma_f32_16x16x32_bf16 v[78:81], v[94:97], v[30:33], v[78:81]
    v_mfma_f32_16x16x32_bf16 v[82:85], v[94:97], v[26:29], v[82:85]
    v_mfma_f32_16x16x32_bf16 v[86:89], v[94:97], v[38:41], v[86:89]
    v_mfma_f32_16x16x32_bf16 v[82:85], v[98:101], v[30:33], v[82:85]
    v_mfma_f32_16x16x32_bf16 v[86:89], v[98:101], v[26:29], v[86:89]
    v_mfma_f32_16x16x32_bf16 v[86:89], v[102:105], v[30:33], v[86:89]
    v_mfma_f32_16x16x16_bf16 v[74:77], v[106:107], v[22:23], v[74:77]
    v_mfma_f32_16x16x16_bf16 v[78:81], v[110:111], v[22:23], v[78:81]
    v_mfma_f32_16x16x16_bf16 v[82:85], v[114:115], v[22:23], v[82:85]
    v_mfma_f32_16x16x16_bf16 v[86:89], v[118:119], v[22:23], v[86:89]
    s_waitcnt lgkmcnt(0)
    buffer_load_dwordx4 v[128:131], v8, s[56:59], 0 offen offset:512 sc1
    buffer_load_dwordx4 v[132:135], v8, s[56:59], 0 offen offset:448 sc1
    buffer_load_dwordx4 v[136:139], v8, s[56:59], 0 offen offset:384 sc1
    buffer_load_dwordx4 v[140:143], v8, s[56:59], 0 offen offset:320 sc1
    buffer_load_dwordx4 v[42:45], v8, s[56:59], 0 offen offset:256 sc1
    buffer_load_dwordx4 v[46:49], v8, s[56:59], 0 offen offset:192 sc1
    buffer_load_dwordx4 v[50:53], v8, s[56:59], 0 offen offset:128 sc1
    buffer_load_dwordx4 v[54:57], v8, s[56:59], 0 offen offset:64 sc1
    buffer_load_dwordx4 v[34:37], v8, s[56:59], 0 offen offset:0 sc1
    ds_read_b64_tr_b16 v[90:91], v14 offset:4136
    ds_read_b64_tr_b16 v[92:93], v14 offset:4200
    ds_read_b64_tr_b16 v[94:95], v14 offset:7744
    ds_read_b64_tr_b16 v[96:97], v14 offset:7808
    ds_read_b64_tr_b16 v[98:99], v14 offset:4648
    ds_read_b64_tr_b16 v[100:101], v14 offset:4712
    ds_read_b64_tr_b16 v[102:103], v14 offset:8256
    ds_read_b64_tr_b16 v[104:105], v14 offset:8320
    ds_read_b64_tr_b16 v[106:107], v14 offset:5160
    ds_read_b64_tr_b16 v[108:109], v14 offset:5224
    ds_read_b64_tr_b16 v[110:111], v14 offset:8768
    ds_read_b64_tr_b16 v[112:113], v14 offset:8832
    s_waitcnt lgkmcnt(10)
    v_mfma_f32_16x16x32_bf16 v[66:69], v[90:93], v[152:155], v[66:69]
    ds_read_b64_tr_b16 v[114:115], v14 offset:5672
    ds_read_b64_tr_b16 v[116:117], v14 offset:5736
    v_mfma_f32_16x16x32_bf16 v[70:73], v[90:93], v[148:151], v[70:73]
    v_mfma_f32_16x16x32_bf16 v[74:77], v[90:93], v[144:147], v[74:77]
    s_waitcnt lgkmcnt(10)
    v_mfma_f32_16x16x32_bf16 v[66:69], v[94:97], v[164:167], v[66:69]
    ds_read_b64_tr_b16 v[118:119], v14 offset:9280
    ds_read_b64_tr_b16 v[120:121], v14 offset:9344
    v_mfma_f32_16x16x32_bf16 v[70:73], v[94:97], v[160:163], v[70:73]
    v_mfma_f32_16x16x32_bf16 v[74:77], v[94:97], v[156:159], v[74:77]
    s_waitcnt lgkmcnt(10)
    v_mfma_f32_16x16x32_bf16 v[70:73], v[98:101], v[152:155], v[70:73]
    ds_read_b64_tr_b16 v[90:91], v14 offset:6184
    ds_read_b64_tr_b16 v[92:93], v14 offset:6248
    v_mfma_f32_16x16x32_bf16 v[74:77], v[98:101], v[148:151], v[74:77]
    v_mfma_f32_16x16x32_bf16 v[78:81], v[98:101], v[144:147], v[78:81]
    s_waitcnt lgkmcnt(10)
    v_mfma_f32_16x16x32_bf16 v[70:73], v[102:105], v[164:167], v[70:73]
    ds_read_b64_tr_b16 v[94:95], v14 offset:9792
    ds_read_b64_tr_b16 v[96:97], v14 offset:9856
    v_mfma_f32_16x16x32_bf16 v[74:77], v[102:105], v[160:163], v[74:77]
    v_mfma_f32_16x16x32_bf16 v[78:81], v[102:105], v[156:159], v[78:81]
    s_waitcnt lgkmcnt(10)
    v_mfma_f32_16x16x32_bf16 v[74:77], v[106:109], v[152:155], v[74:77]
    ds_read_b64_tr_b16 v[98:99], v14 offset:6696
    ds_read_b64_tr_b16 v[100:101], v14 offset:6760
    v_mfma_f32_16x16x32_bf16 v[78:81], v[106:109], v[148:151], v[78:81]
    v_mfma_f32_16x16x32_bf16 v[82:85], v[106:109], v[144:147], v[82:85]
    s_waitcnt lgkmcnt(10)
    v_mfma_f32_16x16x32_bf16 v[74:77], v[110:113], v[164:167], v[74:77]
    ds_read_b64_tr_b16 v[102:103], v14 offset:10304
    ds_read_b64_tr_b16 v[104:105], v14 offset:10368
    v_mfma_f32_16x16x32_bf16 v[78:81], v[110:113], v[160:163], v[78:81]
    v_mfma_f32_16x16x32_bf16 v[82:85], v[110:113], v[156:159], v[82:85]
    s_waitcnt lgkmcnt(10)
    v_mfma_f32_16x16x32_bf16 v[78:81], v[114:117], v[152:155], v[78:81]
    v_mfma_f32_16x16x32_bf16 v[82:85], v[114:117], v[148:151], v[82:85]
    v_mfma_f32_16x16x32_bf16 v[86:89], v[114:117], v[144:147], v[86:89]
    s_waitcnt lgkmcnt(8)
    v_mfma_f32_16x16x32_bf16 v[78:81], v[118:121], v[164:167], v[78:81]
    v_mfma_f32_16x16x32_bf16 v[82:85], v[118:121], v[160:163], v[82:85]
    v_mfma_f32_16x16x32_bf16 v[86:89], v[118:121], v[156:159], v[86:89]
    s_waitcnt lgkmcnt(6)
    v_mfma_f32_16x16x32_bf16 v[82:85], v[90:93], v[152:155], v[82:85]
    v_mfma_f32_16x16x32_bf16 v[86:89], v[90:93], v[148:151], v[86:89]
    s_waitcnt lgkmcnt(4)
    v_mfma_f32_16x16x32_bf16 v[82:85], v[94:97], v[164:167], v[82:85]
    v_mfma_f32_16x16x32_bf16 v[86:89], v[94:97], v[160:163], v[86:89]
    s_waitcnt lgkmcnt(2)
    v_mfma_f32_16x16x32_bf16 v[86:89], v[98:101], v[152:155], v[86:89]
    s_waitcnt lgkmcnt(0)
    v_mfma_f32_16x16x32_bf16 v[86:89], v[102:105], v[164:167], v[86:89]
    s_waitcnt vmcnt(0)
    buffer_load_dwordx4 v[144:147], v9, s[56:59], 0 offen offset:0 sc1
    buffer_load_dwordx4 v[148:151], v9, s[56:59], 0 offen offset:64 sc1
    buffer_load_dwordx4 v[152:155], v9, s[56:59], 0 offen offset:128 sc1
    buffer_load_dwordx4 v[156:159], v9, s[56:59], 0 offen offset:192 sc1
    buffer_load_dwordx4 v[160:163], v9, s[56:59], 0 offen offset:384 sc1
    buffer_load_dwordx4 v[164:167], v9, s[56:59], 0 offen offset:448 sc1
    buffer_load_dwordx4 v[26:29], v9, s[56:59], 0 offen offset:512 sc1
    buffer_load_dwordx4 v[30:33], v9, s[56:59], 0 offen offset:576 sc1
    v_mov_b32 v6, s26
    v_add_u32 v5, -400, v12
    v_max_i32 v5, v6, v5
    ds_read_b128 v[90:93], v5
    v_add_u32 v5, -336, v12
    v_max_i32 v5, v6, v5
    ds_read_b128 v[94:97], v5
    v_add_u32 v5, -272, v12
    v_max_i32 v5, v6, v5
    ds_read_b128 v[98:101], v5
    v_add_u32 v5, -208, v12
    v_max_i32 v5, v6, v5
    ds_read_b128 v[102:105], v5
    v_add_u32 v5, -144, v12
    v_max_i32 v5, v6, v5
    ds_read_b128 v[106:109], v5
    v_add_u32 v5, -80, v12
    v_max_i32 v5, v6, v5
    ds_read_b128 v[110:113], v5
    s_waitcnt lgkmcnt(5)
    v_mfma_f32_16x16x32_bf16 v[58:61], v[54:57], v[90:93], v[58:61]
    v_add_u32 v5, -16, v12
    v_max_i32 v5, v6, v5
    ds_read_b128 v[114:117], v5
    s_waitcnt lgkmcnt(5)
    v_mfma_f32_16x16x32_bf16 v[58:61], v[50:53], v[94:97], v[58:61]
    v_add_u32 v5, 48, v12
    v_max_i32 v5, v6, v5
    ds_read_b128 v[118:121], v5
    s_waitcnt lgkmcnt(5)
    v_mfma_f32_16x16x32_bf16 v[58:61], v[46:49], v[98:101], v[58:61]
    ds_read_b128 v[90:93], v12 offset:112
    s_waitcnt lgkmcnt(5)
    v_mfma_f32_16x16x32_bf16 v[58:61], v[42:45], v[102:105], v[58:61]
    ds_read_b128 v[94:97], v12 offset:176
    s_waitcnt lgkmcnt(5)
    v_mfma_f32_16x16x32_bf16 v[58:61], v[140:143], v[106:109], v[58:61]
    ds_read_b128 v[98:101], v12 offset:240
    s_waitcnt lgkmcnt(5)
    v_mfma_f32_16x16x32_bf16 v[58:61], v[136:139], v[110:113], v[58:61]
    ds_read_b128 v[102:105], v12 offset:304
    s_waitcnt lgkmcnt(5)
    v_mfma_f32_16x16x32_bf16 v[58:61], v[132:135], v[114:117], v[58:61]
    ds_read_b128 v[106:109], v12 offset:368
    s_waitcnt lgkmcnt(5)
    v_mfma_f32_16x16x32_bf16 v[58:61], v[128:131], v[118:121], v[58:61]
    ds_read_b128 v[110:113], v12 offset:432
    v_mfma_f32_16x16x32_bf16 v[62:65], v[34:37], v[118:121], v[62:65]
    s_waitcnt lgkmcnt(5)
    v_mfma_f32_16x16x32_bf16 v[62:65], v[54:57], v[90:93], v[62:65]
    ds_read_b128 v[114:117], v12 offset:496
    s_waitcnt lgkmcnt(5)
    v_mfma_f32_16x16x32_bf16 v[62:65], v[50:53], v[94:97], v[62:65]
    ds_read_b128 v[118:121], v12 offset:560
    s_waitcnt lgkmcnt(5)
    v_mfma_f32_16x16x32_bf16 v[62:65], v[46:49], v[98:101], v[62:65]
    ds_read_b128 v[90:93], v12 offset:624
    s_waitcnt lgkmcnt(5)
    v_mfma_f32_16x16x32_bf16 v[62:65], v[42:45], v[102:105], v[62:65]
    ds_read_b128 v[94:97], v12 offset:688
    s_waitcnt lgkmcnt(5)
    v_mfma_f32_16x16x32_bf16 v[62:65], v[140:143], v[106:109], v[62:65]
    ds_read_b128 v[98:101], v12 offset:752
    s_waitcnt lgkmcnt(5)
    v_mfma_f32_16x16x32_bf16 v[62:65], v[136:139], v[110:113], v[62:65]
    ds_read_b128 v[102:105], v12 offset:816
    s_waitcnt lgkmcnt(5)
    v_mfma_f32_16x16x32_bf16 v[62:65], v[132:135], v[114:117], v[62:65]
    ds_read_b128 v[106:109], v12 offset:880
    s_waitcnt lgkmcnt(5)
    v_mfma_f32_16x16x32_bf16 v[62:65], v[128:131], v[118:121], v[62:65]
    ds_read_b128 v[110:113], v12 offset:944
    v_mfma_f32_16x16x32_bf16 v[66:69], v[34:37], v[118:121], v[66:69]
    s_waitcnt lgkmcnt(5)
    v_mfma_f32_16x16x32_bf16 v[66:69], v[54:57], v[90:93], v[66:69]
    ds_read_b128 v[114:117], v12 offset:1008
    s_waitcnt lgkmcnt(5)
    v_mfma_f32_16x16x32_bf16 v[66:69], v[50:53], v[94:97], v[66:69]
    ds_read_b128 v[118:121], v12 offset:1072
    s_waitcnt lgkmcnt(5)
    v_mfma_f32_16x16x32_bf16 v[66:69], v[46:49], v[98:101], v[66:69]
    ds_read_b128 v[90:93], v12 offset:1136
    s_waitcnt lgkmcnt(5)
    v_mfma_f32_16x16x32_bf16 v[66:69], v[42:45], v[102:105], v[66:69]
    ds_read_b128 v[94:97], v12 offset:1200
    s_waitcnt lgkmcnt(5)
    v_mfma_f32_16x16x32_bf16 v[66:69], v[140:143], v[106:109], v[66:69]
    ds_read_b128 v[98:101], v12 offset:1264
    s_waitcnt lgkmcnt(5)
    v_mfma_f32_16x16x32_bf16 v[66:69], v[136:139], v[110:113], v[66:69]
    ds_read_b128 v[102:105], v12 offset:1328
    s_waitcnt lgkmcnt(5)
    v_mfma_f32_16x16x32_bf16 v[66:69], v[132:135], v[114:117], v[66:69]
    ds_read_b128 v[106:109], v12 offset:1392
    s_waitcnt lgkmcnt(5)
    v_mfma_f32_16x16x32_bf16 v[66:69], v[128:131], v[118:121], v[66:69]
    ds_read_b128 v[110:113], v12 offset:1456
    v_mfma_f32_16x16x32_bf16 v[70:73], v[34:37], v[118:121], v[70:73]
    s_waitcnt lgkmcnt(5)
    v_mfma_f32_16x16x32_bf16 v[70:73], v[54:57], v[90:93], v[70:73]
    ds_read_b128 v[114:117], v12 offset:1520
    s_waitcnt lgkmcnt(5)
    v_mfma_f32_16x16x32_bf16 v[70:73], v[50:53], v[94:97], v[70:73]
    ds_read_b128 v[118:121], v12 offset:1584
    s_waitcnt lgkmcnt(5)
    v_mfma_f32_16x16x32_bf16 v[70:73], v[46:49], v[98:101], v[70:73]
    ds_read_b128 v[90:93], v12 offset:1648
    s_waitcnt lgkmcnt(5)
    v_mfma_f32_16x16x32_bf16 v[70:73], v[42:45], v[102:105], v[70:73]
    ds_read_b128 v[94:97], v12 offset:1712
    s_waitcnt lgkmcnt(5)
    v_mfma_f32_16x16x32_bf16 v[70:73], v[140:143], v[106:109], v[70:73]
    ds_read_b128 v[98:101], v12 offset:1776
    s_waitcnt lgkmcnt(5)
    v_mfma_f32_16x16x32_bf16 v[70:73], v[136:139], v[110:113], v[70:73]
    ds_read_b128 v[102:105], v12 offset:1840
    s_waitcnt lgkmcnt(5)
    v_mfma_f32_16x16x32_bf16 v[70:73], v[132:135], v[114:117], v[70:73]
    ds_read_b128 v[106:109], v12 offset:1904
    s_waitcnt lgkmcnt(5)
    v_mfma_f32_16x16x32_bf16 v[70:73], v[128:131], v[118:121], v[70:73]
    ds_read_b128 v[110:113], v12 offset:1968
    v_mfma_f32_16x16x32_bf16 v[74:77], v[34:37], v[118:121], v[74:77]
    s_waitcnt lgkmcnt(5)
    v_mfma_f32_16x16x32_bf16 v[74:77], v[54:57], v[90:93], v[74:77]
    ds_read_b128 v[114:117], v12 offset:2032
    s_waitcnt lgkmcnt(5)
    v_mfma_f32_16x16x32_bf16 v[74:77], v[50:53], v[94:97], v[74:77]
    ds_read_b128 v[118:121], v12 offset:2096
    s_waitcnt lgkmcnt(5)
    v_mfma_f32_16x16x32_bf16 v[74:77], v[46:49], v[98:101], v[74:77]
    ds_read_b128 v[90:93], v12 offset:2160
    s_waitcnt lgkmcnt(5)
    v_mfma_f32_16x16x32_bf16 v[74:77], v[42:45], v[102:105], v[74:77]
    ds_read_b128 v[94:97], v12 offset:2224
    s_waitcnt lgkmcnt(5)
    v_mfma_f32_16x16x32_bf16 v[74:77], v[140:143], v[106:109], v[74:77]
    ds_read_b128 v[98:101], v12 offset:2288
    s_waitcnt lgkmcnt(5)
    v_mfma_f32_16x16x32_bf16 v[74:77], v[136:139], v[110:113], v[74:77]
    ds_read_b128 v[102:105], v12 offset:2352
    s_waitcnt lgkmcnt(5)
    v_mfma_f32_16x16x32_bf16 v[74:77], v[132:135], v[114:117], v[74:77]
    ds_read_b128 v[106:109], v12 offset:2416
    s_waitcnt lgkmcnt(5)
    v_mfma_f32_16x16x32_bf16 v[74:77], v[128:131], v[118:121], v[74:77]
    ds_read_b128 v[110:113], v12 offset:2480
    v_mfma_f32_16x16x32_bf16 v[78:81], v[34:37], v[118:121], v[78:81]
    s_waitcnt lgkmcnt(5)
    v_mfma_f32_16x16x32_bf16 v[78:81], v[54:57], v[90:93], v[78:81]
    ds_read_b128 v[114:117], v12 offset:2544
    s_waitcnt lgkmcnt(5)
    v_mfma_f32_16x16x32_bf16 v[78:81], v[50:53], v[94:97], v[78:81]
    ds_read_b128 v[118:121], v12 offset:2608
    s_waitcnt lgkmcnt(5)
    v_mfma_f32_16x16x32_bf16 v[78:81], v[46:49], v[98:101], v[78:81]
    ds_read_b128 v[90:93], v12 offset:2672
    s_waitcnt lgkmcnt(5)
    v_mfma_f32_16x16x32_bf16 v[78:81], v[42:45], v[102:105], v[78:81]
    ds_read_b128 v[94:97], v12 offset:2736
    s_waitcnt lgkmcnt(5)
    v_mfma_f32_16x16x32_bf16 v[78:81], v[140:143], v[106:109], v[78:81]
    ds_read_b128 v[98:101], v12 offset:2800
    s_waitcnt lgkmcnt(5)
    v_mfma_f32_16x16x32_bf16 v[78:81], v[136:139], v[110:113], v[78:81]
    ds_read_b128 v[102:105], v12 offset:2864
    s_waitcnt lgkmcnt(5)
    v_mfma_f32_16x16x32_bf16 v[78:81], v[132:135], v[114:117], v[78:81]
    ds_read_b128 v[106:109], v12 offset:2928
    s_waitcnt lgkmcnt(5)
    v_mfma_f32_16x16x32_bf16 v[78:81], v[128:131], v[118:121], v[78:81]
    ds_read_b128 v[110:113], v12 offset:2992
    v_mfma_f32_16x16x32_bf16 v[82:85], v[34:37], v[118:121], v[82:85]
    s_waitcnt lgkmcnt(5)
    v_mfma_f32_16x16x32_bf16 v[82:85], v[54:57], v[90:93], v[82:85]
    ds_read_b128 v[114:117], v12 offset:3056
    s_waitcnt lgkmcnt(5)
    v_mfma_f32_16x16x32_bf16 v[82:85], v[50:53], v[94:97], v[82:85]
    ds_read_b128 v[118:121], v12 offset:3120
    s_waitcnt lgkmcnt(5)
    v_mfma_f32_16x16x32_bf16 v[82:85], v[46:49], v[98:101], v[82:85]
    ds_read_b128 v[90:93], v12 offset:3184
    s_waitcnt lgkmcnt(5)
    v_mfma_f32_16x16x32_bf16 v[82:85], v[42:45], v[102:105], v[82:85]
    ds_read_b128 v[94:97], v12 offset:3248
    s_waitcnt lgkmcnt(5)
    v_mfma_f32_16x16x32_bf16 v[82:85], v[140:143], v[106:109], v[82:85]
    ds_read_b128 v[98:101], v12 offset:3312
    s_waitcnt lgkmcnt(5)
    v_mfma_f32_16x16x32_bf16 v[82:85], v[136:139], v[110:113], v[82:85]
    ds_read_b128 v[102:105], v12 offset:3376
    s_waitcnt lgkmcnt(5)
    v_mfma_f32_16x16x32_bf16 v[82:85], v[132:135], v[114:117], v[82:85]
    ds_read_b128 v[106:109], v12 offset:3440
    s_waitcnt lgkmcnt(5)
    v_mfma_f32_16x16x32_bf16 v[82:85], v[128:131], v[118:121], v[82:85]
    ds_read_b128 v[110:113], v12 offset:3504
    v_mfma_f32_16x16x32_bf16 v[86:89], v[34:37], v[118:121], v[86:89]
    s_waitcnt lgkmcnt(5)
    v_mfma_f32_16x16x32_bf16 v[86:89], v[54:57], v[90:93], v[86:89]
    ds_read_b128 v[114:117], v12 offset:3568
    s_waitcnt lgkmcnt(5)
    v_mfma_f32_16x16x32_bf16 v[86:89], v[50:53], v[94:97], v[86:89]
    ds_read_b128 v[118:121], v12 offset:3632
    s_waitcnt lgkmcnt(5)
    v_mfma_f32_16x16x32_bf16 v[86:89], v[46:49], v[98:101], v[86:89]
    s_waitcnt lgkmcnt(4)
    v_mfma_f32_16x16x32_bf16 v[86:89], v[42:45], v[102:105], v[86:89]
    s_waitcnt lgkmcnt(3)
    v_mfma_f32_16x16x32_bf16 v[86:89], v[140:143], v[106:109], v[86:89]
    s_waitcnt lgkmcnt(2)
    v_mfma_f32_16x16x32_bf16 v[86:89], v[136:139], v[110:113], v[86:89]
    s_waitcnt lgkmcnt(1)
    v_mfma_f32_16x16x32_bf16 v[86:89], v[132:135], v[114:117], v[86:89]
    s_waitcnt lgkmcnt(0)
    v_mfma_f32_16x16x32_bf16 v[86:89], v[128:131], v[118:121], v[86:89]
    s_waitcnt vmcnt(0)
    ds_read_b64_tr_b16 v[90:91], v13 offset:10848
    ds_read_b64_tr_b16 v[92:93], v13 offset:10880
    ds_read_b64_tr_b16 v[94:95], v13 offset:4128
    ds_read_b64_tr_b16 v[96:97], v13 offset:4160
    ds_read_b64_tr_b16 v[98:99], v13 offset:11104
    ds_read_b64_tr_b16 v[100:101], v13 offset:11136
    ds_read_b64_tr_b16 v[102:103], v13 offset:4384
    ds_read_b64_tr_b16 v[104:105], v13 offset:4416
    ds_read_b64_tr_b16 v[106:107], v13 offset:11360
    ds_read_b64_tr_b16 v[108:109], v13 offset:11392
    ds_read_b64_tr_b16 v[110:111], v13 offset:4640
    ds_read_b64_tr_b16 v[112:113], v13 offset:4672
    s_waitcnt lgkmcnt(10)
    v_mfma_f32_16x16x32_bf16 v[62:65], v[90:93], v[152:155], v[62:65]
    ds_read_b64_tr_b16 v[114:115], v13 offset:11616
    ds_read_b64_tr_b16 v[116:117], v13 offset:11648
    v_mfma_f32_16x16x32_bf16 v[66:69], v[90:93], v[144:147], v[66:69]
    s_waitcnt lgkmcnt(10)
    v_mfma_f32_16x16x32_bf16 v[62:65], v[94:97], v[26:29], v[62:65]
    ds_read_b64_tr_b16 v[118:119], v13 offset:4896
    ds_read_b64_tr_b16 v[120:121], v13 offset:4928
    v_mfma_f32_16x16x32_bf16 v[66:69], v[94:97], v[160:163], v[66:69]
    s_waitcnt lgkmcnt(10)
    v_mfma_f32_16x16x32_bf16 v[62:65], v[98:101], v[156:159], v[62:65]
    ds_read_b64_tr_b16 v[90:91], v13 offset:11872
    ds_read_b64_tr_b16 v[92:93], v13 offset:11904
    v_mfma_f32_16x16x32_bf16 v[66:69], v[98:101], v[148:151], v[66:69]
    s_waitcnt lgkmcnt(10)
    v_mfma_f32_16x16x32_bf16 v[62:65], v[102:105], v[30:33], v[62:65]
    ds_read_b64_tr_b16 v[94:95], v13 offset:5152
    ds_read_b64_tr_b16 v[96:97], v13 offset:5184
    v_mfma_f32_16x16x32_bf16 v[66:69], v[102:105], v[164:167], v[66:69]
    s_waitcnt lgkmcnt(10)
    v_mfma_f32_16x16x32_bf16 v[66:69], v[106:109], v[152:155], v[66:69]
    ds_read_b64_tr_b16 v[98:99], v13 offset:12128
    ds_read_b64_tr_b16 v[100:101], v13 offset:12160
    v_mfma_f32_16x16x32_bf16 v[70:73], v[106:109], v[144:147], v[70:73]
    s_waitcnt lgkmcnt(10)
    v_mfma_f32_16x16x32_bf16 v[66:69], v[110:113], v[26:29], v[66:69]
    ds_read_b64_tr_b16 v[102:103], v13 offset:5408
    ds_read_b64_tr_b16 v[104:105], v13 offset:5440
    v_mfma_f32_16x16x32_bf16 v[70:73], v[110:113], v[160:163], v[70:73]
    s_waitcnt lgkmcnt(10)
    v_mfma_f32_16x16x32_bf16 v[66:69], v[114:117], v[156:159], v[66:69]
    ds_read_b64_tr_b16 v[106:107], v13 offset:12384
    ds_read_b64_tr_b16 v[108:109], v13 offset:12416
    v_mfma_f32_16x16x32_bf16 v[70:73], v[114:117], v[148:151], v[70:73]
    s_waitcnt lgkmcnt(10)
    v_mfma_f32_16x16x32_bf16 v[66:69], v[118:121], v[30:33], v[66:69]
    ds_read_b64_tr_b16 v[110:111], v13 offset:5664
    ds_read_b64_tr_b16 v[112:113], v13 offset:5696
    v_mfma_f32_16x16x32_bf16 v[70:73], v[118:121], v[164:167], v[70:73]
    s_waitcnt lgkmcnt(10)
    v_mfma_f32_16x16x32_bf16 v[70:73], v[90:93], v[152:155], v[70:73]
    ds_read_b64_tr_b16 v[114:115], v13 offset:12640
    ds_read_b64_tr_b16 v[116:117], v13 offset:12672
    v_mfma_f32_16x16x32_bf16 v[74:77], v[90:93], v[144:147], v[74:77]
    s_waitcnt lgkmcnt(10)
    v_mfma_f32_16x16x32_bf16 v[70:73], v[94:97], v[26:29], v[70:73]
    ds_read_b64_tr_b16 v[118:119], v13 offset:5920
    ds_read_b64_tr_b16 v[120:121], v13 offset:5952
    v_mfma_f32_16x16x32_bf16 v[74:77], v[94:97], v[160:163], v[74:77]
    s_waitcnt lgkmcnt(10)
    v_mfma_f32_16x16x32_bf16 v[70:73], v[98:101], v[156:159], v[70:73]
    ds_read_b64_tr_b16 v[90:91], v13 offset:12896
    ds_read_b64_tr_b16 v[92:93], v13 offset:12928
    v_mfma_f32_16x16x32_bf16 v[74:77], v[98:101], v[148:151], v[74:77]
    s_waitcnt lgkmcnt(10)
    v_mfma_f32_16x16x32_bf16 v[70:73], v[102:105], v[30:33], v[70:73]
    ds_read_b64_tr_b16 v[94:95], v13 offset:6176
    ds_read_b64_tr_b16 v[96:97], v13 offset:6208
    v_mfma_f32_16x16x32_bf16 v[74:77], v[102:105], v[164:167], v[74:77]
    s_waitcnt lgkmcnt(10)
    v_mfma_f32_16x16x32_bf16 v[74:77], v[106:109], v[152:155], v[74:77]
    ds_read_b64_tr_b16 v[98:99], v13 offset:13152
    ds_read_b64_tr_b16 v[100:101], v13 offset:13184
    v_mfma_f32_16x16x32_bf16 v[78:81], v[106:109], v[144:147], v[78:81]
    s_waitcnt lgkmcnt(10)
    v_mfma_f32_16x16x32_bf16 v[74:77], v[110:113], v[26:29], v[74:77]
    ds_read_b64_tr_b16 v[102:103], v13 offset:6432
    ds_read_b64_tr_b16 v[104:105], v13 offset:6464
    v_mfma_f32_16x16x32_bf16 v[78:81], v[110:113], v[160:163], v[78:81]
    s_waitcnt lgkmcnt(10)
    v_mfma_f32_16x16x32_bf16 v[74:77], v[114:117], v[156:159], v[74:77]
    ds_read_b64_tr_b16 v[106:107], v13 offset:13408
    ds_read_b64_tr_b16 v[108:109], v13 offset:13440
    v_mfma_f32_16x16x32_bf16 v[78:81], v[114:117], v[148:151], v[78:81]
    s_waitcnt lgkmcnt(10)
    v_mfma_f32_16x16x32_bf16 v[74:77], v[118:121], v[30:33], v[74:77]
    ds_read_b64_tr_b16 v[110:111], v13 offset:6688
    ds_read_b64_tr_b16 v[112:113], v13 offset:6720
    v_mfma_f32_16x16x32_bf16 v[78:81], v[118:121], v[164:167], v[78:81]
    s_waitcnt lgkmcnt(10)
    v_mfma_f32_16x16x32_bf16 v[78:81], v[90:93], v[152:155], v[78:81]
    ds_read_b64_tr_b16 v[114:115], v13 offset:13664
    ds_read_b64_tr_b16 v[116:117], v13 offset:13696
    v_mfma_f32_16x16x32_bf16 v[82:85], v[90:93], v[144:147], v[82:85]
    s_waitcnt lgkmcnt(10)
    v_mfma_f32_16x16x32_bf16 v[78:81], v[94:97], v[26:29], v[78:81]
    ds_read_b64_tr_b16 v[118:119], v13 offset:6944
    ds_read_b64_tr_b16 v[120:121], v13 offset:6976
    v_mfma_f32_16x16x32_bf16 v[82:85], v[94:97], v[160:163], v[82:85]
    s_waitcnt lgkmcnt(10)
    v_mfma_f32_16x16x32_bf16 v[78:81], v[98:101], v[156:159], v[78:81]
    ds_read_b64_tr_b16 v[90:91], v13 offset:13920
    ds_read_b64_tr_b16 v[92:93], v13 offset:13952
    v_mfma_f32_16x16x32_bf16 v[82:85], v[98:101], v[148:151], v[82:85]
    s_waitcnt lgkmcnt(10)
    v_mfma_f32_16x16x32_bf16 v[78:81], v[102:105], v[30:33], v[78:81]
    ds_read_b64_tr_b16 v[94:95], v13 offset:7200
    ds_read_b64_tr_b16 v[96:97], v13 offset:7232
    v_mfma_f32_16x16x32_bf16 v[82:85], v[102:105], v[164:167], v[82:85]
    s_waitcnt lgkmcnt(10)
    v_mfma_f32_16x16x32_bf16 v[82:85], v[106:109], v[152:155], v[82:85]
    ds_read_b64_tr_b16 v[98:99], v13 offset:14176
    ds_read_b64_tr_b16 v[100:101], v13 offset:14208
    v_mfma_f32_16x16x32_bf16 v[86:89], v[106:109], v[144:147], v[86:89]
    s_waitcnt lgkmcnt(10)
    v_mfma_f32_16x16x32_bf16 v[82:85], v[110:113], v[26:29], v[82:85]
    ds_read_b64_tr_b16 v[102:103], v13 offset:7456
    ds_read_b64_tr_b16 v[104:105], v13 offset:7488
    v_mfma_f32_16x16x32_bf16 v[86:89], v[110:113], v[160:163], v[86:89]
    s_waitcnt lgkmcnt(10)
    v_mfma_f32_16x16x32_bf16 v[82:85], v[114:117], v[156:159], v[82:85]
    v_mfma_f32_16x16x32_bf16 v[86:89], v[114:117], v[148:151], v[86:89]
    s_waitcnt lgkmcnt(8)
    v_mfma_f32_16x16x32_bf16 v[82:85], v[118:121], v[30:33], v[82:85]
    v_mfma_f32_16x16x32_bf16 v[86:89], v[118:121], v[164:167], v[86:89]
    s_waitcnt lgkmcnt(6)
    v_mfma_f32_16x16x32_bf16 v[86:89], v[90:93], v[152:155], v[86:89]
    s_waitcnt lgkmcnt(4)
    v_mfma_f32_16x16x32_bf16 v[86:89], v[94:97], v[26:29], v[86:89]
    s_waitcnt lgkmcnt(2)
    v_mfma_f32_16x16x32_bf16 v[86:89], v[98:101], v[156:159], v[86:89]
    s_waitcnt lgkmcnt(0)
    v_mfma_f32_16x16x32_bf16 v[86:89], v[102:105], v[30:33], v[86:89]
    ds_read_b64 v[128:129], v19 offset:32
    ds_read_b64 v[130:131], v19 offset:544
    ds_read_b64 v[132:133], v19 offset:1056
    ds_read_b64 v[134:135], v19 offset:1568
    ds_read_b64 v[136:137], v19 offset:2080
    ds_read_b64 v[138:139], v19 offset:2592
    ds_read_b64 v[140:141], v19 offset:3104
    ds_read_b64 v[142:143], v19 offset:3616
    s_waitcnt lgkmcnt(0)
    v_lshlrev_b32 v20, 5, v2
    v_and_b32 v4, 1, v3
    v_lshl_add_u32 v20, v4, 9, v20
    v_lshrrev_b32 v4, 1, v3
    v_lshl_add_u32 v20, v4, 4, v20
    v_lshlrev_b32 v90, 16, v128
    v_and_b32 v91, 0xffff0000, v128
    v_lshlrev_b32 v92, 16, v129
    v_and_b32 v93, 0xffff0000, v129
    v_pk_mul_f32 v[90:91], v[90:91], s[30:31]
    v_pk_mul_f32 v[92:93], v[92:93], s[30:31]
    v_cvt_pk_bf16_f32 v94, v58, v59
    v_cvt_pk_bf16_f32 v95, v60, v61
    v_lshlrev_b32 v58, 16, v94
    v_and_b32 v59, 0xffff0000, v94
    v_lshlrev_b32 v60, 16, v95
    v_and_b32 v61, 0xffff0000, v95
    v_cvt_pk_bf16_f32 v96, v90, v91
    v_cvt_pk_bf16_f32 v97, v92, v93
    v_lshlrev_b32 v90, 16, v96
    v_and_b32 v91, 0xffff0000, v96
    v_lshlrev_b32 v92, 16, v97
    v_and_b32 v93, 0xffff0000, v97
    v_pk_add_f32 v[58:59], v[58:59], v[90:91]
    v_pk_add_f32 v[60:61], v[60:61], v[92:93]
    v_cvt_pk_bf16_f32 v106, v58, v59
    v_cvt_pk_bf16_f32 v107, v60, v61
    v_lshlrev_b32 v98, 16, v130
    v_and_b32 v99, 0xffff0000, v130
    v_lshlrev_b32 v100, 16, v131
    v_and_b32 v101, 0xffff0000, v131
    v_pk_mul_f32 v[98:99], v[98:99], s[30:31]
    v_pk_mul_f32 v[100:101], v[100:101], s[30:31]
    v_cvt_pk_bf16_f32 v102, v62, v63
    v_cvt_pk_bf16_f32 v103, v64, v65
    v_lshlrev_b32 v62, 16, v102
    v_and_b32 v63, 0xffff0000, v102
    v_lshlrev_b32 v64, 16, v103
    v_and_b32 v65, 0xffff0000, v103
    v_cvt_pk_bf16_f32 v104, v98, v99
    v_cvt_pk_bf16_f32 v105, v100, v101
    v_lshlrev_b32 v98, 16, v104
    v_and_b32 v99, 0xffff0000, v104
    v_lshlrev_b32 v100, 16, v105
    v_and_b32 v101, 0xffff0000, v105
    v_pk_add_f32 v[62:63], v[62:63], v[98:99]
    v_pk_add_f32 v[64:65], v[64:65], v[100:101]
    v_cvt_pk_bf16_f32 v108, v62, v63
    v_cvt_pk_bf16_f32 v109, v64, v65
    s_nop 1
    v_permlane16_swap_b32 v106, v108
    v_permlane16_swap_b32 v107, v109
    buffer_store_dwordx4 v[106:109], v20, s[36:39], 0 offen offset:0 sc1
    v_lshlrev_b32 v90, 16, v132
    v_and_b32 v91, 0xffff0000, v132
    v_lshlrev_b32 v92, 16, v133
    v_and_b32 v93, 0xffff0000, v133
    v_pk_mul_f32 v[90:91], v[90:91], s[30:31]
    v_pk_mul_f32 v[92:93], v[92:93], s[30:31]
    v_cvt_pk_bf16_f32 v94, v66, v67
    v_cvt_pk_bf16_f32 v95, v68, v69
    v_lshlrev_b32 v66, 16, v94
    v_and_b32 v67, 0xffff0000, v94
    v_lshlrev_b32 v68, 16, v95
    v_and_b32 v69, 0xffff0000, v95
    v_cvt_pk_bf16_f32 v96, v90, v91
    v_cvt_pk_bf16_f32 v97, v92, v93
    v_lshlrev_b32 v90, 16, v96
    v_and_b32 v91, 0xffff0000, v96
    v_lshlrev_b32 v92, 16, v97
    v_and_b32 v93, 0xffff0000, v97
    v_pk_add_f32 v[66:67], v[66:67], v[90:91]
    v_pk_add_f32 v[68:69], v[68:69], v[92:93]
    v_cvt_pk_bf16_f32 v110, v66, v67
    v_cvt_pk_bf16_f32 v111, v68, v69
    v_lshlrev_b32 v98, 16, v134
    v_and_b32 v99, 0xffff0000, v134
    v_lshlrev_b32 v100, 16, v135
    v_and_b32 v101, 0xffff0000, v135
    v_pk_mul_f32 v[98:99], v[98:99], s[30:31]
    v_pk_mul_f32 v[100:101], v[100:101], s[30:31]
    v_cvt_pk_bf16_f32 v102, v70, v71
    v_cvt_pk_bf16_f32 v103, v72, v73
    v_lshlrev_b32 v70, 16, v102
    v_and_b32 v71, 0xffff0000, v102
    v_lshlrev_b32 v72, 16, v103
    v_and_b32 v73, 0xffff0000, v103
    v_cvt_pk_bf16_f32 v104, v98, v99
    v_cvt_pk_bf16_f32 v105, v100, v101
    v_lshlrev_b32 v98, 16, v104
    v_and_b32 v99, 0xffff0000, v104
    v_lshlrev_b32 v100, 16, v105
    v_and_b32 v101, 0xffff0000, v105
    v_pk_add_f32 v[70:71], v[70:71], v[98:99]
    v_pk_add_f32 v[72:73], v[72:73], v[100:101]
    v_cvt_pk_bf16_f32 v112, v70, v71
    v_cvt_pk_bf16_f32 v113, v72, v73
    s_nop 1
    v_permlane16_swap_b32 v110, v112
    v_permlane16_swap_b32 v111, v113
    buffer_store_dwordx4 v[110:113], v20, s[36:39], 0 offen offset:1024 sc1
    v_lshlrev_b32 v90, 16, v136
    v_and_b32 v91, 0xffff0000, v136
    v_lshlrev_b32 v92, 16, v137
    v_and_b32 v93, 0xffff0000, v137
    v_pk_mul_f32 v[90:91], v[90:91], s[30:31]
    v_pk_mul_f32 v[92:93], v[92:93], s[30:31]
    v_cvt_pk_bf16_f32 v94, v74, v75
    v_cvt_pk_bf16_f32 v95, v76, v77
    v_lshlrev_b32 v74, 16, v94
    v_and_b32 v75, 0xffff0000, v94
    v_lshlrev_b32 v76, 16, v95
    v_and_b32 v77, 0xffff0000, v95
    v_cvt_pk_bf16_f32 v96, v90, v91
    v_cvt_pk_bf16_f32 v97, v92, v93
    v_lshlrev_b32 v90, 16, v96
    v_and_b32 v91, 0xffff0000, v96
    v_lshlrev_b32 v92, 16, v97
    v_and_b32 v93, 0xffff0000, v97
    v_pk_add_f32 v[74:75], v[74:75], v[90:91]
    v_pk_add_f32 v[76:77], v[76:77], v[92:93]
    v_cvt_pk_bf16_f32 v106, v74, v75
    v_cvt_pk_bf16_f32 v107, v76, v77
    v_lshlrev_b32 v98, 16, v138
    v_and_b32 v99, 0xffff0000, v138
    v_lshlrev_b32 v100, 16, v139
    v_and_b32 v101, 0xffff0000, v139
    v_pk_mul_f32 v[98:99], v[98:99], s[30:31]
    v_pk_mul_f32 v[100:101], v[100:101], s[30:31]
    v_cvt_pk_bf16_f32 v102, v78, v79
    v_cvt_pk_bf16_f32 v103, v80, v81
    v_lshlrev_b32 v78, 16, v102
    v_and_b32 v79, 0xffff0000, v102
    v_lshlrev_b32 v80, 16, v103
    v_and_b32 v81, 0xffff0000, v103
    v_cvt_pk_bf16_f32 v104, v98, v99
    v_cvt_pk_bf16_f32 v105, v100, v101
    v_lshlrev_b32 v98, 16, v104
    v_and_b32 v99, 0xffff0000, v104
    v_lshlrev_b32 v100, 16, v105
    v_and_b32 v101, 0xffff0000, v105
    v_pk_add_f32 v[78:79], v[78:79], v[98:99]
    v_pk_add_f32 v[80:81], v[80:81], v[100:101]
    v_cvt_pk_bf16_f32 v108, v78, v79
    v_cvt_pk_bf16_f32 v109, v80, v81
    s_nop 1
    v_permlane16_swap_b32 v106, v108
    v_permlane16_swap_b32 v107, v109
    buffer_store_dwordx4 v[106:109], v20, s[36:39], 0 offen offset:2048 sc1
    v_lshlrev_b32 v90, 16, v140
    v_and_b32 v91, 0xffff0000, v140
    v_lshlrev_b32 v92, 16, v141
    v_and_b32 v93, 0xffff0000, v141
    v_pk_mul_f32 v[90:91], v[90:91], s[30:31]
    v_pk_mul_f32 v[92:93], v[92:93], s[30:31]
    v_cvt_pk_bf16_f32 v94, v82, v83
    v_cvt_pk_bf16_f32 v95, v84, v85
    v_lshlrev_b32 v82, 16, v94
    v_and_b32 v83, 0xffff0000, v94
    v_lshlrev_b32 v84, 16, v95
    v_and_b32 v85, 0xffff0000, v95
    v_cvt_pk_bf16_f32 v96, v90, v91
    v_cvt_pk_bf16_f32 v97, v92, v93
    v_lshlrev_b32 v90, 16, v96
    v_and_b32 v91, 0xffff0000, v96
    v_lshlrev_b32 v92, 16, v97
    v_and_b32 v93, 0xffff0000, v97
    v_pk_add_f32 v[82:83], v[82:83], v[90:91]
    v_pk_add_f32 v[84:85], v[84:85], v[92:93]
    v_cvt_pk_bf16_f32 v110, v82, v83
    v_cvt_pk_bf16_f32 v111, v84, v85
    v_lshlrev_b32 v98, 16, v142
    v_and_b32 v99, 0xffff0000, v142
    v_lshlrev_b32 v100, 16, v143
    v_and_b32 v101, 0xffff0000, v143
    v_pk_mul_f32 v[98:99], v[98:99], s[30:31]
    v_pk_mul_f32 v[100:101], v[100:101], s[30:31]
    v_cvt_pk_bf16_f32 v102, v86, v87
    v_cvt_pk_bf16_f32 v103, v88, v89
    v_lshlrev_b32 v86, 16, v102
    v_and_b32 v87, 0xffff0000, v102
    v_lshlrev_b32 v88, 16, v103
    v_and_b32 v89, 0xffff0000, v103
    v_cvt_pk_bf16_f32 v104, v98, v99
    v_cvt_pk_bf16_f32 v105, v100, v101
    v_lshlrev_b32 v98, 16, v104
    v_and_b32 v99, 0xffff0000, v104
    v_lshlrev_b32 v100, 16, v105
    v_and_b32 v101, 0xffff0000, v105
    v_pk_add_f32 v[86:87], v[86:87], v[98:99]
    v_pk_add_f32 v[88:89], v[88:89], v[100:101]
    v_cvt_pk_bf16_f32 v112, v86, v87
    v_cvt_pk_bf16_f32 v113, v88, v89
    s_nop 1
    v_permlane16_swap_b32 v110, v112
    v_permlane16_swap_b32 v111, v113
    buffer_store_dwordx4 v[110:113], v20, s[36:39], 0 offen offset:3072 sc1
    s_waitcnt vmcnt(0)
    v_mov_b32 v8, 163824
    v_mov_b32 v9, 1
    s_mov_b64 exec, 1
    ds_add_rtn_u32 v9, v8, v9
    s_waitcnt lgkmcnt(0)
    s_mov_b64 exec, -1
    v_readfirstlane_b32 s24, v9
    s_cmp_lg_u32 s24, 11
    s_cbranch_scc1 a_sig9
    v_mov_b32 v8, 163836
    ds_read_b32 v8, v8
    s_waitcnt lgkmcnt(0)
    v_readfirstlane_b32 s97, v8
    s_nop 1
    v_and_b32 v8, 3, v1
    v_lshlrev_b32 v8, 3, v8
    v_bfe_u32 v10, v1, 2, 3
    s_lshr_b32 s76, s3, 3
    s_lshl_b32 s76, s76, 5
    v_add3_u32 v8, v8, v10, s76
    v_lshlrev_b32 v8, 10, v8
    s_and_b32 s76, s3, 7
    s_lshl_b32 s76, s76, 2
    s_add_u32 s76, s76, 304
    v_add_u32 v8, s76, v8
    s_lshr_b32 s76, s3, 1
    s_and_b32 s77, s76, 3
    s_lshl_b32 s77, s77, 3
    s_lshr_b32 s76, s76, 2
    s_add_u32 s76, s76, s77
    v_and_b32 v10, 7, v1
    v_lshlrev_b32 v10, 5, v10
    v_add_u32 v10, s76, v10
    v_lshlrev_b32 v10, 10, v10
    s_and_b32 s76, s3, 1
    s_lshl_b32 s76, s76, 2
    s_add_u32 s76, s76, 336
    v_add_u32 v10, s76, v10
    v_cmp_gt_u32 vcc, 32, v1
    s_nop 1
    v_cndmask_b32 v8, v10, v8, vcc
    s_mov_b32 vcc_lo, -1
    s_mov_b32 vcc_hi, 0xff
    v_mov_b32 v9, s97
    s_mov_b64 exec, vcc
    buffer_store_dword v9, v8, s[88:91], 0 offen sc1
    s_mov_b64 exec, -1
a_sig9:
    s_branch f_phase3
a_xw1:
    s_getpc_b64 s[24:25]
f_pcref:
    s_sub_u32 s24, s24, f_pcref - f_start
    s_subb_u32 s25, s25, 0
    s_lshr_b32 s26, s3, 3
    s_lshl_b32 s26, s26, 1
    s_add_u32 s26, s26, s96
    s_sub_u32 s26, s26, 10
    s_min_u32 s26, s26, (f_end - f_start) / 3072 - 1
    s_mul_i32 s26, s26, 3072
    v_lshlrev_b32 v2, 4, v1
    v_add_u32 v2, s26, v2
    v_mov_b32 v3, s25
    v_add_co_u32 v2, vcc, s24, v2
    s_nop 1
    v_addc_co_u32 v3, vcc, 0, v3, vcc
    global_load_dwordx4 v[164:167], v[2:3], off offset:0
    global_load_dwordx4 v[164:167], v[2:3], off offset:1024
    global_load_dwordx4 v[164:167], v[2:3], off offset:2048
    s_load_dwordx2 s[4:5], s[0:1], 0
    s_load_dwordx2 s[6:7], s[0:1], 112
    s_load_dwordx2 s[8:9], s[0:1], 88
    s_load_dwordx2 s[10:11], s[0:1], 104
    s_sub_u32 s23, s96, 10
    v_and_b32 v5, 15, v1
    v_lshrrev_b32 v6, 4, v1
    v_lshlrev_b32 v7, 4, v5
    v_mul_u32_u24 v4, 1280, v6
    v_add_u32 v4, v4, v7
    s_lshl_b32 s26, s3, 1
    s_add_u32 s26, s26, s23
    s_mul_i32 s24, s26, 20480
    s_waitcnt lgkmcnt(0)
    s_mov_b32 s52, s92
    s_mov_b32 s53, s93
    s_mov_b32 s54, 0x100
    s_mov_b32 s55, 0x00020000
    s_memrealtime s[76:77]
    v_mov_b32 v161, 0
    v_mov_b32 v162, 0
    s_waitcnt lgkmcnt(0)
    s_or_b32 s76, s76, 1
    v_mov_b32 v160, s76
    v_mov_b32 v163, s76
    s_mov_b64 exec, 1
    buffer_atomic_cmpswap v[160:161], v162, s[52:55], 0 offen sc0 sc1
    s_mov_b64 exec, -1
    s_add_u32 s88, s94, 0x1400000
    s_addc_u32 s89, s95, 0
    s_mov_b32 s90, 0x40000
    s_mov_b32 s91, 0x00020000
    v_add_u32 v113, 0, v1
    v_mul_u32_u24 v114, 0x6667, v113
    v_lshrrev_b32 v114, 18, v114
    v_mul_u32_u24 v115, 10, v114
    v_sub_u32 v115, v113, v115
    v_mul_u32_u24 v114, 1280, v114
    v_lshl_add_u32 v108, v115, 4, v114
    v_add_u32 v113, 64, v1
    v_mul_u32_u24 v114, 0x6667, v113
    v_lshrrev_b32 v114, 18, v114
    v_mul_u32_u24 v115, 10, v114
    v_sub_u32 v115, v113, v115
    v_mul_u32_u24 v114, 1280, v114
    v_lshl_add_u32 v109, v115, 4, v114
    v_add_u32 v113, 128, v1
    v_mul_u32_u24 v114, 0x6667, v113
    v_lshrrev_b32 v114, 18, v114
    v_mul_u32_u24 v115, 10, v114
    v_sub_u32 v115, v113, v115
    v_mul_u32_u24 v114, 1280, v114
    v_lshl_add_u32 v110, v115, 4, v114
    v_add_u32 v113, 192, v1
    v_mul_u32_u24 v114, 0x6667, v113
    v_lshrrev_b32 v114, 18, v114
    v_mul_u32_u24 v115, 10, v114
    v_sub_u32 v115, v113, v115
    v_mul_u32_u24 v114, 1280, v114
    v_lshl_add_u32 v111, v115, 4, v114
    v_add_u32 v113, 256, v1
    v_mul_u32_u24 v114, 0x6667, v113
    v_lshrrev_b32 v114, 18, v114
    v_mul_u32_u24 v115, 10, v114
    v_sub_u32 v115, v113, v115
    v_mul_u32_u24 v114, 1280, v114
    v_lshl_add_u32 v112, v115, 4, v114
    s_lshr_b32 s24, s3, 3
    s_mul_i32 s25, s24, 160
    s_add_u32 s44, s10, s25
    s_addc_u32 s45, s11, 0
    s_mov_b32 s46, 0xefba0
    s_mov_b32 s47, 0x00020000
    s_mul_i32 s24, s24, 122880
    s_add_u32 s24, s24, 22020096
    s_add_u32 s32, s94, s24
    s_addc_u32 s33, s95, 0
    s_mov_b32 s34, 0x1e000
    s_mov_b32 s35, 0x00020000
    s_and_b32 s26, s3, 7
    s_mul_i32 s26, s26, 3
    s_lshl_b32 s24, s23, 1
    s_add_u32 s26, s26, s24
    s_mul_i32 s60, s23, 10240
    s_add_u32 s60, s60, 144640
    s_add_u32 s24, s26, 0
    s_mul_i32 s25, s24, 40960
    s_add_u32 m0, s60, 0
    s_nop 0
    buffer_load_dwordx4 v108, s[44:47], s25 offen lds
    s_add_u32 m0, s60, 1024
    s_nop 0
    buffer_load_dwordx4 v109, s[44:47], s25 offen lds
    s_add_u32 m0, s60, 2048
    s_nop 0
    buffer_load_dwordx4 v110, s[44:47], s25 offen lds
    s_add_u32 m0, s60, 3072
    s_nop 0
    buffer_load_dwordx4 v111, s[44:47], s25 offen lds
    s_add_u32 m0, s60, 4096
    s_nop 0
    buffer_load_dwordx4 v112, s[44:47], s25 offen lds
    s_cmp_lg_u32 s23, 0
    s_cbranch_scc1 a_fw110
    s_add_u32 s24, s26, 1
    s_mul_i32 s25, s24, 40960
    s_add_u32 m0, s60, 5120
    s_nop 0
    buffer_load_dwordx4 v108, s[44:47], s25 offen lds
    s_add_u32 m0, s60, 6144
    s_nop 0
    buffer_load_dwordx4 v109, s[44:47], s25 offen lds
    s_add_u32 m0, s60, 7168
    s_nop 0
    buffer_load_dwordx4 v110, s[44:47], s25 offen lds
    s_add_u32 m0, s60, 8192
    s_nop 0
    buffer_load_dwordx4 v111, s[44:47], s25 offen lds
    s_add_u32 m0, s60, 9216
    s_nop 0
    buffer_load_dwordx4 v112, s[44:47], s25 offen lds
a_fw110:
    v_lshrrev_b32 v2, 2, v5
    v_lshl_add_u32 v2, v6, 3, v2
    v_mul_u32_u24 v2, 160, v2
    v_and_b32 v3, 3, v1
    v_lshl_add_u32 v2, v3, 3, v2
    v_add_u32 v2, s60, v2
    v_lshlrev_b32 v3, 4, v1
    s_waitcnt vmcnt(0)
    ds_read_b64_tr_b16 v[8:9], v2 offset:0
    ds_read_b64_tr_b16 v[10:11], v2 offset:640
    ds_read_b64_tr_b16 v[12:13], v2 offset:32
    ds_read_b64_tr_b16 v[14:15], v2 offset:672
    ds_read_b64_tr_b16 v[16:17], v2 offset:64
    ds_read_b64_tr_b16 v[18:19], v2 offset:704
    ds_read_b64_tr_b16 v[20:21], v2 offset:96
    ds_read_b64_tr_b16 v[22:23], v2 offset:736
    ds_read_b64_tr_b16 v[24:25], v2 offset:128
    ds_read_b64_tr_b16 v[26:27], v2 offset:768
    s_add_u32 s24, s26, 0
    s_lshl_b32 s24, s24, 10
    s_waitcnt lgkmcnt(0)
    buffer_store_dwordx4 v[8:11], v3, s[32:35], s24 offen sc1
    s_add_u32 s24, s24, 24576
    buffer_store_dwordx4 v[12:15], v3, s[32:35], s24 offen sc1
    s_add_u32 s24, s24, 24576
    buffer_store_dwordx4 v[16:19], v3, s[32:35], s24 offen sc1
    s_add_u32 s24, s24, 24576
    buffer_store_dwordx4 v[20:23], v3, s[32:35], s24 offen sc1
    s_add_u32 s24, s24, 24576
    buffer_store_dwordx4 v[24:27], v3, s[32:35], s24 offen sc1
    s_cmp_lg_u32 s23, 0
    s_cbranch_scc1 a_fw211
    ds_read_b64_tr_b16 v[28:29], v2 offset:5120
    ds_read_b64_tr_b16 v[30:31], v2 offset:5760
    ds_read_b64_tr_b16 v[32:33], v2 offset:5152
    ds_read_b64_tr_b16 v[34:35], v2 offset:5792
    ds_read_b64_tr_b16 v[36:37], v2 offset:5184
    ds_read_b64_tr_b16 v[38:39], v2 offset:5824
    ds_read_b64_tr_b16 v[40:41], v2 offset:5216
    ds_read_b64_tr_b16 v[42:43], v2 offset:5856
    ds_read_b64_tr_b16 v[44:45], v2 offset:5248
    ds_read_b64_tr_b16 v[46:47], v2 offset:5888
    s_add_u32 s24, s26, 1
    s_lshl_b32 s24, s24, 10
    s_waitcnt lgkmcnt(0)
    buffer_store_dwordx4 v[28:31], v3, s[32:35], s24 offen sc1
    s_add_u32 s24, s24, 24576
    buffer_store_dwordx4 v[32:35], v3, s[32:35], s24 offen sc1
    s_add_u32 s24, s24, 24576
    buffer_store_dwordx4 v[36:39], v3, s[32:35], s24 offen sc1
    s_add_u32 s24, s24, 24576
    buffer_store_dwordx4 v[40:43], v3, s[32:35], s24 offen sc1
    s_add_u32 s24, s24, 24576
    buffer_store_dwordx4 v[44:47], v3, s[32:35], s24 offen sc1
a_fw211:
    s_waitcnt vmcnt(0)
    v_cmp_eq_u32 vcc, 0, v160
    s_nop 1
    v_cndmask_b32 v160, v160, v163, vcc
    s_nop 0
    v_readfirstlane_b32 s97, v160
    s_nop 1
    v_and_b32 v96, 3, v1
    v_lshlrev_b32 v96, 3, v96
    v_bfe_u32 v98, v1, 2, 3
    s_lshr_b32 s76, s3, 3
    s_lshl_b32 s76, s76, 5
    v_add3_u32 v96, v96, v98, s76
    v_lshlrev_b32 v96, 10, v96
    s_and_b32 s76, s3, 7
    s_lshl_b32 s76, s76, 1
    s_add_u32 s76, s76, s23
    s_lshl_b32 s76, s76, 2
    s_add_u32 s76, s76, 640
    v_add_u32 v96, s76, v96
    s_mov_b32 vcc_lo, -1
    s_mov_b32 vcc_hi, 0
    v_mov_b32 v97, s97
    s_mov_b64 exec, vcc
    buffer_store_dword v97, v96, s[88:91], 0 offen sc1
    s_mov_b64 exec, -1
    s_mul_i32 s25, s3, 40960
    s_add_u32 s56, s4, s25
    s_addc_u32 s57, s5, 0
    s_mov_b32 s58, 0xa000
    s_mov_b32 s59, 0x00020000
    s_add_u32 s48, s94, 0x900000
    s_addc_u32 s49, s95, 0
    s_mov_b32 s50, 0x294000
    s_mov_b32 s51, 0x00020000
    v_lshrrev_b32 v8, 3, v1
    v_and_b32 v9, 7, v1
    v_lshrrev_b32 v10, 1, v8
    v_xor_b32 v10, v9, v10
    v_lshlrev_b32 v10, 4, v10
    v_mul_u32_u24 v11, 1280, v8
    v_add_u32 v12, v11, v10
    v_xor_b32 v10, 64, v10
    v_add_u32 v13, v11, v10
    v_add_u32 v14, 18432, v12
    v_add_u32 v15, 27648, v13
    v_add_u32 v13, 9216, v13
    s_mul_i32 s60, s23, 10240
    s_add_u32 s60, s60, 144640
    s_mul_i32 s61, s23, 640
    s_add_u32 m0, s60, 0
    s_add_u32 s25, s61, 0
    buffer_load_dwordx4 v12, s[56:59], s25 offen offset:0 lds
    buffer_load_dwordx4 v13, s[56:59], s25 offen offset:1024 lds
    buffer_load_dwordx4 v14, s[56:59], s25 offen offset:2048 lds
    buffer_load_dwordx4 v15, s[56:59], s25 offen offset:3072 lds
    s_add_u32 m0, s60, 4096
    s_add_u32 s25, s61, 128
    buffer_load_dwordx4 v12, s[56:59], s25 offen offset:0 lds
    buffer_load_dwordx4 v13, s[56:59], s25 offen offset:1024 lds
    buffer_load_dwordx4 v14, s[56:59], s25 offen offset:2048 lds
    buffer_load_dwordx4 v15, s[56:59], s25 offen offset:3072 lds
    v_lshrrev_b32 v8, 2, v5
    v_lshl_add_u32 v9, v6, 3, v8
    v_lshrrev_b32 v10, 1, v9
    v_and_b32 v10, 7, v10
    v_and_b32 v11, 3, v1
    v_lshrrev_b32 v8, 1, v11
    v_xor_b32 v8, v8, v10
    v_lshlrev_b32 v8, 4, v8
    v_lshl_add_u32 v8, v9, 7, v8
    v_and_b32 v11, 1, v11
    v_lshl_add_u32 v8, v11, 3, v8
    v_add_u32 v16, s60, v8
    v_xor_b32 v17, 32, v16
    v_xor_b32 v18, 64, v16
    v_xor_b32 v19, 96, v16
    v_mul_u32_u24 v8, 4224, v5
    v_lshl_add_u32 v20, v6, 4, v8
    v_add_u32 v21, 67584, v20
    v_add_u32 v22, 135168, v20
    v_add_u32 v23, 202752, v20
    s_mul_i32 s62, s23, 1351680
    s_lshl_b32 s63, s3, 6
    s_add_u32 s62, s62, s63
    s_add_u32 s62, s62, 64
    s_waitcnt vmcnt(4)
    ds_read_b64_tr_b16 v[24:25], v16 offset:0
    ds_read_b64_tr_b16 v[26:27], v17 offset:512
    ds_read_b64_tr_b16 v[28:29], v17 offset:0
    ds_read_b64_tr_b16 v[30:31], v16 offset:512
    ds_read_b64_tr_b16 v[32:33], v18 offset:0
    ds_read_b64_tr_b16 v[34:35], v19 offset:512
    ds_read_b64_tr_b16 v[36:37], v19 offset:0
    ds_read_b64_tr_b16 v[38:39], v18 offset:512
    s_add_u32 s25, s62, 0
    s_waitcnt lgkmcnt(0)
    buffer_store_dwordx4 v[24:27], v20, s[48:51], s25 offen sc1
    buffer_store_dwordx4 v[28:31], v21, s[48:51], s25 offen sc1
    buffer_store_dwordx4 v[32:35], v22, s[48:51], s25 offen sc1
    buffer_store_dwordx4 v[36:39], v23, s[48:51], s25 offen sc1
    s_add_u32 m0, s60, 0
    s_add_u32 s25, s61, 256
    buffer_load_dwordx4 v12, s[56:59], s25 offen offset:0 lds
    buffer_load_dwordx4 v13, s[56:59], s25 offen offset:1024 lds
    buffer_load_dwordx4 v14, s[56:59], s25 offen offset:2048 lds
    buffer_load_dwordx4 v15, s[56:59], s25 offen offset:3072 lds
    s_waitcnt vmcnt(8)
    ds_read_b64_tr_b16 v[40:41], v16 offset:4096
    ds_read_b64_tr_b16 v[42:43], v17 offset:4608
    ds_read_b64_tr_b16 v[44:45], v17 offset:4096
    ds_read_b64_tr_b16 v[46:47], v16 offset:4608
    ds_read_b64_tr_b16 v[48:49], v18 offset:4096
    ds_read_b64_tr_b16 v[50:51], v19 offset:4608
    ds_read_b64_tr_b16 v[52:53], v19 offset:4096
    ds_read_b64_tr_b16 v[54:55], v18 offset:4608
    s_add_u32 s25, s62, 270336
    s_waitcnt lgkmcnt(0)
    buffer_store_dwordx4 v[40:43], v20, s[48:51], s25 offen sc1
    buffer_store_dwordx4 v[44:47], v21, s[48:51], s25 offen sc1
    buffer_store_dwordx4 v[48:51], v22, s[48:51], s25 offen sc1
    buffer_store_dwordx4 v[52:55], v23, s[48:51], s25 offen sc1
    s_add_u32 m0, s60, 4096
    s_add_u32 s25, s61, 384
    buffer_load_dwordx4 v12, s[56:59], s25 offen offset:0 lds
    buffer_load_dwordx4 v13, s[56:59], s25 offen offset:1024 lds
    buffer_load_dwordx4 v14, s[56:59], s25 offen offset:2048 lds
    buffer_load_dwordx4 v15, s[56:59], s25 offen offset:3072 lds
    s_waitcnt vmcnt(8)
    ds_read_b64_tr_b16 v[24:25], v16 offset:0
    ds_read_b64_tr_b16 v[26:27], v17 offset:512
    ds_read_b64_tr_b16 v[28:29], v17 offset:0
    ds_read_b64_tr_b16 v[30:31], v16 offset:512
    ds_read_b64_tr_b16 v[32:33], v18 offset:0
    ds_read_b64_tr_b16 v[34:35], v19 offset:512
    ds_read_b64_tr_b16 v[36:37], v19 offset:0
    ds_read_b64_tr_b16 v[38:39], v18 offset:512
    s_add_u32 s25, s62, 540672
    s_waitcnt lgkmcnt(0)
    buffer_store_dwordx4 v[24:27], v20, s[48:51], s25 offen sc1
    buffer_store_dwordx4 v[28:31], v21, s[48:51], s25 offen sc1
    buffer_store_dwordx4 v[32:35], v22, s[48:51], s25 offen sc1
    buffer_store_dwordx4 v[36:39], v23, s[48:51], s25 offen sc1
    s_add_u32 m0, s60, 0
    s_add_u32 s25, s61, 512
    buffer_load_dwordx4 v12, s[56:59], s25 offen offset:0 lds
    buffer_load_dwordx4 v13, s[56:59], s25 offen offset:1024 lds
    buffer_load_dwordx4 v14, s[56:59], s25 offen offset:2048 lds
    buffer_load_dwordx4 v15, s[56:59], s25 offen offset:3072 lds
    s_waitcnt vmcnt(8)
    ds_read_b64_tr_b16 v[40:41], v16 offset:4096
    ds_read_b64_tr_b16 v[42:43], v17 offset:4608
    ds_read_b64_tr_b16 v[44:45], v17 offset:4096
    ds_read_b64_tr_b16 v[46:47], v16 offset:4608
    ds_read_b64_tr_b16 v[48:49], v18 offset:4096
    ds_read_b64_tr_b16 v[50:51], v19 offset:4608
    ds_read_b64_tr_b16 v[52:53], v19 offset:4096
    ds_read_b64_tr_b16 v[54:55], v18 offset:4608
    s_add_u32 s25, s62, 811008
    s_waitcnt lgkmcnt(0)
    buffer_store_dwordx4 v[40:43], v20, s[48:51], s25 offen sc1
    buffer_store_dwordx4 v[44:47], v21, s[48:51], s25 offen sc1
    buffer_store_dwordx4 v[48:51], v22, s[48:51], s25 offen sc1
    buffer_store_dwordx4 v[52:55], v23, s[48:51], s25 offen sc1
    s_waitcnt vmcnt(4)
    ds_read_b64_tr_b16 v[24:25], v16 offset:0
    ds_read_b64_tr_b16 v[26:27], v17 offset:512
    ds_read_b64_tr_b16 v[28:29], v17 offset:0
    ds_read_b64_tr_b16 v[30:31], v16 offset:512
    ds_read_b64_tr_b16 v[32:33], v18 offset:0
    ds_read_b64_tr_b16 v[34:35], v19 offset:512
    ds_read_b64_tr_b16 v[36:37], v19 offset:0
    ds_read_b64_tr_b16 v[38:39], v18 offset:512
    s_add_u32 s25, s62, 1081344
    s_waitcnt lgkmcnt(0)
    buffer_store_dwordx4 v[24:27], v20, s[48:51], s25 offen sc1
    buffer_store_dwordx4 v[28:31], v21, s[48:51], s25 offen sc1
    buffer_store_dwordx4 v[32:35], v22, s[48:51], s25 offen sc1
    buffer_store_dwordx4 v[36:39], v23, s[48:51], s25 offen sc1
    s_lshl_b32 s24, s3, 17
    s_add_u32 s52, s8, s24
    s_addc_u32 s53, s9, 0
    s_mov_b32 s54, 0x20000
    s_mov_b32 s55, 0x00020000
    s_mul_i32 s24, s3, 15360
    s_add_u32 s56, s10, s24
    s_addc_u32 s57, s11, 0
    s_mov_b32 s58, 0x3c00
    s_mov_b32 s59, 0x00020000
    v_lshlrev_b32 v116, 4, v1
    s_cmp_lg_u32 s23, 0
    s_cbranch_scc1 a_xw112
    v_cmp_eq_u32 vcc, 0, v160
    v_mov_b32 v162, 163836
    s_nop 0
    v_cndmask_b32 v160, v160, v163, vcc
    s_mov_b64 exec, 1
    ds_write_b32 v162, v160
    s_mov_b64 exec, -1
    s_waitcnt lgkmcnt(0)
a_xw112:
    s_waitcnt vmcnt(0)
    v_lshlrev_b32 v96, 10, v1
    s_lshl_b32 s76, s3, 2
    s_add_u32 s76, s76, 196992
    s_mul_i32 s77, s23, 384
    s_add_u32 s76, s76, s77
    v_add_u32 v96, s76, v96
    s_mov_b64 vcc, -1
    v_mov_b32 v97, s97
    buffer_store_dword v97, v96, s[88:91], 0 offen sc1
    s_barrier
    s_setprio 3
    s_lshl_b32 s24, s23, 16
    s_add_u32 s25, s24, 65536
a_pfl13:
    buffer_load_dwordx4 v[156:159], v116, s[52:55], s24 offen offset:0
    buffer_load_dwordx4 v[156:159], v116, s[52:55], s24 offen offset:1024
    buffer_load_dwordx4 v[156:159], v116, s[52:55], s24 offen offset:2048
    buffer_load_dwordx4 v[156:159], v116, s[52:55], s24 offen offset:3072
    s_add_u32 s24, s24, 4096
    s_cmp_lt_u32 s24, s25
    s_cbranch_scc1 a_pfl13
    s_setprio 0
    s_lshl_b32 s26, s3, 1
    s_add_u32 s26, s26, s23
    s_mul_i32 s24, s26, 20480
    v_lshlrev_b32 v7, 4, v5
    v_mul_u32_u24 v4, 1280, v6
    v_add_u32 v4, v4, v7
    s_add_u32 s48, s4, s24
    s_addc_u32 s49, s5, 0
    s_mov_b32 s50, 0x5000
    s_mov_b32 s51, 0x00020000
    s_mov_b32 s36, s6
    s_mov_b32 s37, s7
    s_mov_b32 s38, 0x500
    s_mov_b32 s39, 0x00020000
    s_lshl_b32 s24, s26, 7
    s_add_u32 s24, s24, 16777216
    s_add_u32 s40, s94, s24
    s_addc_u32 s41, s95, 0
    s_mov_b32 s42, 0x80
    s_mov_b32 s43, 0x00020000
    buffer_load_dwordx4 v[8:11], v7, s[36:39], 0 offen offset:0
    buffer_load_dwordx4 v[12:15], v7, s[36:39], 0 offen offset:256
    buffer_load_dwordx4 v[16:19], v7, s[36:39], 0 offen offset:512
    buffer_load_dwordx4 v[20:23], v7, s[36:39], 0 offen offset:768
    buffer_load_dwordx4 v[24:27], v7, s[36:39], 0 offen offset:1024
    s_movk_i32 s25, 0
    buffer_load_dwordx4 v[68:71], v4, s[48:51], s25 offen offset:0
    buffer_load_dwordx4 v[72:75], v4, s[48:51], s25 offen offset:256
    buffer_load_dwordx4 v[76:79], v4, s[48:51], s25 offen offset:512
    buffer_load_dwordx4 v[80:83], v4, s[48:51], s25 offen offset:768
    buffer_load_dwordx4 v[84:87], v4, s[48:51], s25 offen offset:1024
    s_movk_i32 s25, 5120
    buffer_load_dwordx4 v[88:91], v4, s[48:51], s25 offen offset:0
    buffer_load_dwordx4 v[92:95], v4, s[48:51], s25 offen offset:256
    buffer_load_dwordx4 v[96:99], v4, s[48:51], s25 offen offset:512
    buffer_load_dwordx4 v[100:103], v4, s[48:51], s25 offen offset:768
    buffer_load_dwordx4 v[104:107], v4, s[48:51], s25 offen offset:1024
    s_movk_i32 s25, 10240
    buffer_load_dwordx4 v[108:111], v4, s[48:51], s25 offen offset:0
    buffer_load_dwordx4 v[112:115], v4, s[48:51], s25 offen offset:256
    buffer_load_dwordx4 v[116:119], v4, s[48:51], s25 offen offset:512
    buffer_load_dwordx4 v[120:123], v4, s[48:51], s25 offen offset:768
    buffer_load_dwordx4 v[124:127], v4, s[48:51], s25 offen offset:1024
    s_movk_i32 s25, 15360
    buffer_load_dwordx4 v[128:131], v4, s[48:51], s25 offen offset:0
    buffer_load_dwordx4 v[132:135], v4, s[48:51], s25 offen offset:256
    buffer_load_dwordx4 v[136:139], v4, s[48:51], s25 offen offset:512
    buffer_load_dwordx4 v[140:143], v4, s[48:51], s25 offen offset:768
    buffer_load_dwordx4 v[144:147], v4, s[48:51], s25 offen offset:1024
    v_lshlrev_b32 v3, 3, v6
    s_waitcnt vmcnt(20)
    v_lshlrev_b32 v28, 16, v8
    v_and_b32 v29, 0xffff0000, v8
    v_lshlrev_b32 v30, 16, v9
    v_and_b32 v31, 0xffff0000, v9
    v_lshlrev_b32 v32, 16, v10
    v_and_b32 v33, 0xffff0000, v10
    v_lshlrev_b32 v34, 16, v11
    v_and_b32 v35, 0xffff0000, v11
    v_lshlrev_b32 v36, 16, v12
    v_and_b32 v37, 0xffff0000, v12
    v_lshlrev_b32 v38, 16, v13
    v_and_b32 v39, 0xffff0000, v13
    v_lshlrev_b32 v40, 16, v14
    v_and_b32 v41, 0xffff0000, v14
    v_lshlrev_b32 v42, 16, v15
    v_and_b32 v43, 0xffff0000, v15
    v_lshlrev_b32 v44, 16, v16
    v_and_b32 v45, 0xffff0000, v16
    v_lshlrev_b32 v46, 16, v17
    v_and_b32 v47, 0xffff0000, v17
    v_lshlrev_b32 v48, 16, v18
    v_and_b32 v49, 0xffff0000, v18
    v_lshlrev_b32 v50, 16, v19
    v_and_b32 v51, 0xffff0000, v19
    v_lshlrev_b32 v52, 16, v20
    v_and_b32 v53, 0xffff0000, v20
    v_lshlrev_b32 v54, 16, v21
    v_and_b32 v55, 0xffff0000, v21
    v_lshlrev_b32 v56, 16, v22
    v_and_b32 v57, 0xffff0000, v22
    v_lshlrev_b32 v58, 16, v23
    v_and_b32 v59, 0xffff0000, v23
    v_lshlrev_b32 v60, 16, v24
    v_and_b32 v61, 0xffff0000, v24
    v_lshlrev_b32 v62, 16, v25
    v_and_b32 v63, 0xffff0000, v25
    v_lshlrev_b32 v64, 16, v26
    v_and_b32 v65, 0xffff0000, v26
    v_lshlrev_b32 v66, 16, v27
    v_and_b32 v67, 0xffff0000, v27
    s_waitcnt vmcnt(15)
    v_mov_b32 v8, 0
    v_mov_b32 v9, 0
    v_lshlrev_b32 v148, 16, v68
    v_and_b32 v149, 0xffff0000, v68
    v_lshlrev_b32 v150, 16, v69
    v_and_b32 v151, 0xffff0000, v69
    v_pk_mul_f32 v[148:149], v[148:149], v[28:29]
    v_pk_mul_f32 v[150:151], v[150:151], v[30:31]
    v_cvt_pk_bf16_f32 v152, v148, v149
    v_cvt_pk_bf16_f32 v153, v150, v151
    v_lshlrev_b32 v148, 16, v152
    v_and_b32 v149, 0xffff0000, v152
    v_lshlrev_b32 v150, 16, v153
    v_and_b32 v151, 0xffff0000, v153
    v_pk_add_f32 v[8:9], v[8:9], v[148:149]
    v_pk_add_f32 v[8:9], v[8:9], v[150:151]
    v_lshlrev_b32 v148, 16, v70
    v_and_b32 v149, 0xffff0000, v70
    v_lshlrev_b32 v150, 16, v71
    v_and_b32 v151, 0xffff0000, v71
    v_pk_mul_f32 v[148:149], v[148:149], v[32:33]
    v_pk_mul_f32 v[150:151], v[150:151], v[34:35]
    v_cvt_pk_bf16_f32 v152, v148, v149
    v_cvt_pk_bf16_f32 v153, v150, v151
    v_lshlrev_b32 v148, 16, v152
    v_and_b32 v149, 0xffff0000, v152
    v_lshlrev_b32 v150, 16, v153
    v_and_b32 v151, 0xffff0000, v153
    v_pk_add_f32 v[8:9], v[8:9], v[148:149]
    v_pk_add_f32 v[8:9], v[8:9], v[150:151]
    v_lshlrev_b32 v148, 16, v72
    v_and_b32 v149, 0xffff0000, v72
    v_lshlrev_b32 v150, 16, v73
    v_and_b32 v151, 0xffff0000, v73
    v_pk_mul_f32 v[148:149], v[148:149], v[36:37]
    v_pk_mul_f32 v[150:151], v[150:151], v[38:39]
    v_cvt_pk_bf16_f32 v152, v148, v149
    v_cvt_pk_bf16_f32 v153, v150, v151
    v_lshlrev_b32 v148, 16, v152
    v_and_b32 v149, 0xffff0000, v152
    v_lshlrev_b32 v150, 16, v153
    v_and_b32 v151, 0xffff0000, v153
    v_pk_add_f32 v[8:9], v[8:9], v[148:149]
    v_pk_add_f32 v[8:9], v[8:9], v[150:151]
    v_lshlrev_b32 v148, 16, v74
    v_and_b32 v149, 0xffff0000, v74
    v_lshlrev_b32 v150, 16, v75
    v_and_b32 v151, 0xffff0000, v75
    v_pk_mul_f32 v[148:149], v[148:149], v[40:41]
    v_pk_mul_f32 v[150:151], v[150:151], v[42:43]
    v_cvt_pk_bf16_f32 v152, v148, v149
    v_cvt_pk_bf16_f32 v153, v150, v151
    v_lshlrev_b32 v148, 16, v152
    v_and_b32 v149, 0xffff0000, v152
    v_lshlrev_b32 v150, 16, v153
    v_and_b32 v151, 0xffff0000, v153
    v_pk_add_f32 v[8:9], v[8:9], v[148:149]
    v_pk_add_f32 v[8:9], v[8:9], v[150:151]
    v_lshlrev_b32 v148, 16, v76
    v_and_b32 v149, 0xffff0000, v76
    v_lshlrev_b32 v150, 16, v77
    v_and_b32 v151, 0xffff0000, v77
    v_pk_mul_f32 v[148:149], v[148:149], v[44:45]
    v_pk_mul_f32 v[150:151], v[150:151], v[46:47]
    v_cvt_pk_bf16_f32 v152, v148, v149
    v_cvt_pk_bf16_f32 v153, v150, v151
    v_lshlrev_b32 v148, 16, v152
    v_and_b32 v149, 0xffff0000, v152
    v_lshlrev_b32 v150, 16, v153
    v_and_b32 v151, 0xffff0000, v153
    v_pk_add_f32 v[8:9], v[8:9], v[148:149]
    v_pk_add_f32 v[8:9], v[8:9], v[150:151]
    v_lshlrev_b32 v148, 16, v78
    v_and_b32 v149, 0xffff0000, v78
    v_lshlrev_b32 v150, 16, v79
    v_and_b32 v151, 0xffff0000, v79
    v_pk_mul_f32 v[148:149], v[148:149], v[48:49]
    v_pk_mul_f32 v[150:151], v[150:151], v[50:51]
    v_cvt_pk_bf16_f32 v152, v148, v149
    v_cvt_pk_bf16_f32 v153, v150, v151
    v_lshlrev_b32 v148, 16, v152
    v_and_b32 v149, 0xffff0000, v152
    v_lshlrev_b32 v150, 16, v153
    v_and_b32 v151, 0xffff0000, v153
    v_pk_add_f32 v[8:9], v[8:9], v[148:149]
    v_pk_add_f32 v[8:9], v[8:9], v[150:151]
    v_lshlrev_b32 v148, 16, v80
    v_and_b32 v149, 0xffff0000, v80
    v_lshlrev_b32 v150, 16, v81
    v_and_b32 v151, 0xffff0000, v81
    v_pk_mul_f32 v[148:149], v[148:149], v[52:53]
    v_pk_mul_f32 v[150:151], v[150:151], v[54:55]
    v_cvt_pk_bf16_f32 v152, v148, v149
    v_cvt_pk_bf16_f32 v153, v150, v151
    v_lshlrev_b32 v148, 16, v152
    v_and_b32 v149, 0xffff0000, v152
    v_lshlrev_b32 v150, 16, v153
    v_and_b32 v151, 0xffff0000, v153
    v_pk_add_f32 v[8:9], v[8:9], v[148:149]
    v_pk_add_f32 v[8:9], v[8:9], v[150:151]
    v_lshlrev_b32 v148, 16, v82
    v_and_b32 v149, 0xffff0000, v82
    v_lshlrev_b32 v150, 16, v83
    v_and_b32 v151, 0xffff0000, v83
    v_pk_mul_f32 v[148:149], v[148:149], v[56:57]
    v_pk_mul_f32 v[150:151], v[150:151], v[58:59]
    v_cvt_pk_bf16_f32 v152, v148, v149
    v_cvt_pk_bf16_f32 v153, v150, v151
    v_lshlrev_b32 v148, 16, v152
    v_and_b32 v149, 0xffff0000, v152
    v_lshlrev_b32 v150, 16, v153
    v_and_b32 v151, 0xffff0000, v153
    v_pk_add_f32 v[8:9], v[8:9], v[148:149]
    v_pk_add_f32 v[8:9], v[8:9], v[150:151]
    v_lshlrev_b32 v148, 16, v84
    v_and_b32 v149, 0xffff0000, v84
    v_lshlrev_b32 v150, 16, v85
    v_and_b32 v151, 0xffff0000, v85
    v_pk_mul_f32 v[148:149], v[148:149], v[60:61]
    v_pk_mul_f32 v[150:151], v[150:151], v[62:63]
    v_cvt_pk_bf16_f32 v152, v148, v149
    v_cvt_pk_bf16_f32 v153, v150, v151
    v_lshlrev_b32 v148, 16, v152
    v_and_b32 v149, 0xffff0000, v152
    v_lshlrev_b32 v150, 16, v153
    v_and_b32 v151, 0xffff0000, v153
    v_pk_add_f32 v[8:9], v[8:9], v[148:149]
    v_pk_add_f32 v[8:9], v[8:9], v[150:151]
    v_lshlrev_b32 v148, 16, v86
    v_and_b32 v149, 0xffff0000, v86
    v_lshlrev_b32 v150, 16, v87
    v_and_b32 v151, 0xffff0000, v87
    v_pk_mul_f32 v[148:149], v[148:149], v[64:65]
    v_pk_mul_f32 v[150:151], v[150:151], v[66:67]
    v_cvt_pk_bf16_f32 v152, v148, v149
    v_cvt_pk_bf16_f32 v153, v150, v151
    v_lshlrev_b32 v148, 16, v152
    v_and_b32 v149, 0xffff0000, v152
    v_lshlrev_b32 v150, 16, v153
    v_and_b32 v151, 0xffff0000, v153
    v_pk_add_f32 v[8:9], v[8:9], v[148:149]
    v_pk_add_f32 v[8:9], v[8:9], v[150:151]
    s_waitcnt vmcnt(10)
    v_mov_b32 v10, 0
    v_mov_b32 v11, 0
    v_lshlrev_b32 v148, 16, v88
    v_and_b32 v149, 0xffff0000, v88
    v_lshlrev_b32 v150, 16, v89
    v_and_b32 v151, 0xffff0000, v89
    v_pk_mul_f32 v[148:149], v[148:149], v[28:29]
    v_pk_mul_f32 v[150:151], v[150:151], v[30:31]
    v_cvt_pk_bf16_f32 v152, v148, v149
    v_cvt_pk_bf16_f32 v153, v150, v151
    v_lshlrev_b32 v148, 16, v152
    v_and_b32 v149, 0xffff0000, v152
    v_lshlrev_b32 v150, 16, v153
    v_and_b32 v151, 0xffff0000, v153
    v_pk_add_f32 v[10:11], v[10:11], v[148:149]
    v_pk_add_f32 v[10:11], v[10:11], v[150:151]
    v_lshlrev_b32 v148, 16, v90
    v_and_b32 v149, 0xffff0000, v90
    v_lshlrev_b32 v150, 16, v91
    v_and_b32 v151, 0xffff0000, v91
    v_pk_mul_f32 v[148:149], v[148:149], v[32:33]
    v_pk_mul_f32 v[150:151], v[150:151], v[34:35]
    v_cvt_pk_bf16_f32 v152, v148, v149
    v_cvt_pk_bf16_f32 v153, v150, v151
    v_lshlrev_b32 v148, 16, v152
    v_and_b32 v149, 0xffff0000, v152
    v_lshlrev_b32 v150, 16, v153
    v_and_b32 v151, 0xffff0000, v153
    v_pk_add_f32 v[10:11], v[10:11], v[148:149]
    v_pk_add_f32 v[10:11], v[10:11], v[150:151]
    v_lshlrev_b32 v148, 16, v92
    v_and_b32 v149, 0xffff0000, v92
    v_lshlrev_b32 v150, 16, v93
    v_and_b32 v151, 0xffff0000, v93
    v_pk_mul_f32 v[148:149], v[148:149], v[36:37]
    v_pk_mul_f32 v[150:151], v[150:151], v[38:39]
    v_cvt_pk_bf16_f32 v152, v148, v149
    v_cvt_pk_bf16_f32 v153, v150, v151
    v_lshlrev_b32 v148, 16, v152
    v_and_b32 v149, 0xffff0000, v152
    v_lshlrev_b32 v150, 16, v153
    v_and_b32 v151, 0xffff0000, v153
    v_pk_add_f32 v[10:11], v[10:11], v[148:149]
    v_pk_add_f32 v[10:11], v[10:11], v[150:151]
    v_lshlrev_b32 v148, 16, v94
    v_and_b32 v149, 0xffff0000, v94
    v_lshlrev_b32 v150, 16, v95
    v_and_b32 v151, 0xffff0000, v95
    v_pk_mul_f32 v[148:149], v[148:149], v[40:41]
    v_pk_mul_f32 v[150:151], v[150:151], v[42:43]
    v_cvt_pk_bf16_f32 v152, v148, v149
    v_cvt_pk_bf16_f32 v153, v150, v151
    v_lshlrev_b32 v148, 16, v152
    v_and_b32 v149, 0xffff0000, v152
    v_lshlrev_b32 v150, 16, v153
    v_and_b32 v151, 0xffff0000, v153
    v_pk_add_f32 v[10:11], v[10:11], v[148:149]
    v_pk_add_f32 v[10:11], v[10:11], v[150:151]
    v_lshlrev_b32 v148, 16, v96
    v_and_b32 v149, 0xffff0000, v96
    v_lshlrev_b32 v150, 16, v97
    v_and_b32 v151, 0xffff0000, v97
    v_pk_mul_f32 v[148:149], v[148:149], v[44:45]
    v_pk_mul_f32 v[150:151], v[150:151], v[46:47]
    v_cvt_pk_bf16_f32 v152, v148, v149
    v_cvt_pk_bf16_f32 v153, v150, v151
    v_lshlrev_b32 v148, 16, v152
    v_and_b32 v149, 0xffff0000, v152
    v_lshlrev_b32 v150, 16, v153
    v_and_b32 v151, 0xffff0000, v153
    v_pk_add_f32 v[10:11], v[10:11], v[148:149]
    v_pk_add_f32 v[10:11], v[10:11], v[150:151]
    v_lshlrev_b32 v148, 16, v98
    v_and_b32 v149, 0xffff0000, v98
    v_lshlrev_b32 v150, 16, v99
    v_and_b32 v151, 0xffff0000, v99
    v_pk_mul_f32 v[148:149], v[148:149], v[48:49]
    v_pk_mul_f32 v[150:151], v[150:151], v[50:51]
    v_cvt_pk_bf16_f32 v152, v148, v149
    v_cvt_pk_bf16_f32 v153, v150, v151
    v_lshlrev_b32 v148, 16, v152
    v_and_b32 v149, 0xffff0000, v152
    v_lshlrev_b32 v150, 16, v153
    v_and_b32 v151, 0xffff0000, v153
    v_pk_add_f32 v[10:11], v[10:11], v[148:149]
    v_pk_add_f32 v[10:11], v[10:11], v[150:151]
    v_lshlrev_b32 v148, 16, v100
    v_and_b32 v149, 0xffff0000, v100
    v_lshlrev_b32 v150, 16, v101
    v_and_b32 v151, 0xffff0000, v101
    v_pk_mul_f32 v[148:149], v[148:149], v[52:53]
    v_pk_mul_f32 v[150:151], v[150:151], v[54:55]
    v_cvt_pk_bf16_f32 v152, v148, v149
    v_cvt_pk_bf16_f32 v153, v150, v151
    v_lshlrev_b32 v148, 16, v152
    v_and_b32 v149, 0xffff0000, v152
    v_lshlrev_b32 v150, 16, v153
    v_and_b32 v151, 0xffff0000, v153
    v_pk_add_f32 v[10:11], v[10:11], v[148:149]
    v_pk_add_f32 v[10:11], v[10:11], v[150:151]
    v_lshlrev_b32 v148, 16, v102
    v_and_b32 v149, 0xffff0000, v102
    v_lshlrev_b32 v150, 16, v103
    v_and_b32 v151, 0xffff0000, v103
    v_pk_mul_f32 v[148:149], v[148:149], v[56:57]
    v_pk_mul_f32 v[150:151], v[150:151], v[58:59]
    v_cvt_pk_bf16_f32 v152, v148, v149
    v_cvt_pk_bf16_f32 v153, v150, v151
    v_lshlrev_b32 v148, 16, v152
    v_and_b32 v149, 0xffff0000, v152
    v_lshlrev_b32 v150, 16, v153
    v_and_b32 v151, 0xffff0000, v153
    v_pk_add_f32 v[10:11], v[10:11], v[148:149]
    v_pk_add_f32 v[10:11], v[10:11], v[150:151]
    v_lshlrev_b32 v148, 16, v104
    v_and_b32 v149, 0xffff0000, v104
    v_lshlrev_b32 v150, 16, v105
    v_and_b32 v151, 0xffff0000, v105
    v_pk_mul_f32 v[148:149], v[148:149], v[60:61]
    v_pk_mul_f32 v[150:151], v[150:151], v[62:63]
    v_cvt_pk_bf16_f32 v152, v148, v149
    v_cvt_pk_bf16_f32 v153, v150, v151
    v_lshlrev_b32 v148, 16, v152
    v_and_b32 v149, 0xffff0000, v152
    v_lshlrev_b32 v150, 16, v153
    v_and_b32 v151, 0xffff0000, v153
    v_pk_add_f32 v[10:11], v[10:11], v[148:149]
    v_pk_add_f32 v[10:11], v[10:11], v[150:151]
    v_lshlrev_b32 v148, 16, v106
    v_and_b32 v149, 0xffff0000, v106
    v_lshlrev_b32 v150, 16, v107
    v_and_b32 v151, 0xffff0000, v107
    v_pk_mul_f32 v[148:149], v[148:149], v[64:65]
    v_pk_mul_f32 v[150:151], v[150:151], v[66:67]
    v_cvt_pk_bf16_f32 v152, v148, v149
    v_cvt_pk_bf16_f32 v153, v150, v151
    v_lshlrev_b32 v148, 16, v152
    v_and_b32 v149, 0xffff0000, v152
    v_lshlrev_b32 v150, 16, v153
    v_and_b32 v151, 0xffff0000, v153
    v_pk_add_f32 v[10:11], v[10:11], v[148:149]
    v_pk_add_f32 v[10:11], v[10:11], v[150:151]
    s_waitcnt vmcnt(5)
    v_mov_b32 v12, 0
    v_mov_b32 v13, 0
    v_lshlrev_b32 v148, 16, v108
    v_and_b32 v149, 0xffff0000, v108
    v_lshlrev_b32 v150, 16, v109
    v_and_b32 v151, 0xffff0000, v109
    v_pk_mul_f32 v[148:149], v[148:149], v[28:29]
    v_pk_mul_f32 v[150:151], v[150:151], v[30:31]
    v_cvt_pk_bf16_f32 v152, v148, v149
    v_cvt_pk_bf16_f32 v153, v150, v151
    v_lshlrev_b32 v148, 16, v152
    v_and_b32 v149, 0xffff0000, v152
    v_lshlrev_b32 v150, 16, v153
    v_and_b32 v151, 0xffff0000, v153
    v_pk_add_f32 v[12:13], v[12:13], v[148:149]
    v_pk_add_f32 v[12:13], v[12:13], v[150:151]
    v_lshlrev_b32 v148, 16, v110
    v_and_b32 v149, 0xffff0000, v110
    v_lshlrev_b32 v150, 16, v111
    v_and_b32 v151, 0xffff0000, v111
    v_pk_mul_f32 v[148:149], v[148:149], v[32:33]
    v_pk_mul_f32 v[150:151], v[150:151], v[34:35]
    v_cvt_pk_bf16_f32 v152, v148, v149
    v_cvt_pk_bf16_f32 v153, v150, v151
    v_lshlrev_b32 v148, 16, v152
    v_and_b32 v149, 0xffff0000, v152
    v_lshlrev_b32 v150, 16, v153
    v_and_b32 v151, 0xffff0000, v153
    v_pk_add_f32 v[12:13], v[12:13], v[148:149]
    v_pk_add_f32 v[12:13], v[12:13], v[150:151]
    v_lshlrev_b32 v148, 16, v112
    v_and_b32 v149, 0xffff0000, v112
    v_lshlrev_b32 v150, 16, v113
    v_and_b32 v151, 0xffff0000, v113
    v_pk_mul_f32 v[148:149], v[148:149], v[36:37]
    v_pk_mul_f32 v[150:151], v[150:151], v[38:39]
    v_cvt_pk_bf16_f32 v152, v148, v149
    v_cvt_pk_bf16_f32 v153, v150, v151
    v_lshlrev_b32 v148, 16, v152
    v_and_b32 v149, 0xffff0000, v152
    v_lshlrev_b32 v150, 16, v153
    v_and_b32 v151, 0xffff0000, v153
    v_pk_add_f32 v[12:13], v[12:13], v[148:149]
    v_pk_add_f32 v[12:13], v[12:13], v[150:151]
    v_lshlrev_b32 v148, 16, v114
    v_and_b32 v149, 0xffff0000, v114
    v_lshlrev_b32 v150, 16, v115
    v_and_b32 v151, 0xffff0000, v115
    v_pk_mul_f32 v[148:149], v[148:149], v[40:41]
    v_pk_mul_f32 v[150:151], v[150:151], v[42:43]
    v_cvt_pk_bf16_f32 v152, v148, v149
    v_cvt_pk_bf16_f32 v153, v150, v151
    v_lshlrev_b32 v148, 16, v152
    v_and_b32 v149, 0xffff0000, v152
    v_lshlrev_b32 v150, 16, v153
    v_and_b32 v151, 0xffff0000, v153
    v_pk_add_f32 v[12:13], v[12:13], v[148:149]
    v_pk_add_f32 v[12:13], v[12:13], v[150:151]
    v_lshlrev_b32 v148, 16, v116
    v_and_b32 v149, 0xffff0000, v116
    v_lshlrev_b32 v150, 16, v117
    v_and_b32 v151, 0xffff0000, v117
    v_pk_mul_f32 v[148:149], v[148:149], v[44:45]
    v_pk_mul_f32 v[150:151], v[150:151], v[46:47]
    v_cvt_pk_bf16_f32 v152, v148, v149
    v_cvt_pk_bf16_f32 v153, v150, v151
    v_lshlrev_b32 v148, 16, v152
    v_and_b32 v149, 0xffff0000, v152
    v_lshlrev_b32 v150, 16, v153
    v_and_b32 v151, 0xffff0000, v153
    v_pk_add_f32 v[12:13], v[12:13], v[148:149]
    v_pk_add_f32 v[12:13], v[12:13], v[150:151]
    v_lshlrev_b32 v148, 16, v118
    v_and_b32 v149, 0xffff0000, v118
    v_lshlrev_b32 v150, 16, v119
    v_and_b32 v151, 0xffff0000, v119
    v_pk_mul_f32 v[148:149], v[148:149], v[48:49]
    v_pk_mul_f32 v[150:151], v[150:151], v[50:51]
    v_cvt_pk_bf16_f32 v152, v148, v149
    v_cvt_pk_bf16_f32 v153, v150, v151
    v_lshlrev_b32 v148, 16, v152
    v_and_b32 v149, 0xffff0000, v152
    v_lshlrev_b32 v150, 16, v153
    v_and_b32 v151, 0xffff0000, v153
    v_pk_add_f32 v[12:13], v[12:13], v[148:149]
    v_pk_add_f32 v[12:13], v[12:13], v[150:151]
    v_lshlrev_b32 v148, 16, v120
    v_and_b32 v149, 0xffff0000, v120
    v_lshlrev_b32 v150, 16, v121
    v_and_b32 v151, 0xffff0000, v121
    v_pk_mul_f32 v[148:149], v[148:149], v[52:53]
    v_pk_mul_f32 v[150:151], v[150:151], v[54:55]
    v_cvt_pk_bf16_f32 v152, v148, v149
    v_cvt_pk_bf16_f32 v153, v150, v151
    v_lshlrev_b32 v148, 16, v152
    v_and_b32 v149, 0xffff0000, v152
    v_lshlrev_b32 v150, 16, v153
    v_and_b32 v151, 0xffff0000, v153
    v_pk_add_f32 v[12:13], v[12:13], v[148:149]
    v_pk_add_f32 v[12:13], v[12:13], v[150:151]
    v_lshlrev_b32 v148, 16, v122
    v_and_b32 v149, 0xffff0000, v122
    v_lshlrev_b32 v150, 16, v123
    v_and_b32 v151, 0xffff0000, v123
    v_pk_mul_f32 v[148:149], v[148:149], v[56:57]
    v_pk_mul_f32 v[150:151], v[150:151], v[58:59]
    v_cvt_pk_bf16_f32 v152, v148, v149
    v_cvt_pk_bf16_f32 v153, v150, v151
    v_lshlrev_b32 v148, 16, v152
    v_and_b32 v149, 0xffff0000, v152
    v_lshlrev_b32 v150, 16, v153
    v_and_b32 v151, 0xffff0000, v153
    v_pk_add_f32 v[12:13], v[12:13], v[148:149]
    v_pk_add_f32 v[12:13], v[12:13], v[150:151]
    v_lshlrev_b32 v148, 16, v124
    v_and_b32 v149, 0xffff0000, v124
    v_lshlrev_b32 v150, 16, v125
    v_and_b32 v151, 0xffff0000, v125
    v_pk_mul_f32 v[148:149], v[148:149], v[60:61]
    v_pk_mul_f32 v[150:151], v[150:151], v[62:63]
    v_cvt_pk_bf16_f32 v152, v148, v149
    v_cvt_pk_bf16_f32 v153, v150, v151
    v_lshlrev_b32 v148, 16, v152
    v_and_b32 v149, 0xffff0000, v152
    v_lshlrev_b32 v150, 16, v153
    v_and_b32 v151, 0xffff0000, v153
    v_pk_add_f32 v[12:13], v[12:13], v[148:149]
    v_pk_add_f32 v[12:13], v[12:13], v[150:151]
    v_lshlrev_b32 v148, 16, v126
    v_and_b32 v149, 0xffff0000, v126
    v_lshlrev_b32 v150, 16, v127
    v_and_b32 v151, 0xffff0000, v127
    v_pk_mul_f32 v[148:149], v[148:149], v[64:65]
    v_pk_mul_f32 v[150:151], v[150:151], v[66:67]
    v_cvt_pk_bf16_f32 v152, v148, v149
    v_cvt_pk_bf16_f32 v153, v150, v151
    v_lshlrev_b32 v148, 16, v152
    v_and_b32 v149, 0xffff0000, v152
    v_lshlrev_b32 v150, 16, v153
    v_and_b32 v151, 0xffff0000, v153
    v_pk_add_f32 v[12:13], v[12:13], v[148:149]
    v_pk_add_f32 v[12:13], v[12:13], v[150:151]
    s_waitcnt vmcnt(0)
    v_mov_b32 v14, 0
    v_mov_b32 v15, 0
    v_lshlrev_b32 v148, 16, v128
    v_and_b32 v149, 0xffff0000, v128
    v_lshlrev_b32 v150, 16, v129
    v_and_b32 v151, 0xffff0000, v129
    v_pk_mul_f32 v[148:149], v[148:149], v[28:29]
    v_pk_mul_f32 v[150:151], v[150:151], v[30:31]
    v_cvt_pk_bf16_f32 v152, v148, v149
    v_cvt_pk_bf16_f32 v153, v150, v151
    v_lshlrev_b32 v148, 16, v152
    v_and_b32 v149, 0xffff0000, v152
    v_lshlrev_b32 v150, 16, v153
    v_and_b32 v151, 0xffff0000, v153
    v_pk_add_f32 v[14:15], v[14:15], v[148:149]
    v_pk_add_f32 v[14:15], v[14:15], v[150:151]
    v_lshlrev_b32 v148, 16, v130
    v_and_b32 v149, 0xffff0000, v130
    v_lshlrev_b32 v150, 16, v131
    v_and_b32 v151, 0xffff0000, v131
    v_pk_mul_f32 v[148:149], v[148:149], v[32:33]
    v_pk_mul_f32 v[150:151], v[150:151], v[34:35]
    v_cvt_pk_bf16_f32 v152, v148, v149
    v_cvt_pk_bf16_f32 v153, v150, v151
    v_lshlrev_b32 v148, 16, v152
    v_and_b32 v149, 0xffff0000, v152
    v_lshlrev_b32 v150, 16, v153
    v_and_b32 v151, 0xffff0000, v153
    v_pk_add_f32 v[14:15], v[14:15], v[148:149]
    v_pk_add_f32 v[14:15], v[14:15], v[150:151]
    v_lshlrev_b32 v148, 16, v132
    v_and_b32 v149, 0xffff0000, v132
    v_lshlrev_b32 v150, 16, v133
    v_and_b32 v151, 0xffff0000, v133
    v_pk_mul_f32 v[148:149], v[148:149], v[36:37]
    v_pk_mul_f32 v[150:151], v[150:151], v[38:39]
    v_cvt_pk_bf16_f32 v152, v148, v149
    v_cvt_pk_bf16_f32 v153, v150, v151
    v_lshlrev_b32 v148, 16, v152
    v_and_b32 v149, 0xffff0000, v152
    v_lshlrev_b32 v150, 16, v153
    v_and_b32 v151, 0xffff0000, v153
    v_pk_add_f32 v[14:15], v[14:15], v[148:149]
    v_pk_add_f32 v[14:15], v[14:15], v[150:151]
    v_lshlrev_b32 v148, 16, v134
    v_and_b32 v149, 0xffff0000, v134
    v_lshlrev_b32 v150, 16, v135
    v_and_b32 v151, 0xffff0000, v135
    v_pk_mul_f32 v[148:149], v[148:149], v[40:41]
    v_pk_mul_f32 v[150:151], v[150:151], v[42:43]
    v_cvt_pk_bf16_f32 v152, v148, v149
    v_cvt_pk_bf16_f32 v153, v150, v151
    v_lshlrev_b32 v148, 16, v152
    v_and_b32 v149, 0xffff0000, v152
    v_lshlrev_b32 v150, 16, v153
    v_and_b32 v151, 0xffff0000, v153
    v_pk_add_f32 v[14:15], v[14:15], v[148:149]
    v_pk_add_f32 v[14:15], v[14:15], v[150:151]
    v_lshlrev_b32 v148, 16, v136
    v_and_b32 v149, 0xffff0000, v136
    v_lshlrev_b32 v150, 16, v137
    v_and_b32 v151, 0xffff0000, v137
    v_pk_mul_f32 v[148:149], v[148:149], v[44:45]
    v_pk_mul_f32 v[150:151], v[150:151], v[46:47]
    v_cvt_pk_bf16_f32 v152, v148, v149
    v_cvt_pk_bf16_f32 v153, v150, v151
    v_lshlrev_b32 v148, 16, v152
    v_and_b32 v149, 0xffff0000, v152
    v_lshlrev_b32 v150, 16, v153
    v_and_b32 v151, 0xffff0000, v153
    v_pk_add_f32 v[14:15], v[14:15], v[148:149]
    v_pk_add_f32 v[14:15], v[14:15], v[150:151]
    v_lshlrev_b32 v148, 16, v138
    v_and_b32 v149, 0xffff0000, v138
    v_lshlrev_b32 v150, 16, v139
    v_and_b32 v151, 0xffff0000, v139
    v_pk_mul_f32 v[148:149], v[148:149], v[48:49]
    v_pk_mul_f32 v[150:151], v[150:151], v[50:51]
    v_cvt_pk_bf16_f32 v152, v148, v149
    v_cvt_pk_bf16_f32 v153, v150, v151
    v_lshlrev_b32 v148, 16, v152
    v_and_b32 v149, 0xffff0000, v152
    v_lshlrev_b32 v150, 16, v153
    v_and_b32 v151, 0xffff0000, v153
    v_pk_add_f32 v[14:15], v[14:15], v[148:149]
    v_pk_add_f32 v[14:15], v[14:15], v[150:151]
    v_lshlrev_b32 v148, 16, v140
    v_and_b32 v149, 0xffff0000, v140
    v_lshlrev_b32 v150, 16, v141
    v_and_b32 v151, 0xffff0000, v141
    v_pk_mul_f32 v[148:149], v[148:149], v[52:53]
    v_pk_mul_f32 v[150:151], v[150:151], v[54:55]
    v_cvt_pk_bf16_f32 v152, v148, v149
    v_cvt_pk_bf16_f32 v153, v150, v151
    v_lshlrev_b32 v148, 16, v152
    v_and_b32 v149, 0xffff0000, v152
    v_lshlrev_b32 v150, 16, v153
    v_and_b32 v151, 0xffff0000, v153
    v_pk_add_f32 v[14:15], v[14:15], v[148:149]
    v_pk_add_f32 v[14:15], v[14:15], v[150:151]
    v_lshlrev_b32 v148, 16, v142
    v_and_b32 v149, 0xffff0000, v142
    v_lshlrev_b32 v150, 16, v143
    v_and_b32 v151, 0xffff0000, v143
    v_pk_mul_f32 v[148:149], v[148:149], v[56:57]
    v_pk_mul_f32 v[150:151], v[150:151], v[58:59]
    v_cvt_pk_bf16_f32 v152, v148, v149
    v_cvt_pk_bf16_f32 v153, v150, v151
    v_lshlrev_b32 v148, 16, v152
    v_and_b32 v149, 0xffff0000, v152
    v_lshlrev_b32 v150, 16, v153
    v_and_b32 v151, 0xffff0000, v153
    v_pk_add_f32 v[14:15], v[14:15], v[148:149]
    v_pk_add_f32 v[14:15], v[14:15], v[150:151]
    v_lshlrev_b32 v148, 16, v144
    v_and_b32 v149, 0xffff0000, v144
    v_lshlrev_b32 v150, 16, v145
    v_and_b32 v151, 0xffff0000, v145
    v_pk_mul_f32 v[148:149], v[148:149], v[60:61]
    v_pk_mul_f32 v[150:151], v[150:151], v[62:63]
    v_cvt_pk_bf16_f32 v152, v148, v149
    v_cvt_pk_bf16_f32 v153, v150, v151
    v_lshlrev_b32 v148, 16, v152
    v_and_b32 v149, 0xffff0000, v152
    v_lshlrev_b32 v150, 16, v153
    v_and_b32 v151, 0xffff0000, v153
    v_pk_add_f32 v[14:15], v[14:15], v[148:149]
    v_pk_add_f32 v[14:15], v[14:15], v[150:151]
    v_lshlrev_b32 v148, 16, v146
    v_and_b32 v149, 0xffff0000, v146
    v_lshlrev_b32 v150, 16, v147
    v_and_b32 v151, 0xffff0000, v147
    v_pk_mul_f32 v[148:149], v[148:149], v[64:65]
    v_pk_mul_f32 v[150:151], v[150:151], v[66:67]
    v_cvt_pk_bf16_f32 v152, v148, v149
    v_cvt_pk_bf16_f32 v153, v150, v151
    v_lshlrev_b32 v148, 16, v152
    v_and_b32 v149, 0xffff0000, v152
    v_lshlrev_b32 v150, 16, v153
    v_and_b32 v151, 0xffff0000, v153
    v_pk_add_f32 v[14:15], v[14:15], v[148:149]
    v_pk_add_f32 v[14:15], v[14:15], v[150:151]
    v_add_f32 v16, v8, v9
    v_add_f32 v17, v10, v11
    v_add_f32 v18, v12, v13
    v_add_f32 v19, v14, v15
    s_nop 0
    v_add_f32_dpp v16, v16, v16 row_ror:8 row_mask:0xf bank_mask:0xf
    v_add_f32_dpp v17, v17, v17 row_ror:8 row_mask:0xf bank_mask:0xf
    v_add_f32_dpp v18, v18, v18 row_ror:8 row_mask:0xf bank_mask:0xf
    v_add_f32_dpp v19, v19, v19 row_ror:8 row_mask:0xf bank_mask:0xf
    v_add_f32_dpp v16, v16, v16 row_ror:4 row_mask:0xf bank_mask:0xf
    v_add_f32_dpp v17, v17, v17 row_ror:4 row_mask:0xf bank_mask:0xf
    v_add_f32_dpp v18, v18, v18 row_ror:4 row_mask:0xf bank_mask:0xf
    v_add_f32_dpp v19, v19, v19 row_ror:4 row_mask:0xf bank_mask:0xf
    v_add_f32_dpp v16, v16, v16 row_ror:2 row_mask:0xf bank_mask:0xf
    v_add_f32_dpp v17, v17, v17 row_ror:2 row_mask:0xf bank_mask:0xf
    v_add_f32_dpp v18, v18, v18 row_ror:2 row_mask:0xf bank_mask:0xf
    v_add_f32_dpp v19, v19, v19 row_ror:2 row_mask:0xf bank_mask:0xf
    v_add_f32_dpp v16, v16, v16 row_ror:1 row_mask:0xf bank_mask:0xf
    v_add_f32_dpp v17, v17, v17 row_ror:1 row_mask:0xf bank_mask:0xf
    v_add_f32_dpp v18, v18, v18 row_ror:1 row_mask:0xf bank_mask:0xf
    v_add_f32_dpp v19, v19, v19 row_ror:1 row_mask:0xf bank_mask:0xf
    v_cvt_pk_bf16_f32 v148, v16, v17
    v_cvt_pk_bf16_f32 v149, v18, v19
    v_lshlrev_b32 v16, 16, v148
    v_and_b32 v17, 0xffff0000, v148
    v_lshlrev_b32 v18, 16, v149
    v_and_b32 v19, 0xffff0000, v149
    v_mul_f32 v16, 0xbfb8aa3b, v16
    v_mul_f32 v17, 0xbfb8aa3b, v17
    v_mul_f32 v18, 0xbfb8aa3b, v18
    v_mul_f32 v19, 0xbfb8aa3b, v19
    v_exp_f32 v16, v16
    v_exp_f32 v17, v17
    v_exp_f32 v18, v18
    v_exp_f32 v19, v19
    s_nop 0
    v_add_f32 v16, 1.0, v16
    v_add_f32 v17, 1.0, v17
    v_add_f32 v18, 1.0, v18
    v_add_f32 v19, 1.0, v19
    v_rcp_f32 v16, v16
    v_rcp_f32 v17, v17
    v_rcp_f32 v18, v18
    v_rcp_f32 v19, v19
    s_nop 0
    v_cvt_pk_bf16_f32 v148, v16, v17
    v_cvt_pk_bf16_f32 v149, v18, v19
    v_lshlrev_b32 v16, 16, v148
    v_and_b32 v17, 0xffff0000, v148
    v_lshlrev_b32 v18, 16, v149
    v_and_b32 v19, 0xffff0000, v149
    v_sub_f32 v20, 1.0, v16
    v_sub_f32 v21, 1.0, v17
    v_sub_f32 v22, 1.0, v18
    v_sub_f32 v23, 1.0, v19
    v_cvt_pk_bf16_f32 v148, v20, v21
    v_cvt_pk_bf16_f32 v149, v22, v23
    v_lshlrev_b32 v20, 16, v148
    v_and_b32 v21, 0xffff0000, v148
    v_lshlrev_b32 v22, 16, v149
    v_and_b32 v23, 0xffff0000, v149
    v_cmp_eq_u32 vcc, 0, v5
    s_and_saveexec_b64 s[26:27], vcc
    v_mov_b32 v148, v16
    v_mov_b32 v149, v20
    buffer_store_dwordx2 v[148:149], v3, s[40:43], 0 offen offset:0 sc1
    v_mov_b32 v150, v17
    v_mov_b32 v151, v21
    buffer_store_dwordx2 v[150:151], v3, s[40:43], 0 offen offset:32 sc1
    v_mov_b32 v152, v18
    v_mov_b32 v153, v22
    buffer_store_dwordx2 v[152:153], v3, s[40:43], 0 offen offset:64 sc1
    v_mov_b32 v154, v19
    v_mov_b32 v155, v23
    buffer_store_dwordx2 v[154:155], v3, s[40:43], 0 offen offset:96 sc1
    s_mov_b64 exec, -1
    s_waitcnt vmcnt(0)
    v_mov_b32 v96, 163824
    v_mov_b32 v97, 1
    s_mov_b64 exec, 1
    ds_add_rtn_u32 v97, v96, v97
    s_waitcnt lgkmcnt(0)
    s_mov_b64 exec, -1
    v_readfirstlane_b32 s24, v97
    s_cmp_lg_u32 s24, 11
    s_cbranch_scc1 a_sig14
    v_mov_b32 v96, 163836
    ds_read_b32 v96, v96
    s_waitcnt lgkmcnt(0)
    v_readfirstlane_b32 s97, v96
    s_nop 1
    v_and_b32 v96, 3, v1
    v_lshlrev_b32 v96, 3, v96
    v_bfe_u32 v98, v1, 2, 3
    s_lshr_b32 s76, s3, 3
    s_lshl_b32 s76, s76, 5
    v_add3_u32 v96, v96, v98, s76
    v_lshlrev_b32 v96, 10, v96
    s_and_b32 s76, s3, 7
    s_lshl_b32 s76, s76, 2
    s_add_u32 s76, s76, 304
    v_add_u32 v96, s76, v96
    s_lshr_b32 s76, s3, 1
    s_and_b32 s77, s76, 3
    s_lshl_b32 s77, s77, 3
    s_lshr_b32 s76, s76, 2
    s_add_u32 s76, s76, s77
    v_and_b32 v98, 7, v1
    v_lshlrev_b32 v98, 5, v98
    v_add_u32 v98, s76, v98
    v_lshlrev_b32 v98, 10, v98
    s_and_b32 s76, s3, 1
    s_lshl_b32 s76, s76, 2
    s_add_u32 s76, s76, 336
    v_add_u32 v98, s76, v98
    v_cmp_gt_u32 vcc, 32, v1
    s_nop 1
    v_cndmask_b32 v96, v98, v96, vcc
    s_mov_b32 vcc_lo, -1
    s_mov_b32 vcc_hi, 0xff
    v_mov_b32 v97, s97
    s_mov_b64 exec, vcc
    buffer_store_dword v97, v96, s[88:91], 0 offen sc1
    s_mov_b64 exec, -1
a_sig14:
    v_mov_b32 v8, 163836
    ds_read_b32 v8, v8
    s_waitcnt lgkmcnt(0)
    v_readfirstlane_b32 s97, v8
    s_nop 1
    s_lshl_b32 s24, s2, 10
    s_add_u32 s24, s24, 640
    v_lshlrev_b32 v8, 2, v1
    v_cmp_gt_u32 vcc, 16, v1
    s_mov_b32 s76, 100000
    s_mov_b64 exec, vcc
a_poll15:
    s_sub_u32 s76, s76, 1
    s_cbranch_scc1 a_polld16
    buffer_load_dword v9, v8, s[88:91], s24 offen sc1
    s_waitcnt vmcnt(0)
    v_cmp_ne_u32 vcc, s97, v9
    s_nop 1
    s_cmp_eq_u64 vcc, 0
    s_cbranch_scc1 a_polld16
    s_sleep 1
    s_branch a_poll15
a_polld16:
    s_mov_b64 exec, -1
f_phase3:
    s_cmp_lt_u32 s96, 2
    s_cbranch_scc1 f_phase3b
    s_and_b32 s44, s2, 7
    s_lshr_b32 s45, s2, 3
    s_lshl_b32 s72, s44, 2
    s_and_b32 s44, s45, 3
    s_add_u32 s72, s72, s44
    s_lshr_b32 s73, s45, 2
    s_sub_i32 s46, s96, 2
    s_max_i32 s46, s46, 0
    s_cmp_ge_u32 s46, 5
    s_cselect_b32 s44, 5, 0
    s_cselect_b32 s45, 12288, 0
    s_sub_u32 s46, s46, s44
    s_mul_i32 s44, s73, 5
    s_add_u32 s44, s44, s46
    s_mul_i32 s44, s44, 24576
    s_add_u32 s44, s44, s45
    s_add_u32 s44, s44, 22020096
    s_add_u32 s32, s94, s44
    s_addc_u32 s33, s95, 0
    s_mov_b32 s34, 0x3000
    s_mov_b32 s35, 0x00020000
    v_lshlrev_b32 v8, 4, v1
    s_movk_i32 s44, 0
    buffer_load_dwordx4 v[64:67], v8, s[32:35], s44 offen offset:0 sc1
    buffer_load_dwordx4 v[68:71], v8, s[32:35], s44 offen offset:1024 sc1
    buffer_load_dwordx4 v[72:75], v8, s[32:35], s44 offen offset:2048 sc1
    buffer_load_dwordx4 v[76:79], v8, s[32:35], s44 offen offset:3072 sc1
    s_movk_i32 s44, 4096
    buffer_load_dwordx4 v[80:83], v8, s[32:35], s44 offen offset:0 sc1
    buffer_load_dwordx4 v[84:87], v8, s[32:35], s44 offen offset:1024 sc1
    buffer_load_dwordx4 v[88:91], v8, s[32:35], s44 offen offset:2048 sc1
    buffer_load_dwordx4 v[92:95], v8, s[32:35], s44 offen offset:3072 sc1
    s_movk_i32 s44, 8192
    buffer_load_dwordx4 v[96:99], v8, s[32:35], s44 offen offset:0 sc1
    buffer_load_dwordx4 v[100:103], v8, s[32:35], s44 offen offset:1024 sc1
    buffer_load_dwordx4 v[104:107], v8, s[32:35], s44 offen offset:2048 sc1
    buffer_load_dwordx4 v[108:111], v8, s[32:35], s44 offen offset:3072 sc1
f_phase3b:
    s_load_dwordx2 s[4:5], s[0:1], 120
    s_and_b32 s44, s2, 7
    s_lshr_b32 s45, s2, 3
    s_lshl_b32 s72, s44, 2
    s_and_b32 s44, s45, 3
    s_add_u32 s72, s72, s44
    s_lshr_b32 s73, s45, 2
    v_and_b32 v6, 15, v1
    v_lshrrev_b32 v7, 4, v1
    s_sub_i32 s14, s96, 2
    s_max_i32 s14, s14, 0
    s_mov_b32 s47, s14
    s_cmp_ge_u32 s47, 5
    s_cselect_b32 s48, 1, 0
    s_mul_i32 s44, s48, 5
    s_sub_u32 s47, s47, s44
    s_cmp_lg_u32 s96, 0
    s_cbranch_scc1 p_p3j1
    v_mov_b32 v30, 163836
    ds_read_b32 v30, v30
    s_waitcnt lgkmcnt(0)
    v_readfirstlane_b32 s97, v30
    s_nop 1
    s_lshl_b32 s44, s2, 10
    s_add_u32 s44, s44, 256
    v_lshlrev_b32 v30, 2, v1
    v_cmp_gt_u32 vcc, 22, v1
    s_mov_b32 s76, 100000
    s_mov_b64 exec, vcc
p_poll2:
    s_sub_u32 s76, s76, 1
    s_cbranch_scc1 p_polld3
    buffer_load_dword v31, v30, s[88:91], s44 offen sc1
    s_waitcnt vmcnt(0)
    v_cmp_ne_u32 vcc, s97, v31
    s_nop 1
    s_cmp_eq_u64 vcc, 0
    s_cbranch_scc1 p_polld3
    s_sleep 1
    s_branch p_poll2
p_polld3:
    s_mov_b64 exec, -1
p_p3j1:
    s_mul_i32 s44, s72, 98304
    s_add_u32 s44, s44, 6291456
    s_add_u32 s16, s94, s44
    s_addc_u32 s17, s95, 0
    s_mov_b32 s18, 0x18000
    s_mov_b32 s19, 0x00020000
    s_mul_i32 s44, s73, 327680
    s_lshl_b32 s45, s72, 7
    s_add_u32 s44, s44, s45
    s_add_u32 s44, s44, 12582912
    s_add_u32 s20, s94, s44
    s_addc_u32 s21, s95, 0
    s_mov_b32 s22, 0x4f080
    s_mov_b32 s23, 0x00020000
    s_lshl_b32 s44, s72, 9
    s_add_u32 s44, s44, 16777216
    s_add_u32 s24, s94, s44
    s_addc_u32 s25, s95, 0
    s_mov_b32 s26, 0x200
    s_mov_b32 s27, 0x00020000
    v_lshrrev_b32 v2, 3, v1
    v_and_b32 v3, 7, v1
    v_lshrrev_b32 v4, 1, v2
    v_xor_b32 v4, v3, v4
    s_and_b32 s44, s96, 1
    s_lshl_b32 s44, s44, 2
    v_xor_b32 v4, s44, v4
    v_lshlrev_b32 v4, 4, v4
    s_lshl_b32 s44, s96, 3
    v_add_u32 v14, s44, v2
    v_mul_u32_u24 v14, 1536, v14
    v_add_u32 v14, v14, v4
    v_lshlrev_b32 v15, 12, v2
    v_lshl_add_u32 v15, v3, 4, v15
    v_lshrrev_b32 v4, 1, v6
    v_xor_b32 v4, v4, v7
    v_lshlrev_b32 v4, 4, v4
    v_lshl_add_u32 v4, v6, 7, v4
    s_mul_i32 s44, s48, 49152
    v_add_u32 v10, s44, v4
    v_xor_b32 v11, 64, v10
    v_lshlrev_b32 v2, 4, v1
    s_lshl_b32 s44, s14, 11
    s_add_u32 s44, s44, 112640
    v_add_u32 v9, s44, v2
    s_mul_i32 s45, s48, 4294946816
    s_add_u32 s44, s44, s45
    s_add_u32 s44, s44, 10240
    v_add_u32 v19, s44, v2
    v_lshrrev_b32 v2, 2, v6
    v_lshl_add_u32 v2, v7, 2, v2
    v_lshlrev_b32 v2, 7, v2
    v_and_b32 v3, 3, v1
    v_lshl_add_u32 v2, v3, 3, v2
    s_lshl_b32 s44, s47, 11
    s_lshl_b32 s45, s48, 6
    s_add_u32 s44, s44, s45
    s_add_u32 s44, s44, 98304
    v_add_u32 v16, s44, v2
    s_lshl_b32 s45, s48, 5
    v_add_u32 v2, s45, v6
    v_lshlrev_b32 v18, 3, v2
    v_and_b32 v3, 1, v7
    v_lshl_add_u32 v2, v3, 4, v2
    v_mul_u32_u24 v2, 1280, v2
    v_lshrrev_b32 v3, 1, v7
    v_lshl_add_u32 v2, v3, 4, v2
    s_lshl_b32 s44, s47, 5
    v_add_u32 v17, s44, v2
    v_mov_b32 v24, 0
    v_mov_b32 v25, 0
    v_mov_b32 v26, 0
    v_mov_b32 v27, 0
    v_mov_b32 v28, 0
    v_mov_b32 v29, 0
    v_mov_b32 v30, 0
    v_mov_b32 v31, 0
    v_mov_b32 v32, 0
    v_mov_b32 v33, 0
    v_mov_b32 v34, 0
    v_mov_b32 v35, 0
    v_mov_b32 v36, 0
    v_mov_b32 v37, 0
    v_mov_b32 v38, 0
    v_mov_b32 v39, 0
    s_waitcnt lgkmcnt(0)
    s_mul_i32 s44, s72, 81920
    s_mul_i32 s45, s73, 160
    s_add_u32 s44, s44, s45
    s_add_u32 s28, s4, s44
    s_addc_u32 s29, s5, 0
    s_mov_b32 s30, 0x13ba0
    s_mov_b32 s31, 0x00020000
    s_barrier
    s_cmp_ge_u32 s96, 8
    s_cbranch_scc1 p_at4
    s_lshl_b32 s45, s96, 10
    s_add_u32 m0, s45, 0
    s_movk_i32 s44, 0
    buffer_load_dwordx4 v14, s[16:19], s44 offen sc1 lds
    s_add_u32 m0, s45, 49152
    s_movk_i32 s44, 768
    buffer_load_dwordx4 v14, s[16:19], s44 offen sc1 lds
    s_add_u32 m0, s45, 8192
    s_movk_i32 s44, 128
    buffer_load_dwordx4 v14, s[16:19], s44 offen sc1 lds
    s_add_u32 m0, s45, 57344
    s_movk_i32 s44, 896
    buffer_load_dwordx4 v14, s[16:19], s44 offen sc1 lds
    s_add_u32 m0, s45, 16384
    s_movk_i32 s44, 256
    buffer_load_dwordx4 v14, s[16:19], s44 offen sc1 lds
    s_add_u32 m0, s45, 65536
    s_movk_i32 s44, 1024
    buffer_load_dwordx4 v14, s[16:19], s44 offen sc1 lds
    s_add_u32 m0, s45, 24576
    s_movk_i32 s44, 384
    buffer_load_dwordx4 v14, s[16:19], s44 offen sc1 lds
    s_add_u32 m0, s45, 73728
    s_movk_i32 s44, 1152
    buffer_load_dwordx4 v14, s[16:19], s44 offen sc1 lds
    s_add_u32 m0, s45, 32768
    s_movk_i32 s44, 512
    buffer_load_dwordx4 v14, s[16:19], s44 offen sc1 lds
    s_add_u32 m0, s45, 81920
    s_movk_i32 s44, 1280
    buffer_load_dwordx4 v14, s[16:19], s44 offen sc1 lds
    s_add_u32 m0, s45, 40960
    s_movk_i32 s44, 640
    buffer_load_dwordx4 v14, s[16:19], s44 offen sc1 lds
    s_add_u32 m0, s45, 90112
    s_movk_i32 s44, 1408
    buffer_load_dwordx4 v14, s[16:19], s44 offen sc1 lds
    s_branch p_p3m5
p_at4:
    s_sub_u32 s44, s96, 8
    s_lshl_b32 s45, s44, 10
    s_add_u32 m0, s45, 98304
    s_lshl_b32 s44, s44, 15
    buffer_load_dwordx4 v15, s[20:23], s44 offen sc1 lds
    s_sub_u32 s44, s96, 4
    s_lshl_b32 s45, s44, 10
    s_add_u32 m0, s45, 98304
    s_lshl_b32 s44, s44, 15
    buffer_load_dwordx4 v15, s[20:23], s44 offen sc1 lds
    s_sub_u32 s44, s96, 0
    s_lshl_b32 s45, s44, 10
    s_add_u32 m0, s45, 98304
    s_lshl_b32 s44, s44, 15
    buffer_load_dwordx4 v15, s[20:23], s44 offen sc1 lds
p_p3m5:
    buffer_load_dwordx2 v[20:21], v18, s[24:27], 0 offen offset:0 sc1
    buffer_load_dwordx2 v[22:23], v18, s[24:27], 0 offen offset:128 sc1
    s_cmp_lt_u32 s96, 2
    s_cbranch_scc1 p_nc27
    s_waitcnt vmcnt(10)
    s_barrier
    ds_read_b128 v[112:115], v10 offset:0
    ds_read_b128 v[116:119], v10 offset:2048
    ds_read_b128 v[120:123], v10 offset:4096
    ds_read_b128 v[124:127], v10 offset:6144
    ds_read_b128 v[128:131], v11 offset:0
    ds_read_b128 v[132:135], v11 offset:2048
    ds_read_b128 v[136:139], v11 offset:4096
    ds_read_b128 v[140:143], v11 offset:6144
    ds_read_b128 v[144:147], v10 offset:8192
    ds_read_b128 v[148:151], v10 offset:10240
    ds_read_b128 v[152:155], v10 offset:12288
    ds_read_b128 v[156:159], v10 offset:14336
    s_waitcnt lgkmcnt(8)
    v_mfma_f32_16x16x32_bf16 v[24:27], v[64:67], v[112:115], v[24:27]
    v_mfma_f32_16x16x32_bf16 v[28:31], v[64:67], v[116:119], v[28:31]
    v_mfma_f32_16x16x32_bf16 v[32:35], v[64:67], v[120:123], v[32:35]
    v_mfma_f32_16x16x32_bf16 v[36:39], v[64:67], v[124:127], v[36:39]
    ds_read_b128 v[112:115], v11 offset:8192
    ds_read_b128 v[116:119], v11 offset:10240
    ds_read_b128 v[120:123], v11 offset:12288
    ds_read_b128 v[124:127], v11 offset:14336
    s_waitcnt lgkmcnt(8)
    v_mfma_f32_16x16x32_bf16 v[24:27], v[68:71], v[128:131], v[24:27]
    v_mfma_f32_16x16x32_bf16 v[28:31], v[68:71], v[132:135], v[28:31]
    v_mfma_f32_16x16x32_bf16 v[32:35], v[68:71], v[136:139], v[32:35]
    v_mfma_f32_16x16x32_bf16 v[36:39], v[68:71], v[140:143], v[36:39]
    s_waitcnt lgkmcnt(4)
    v_mfma_f32_16x16x32_bf16 v[24:27], v[72:75], v[144:147], v[24:27]
    v_mfma_f32_16x16x32_bf16 v[28:31], v[72:75], v[148:151], v[28:31]
    v_mfma_f32_16x16x32_bf16 v[32:35], v[72:75], v[152:155], v[32:35]
    v_mfma_f32_16x16x32_bf16 v[36:39], v[72:75], v[156:159], v[36:39]
    s_waitcnt lgkmcnt(0)
    v_mfma_f32_16x16x32_bf16 v[24:27], v[76:79], v[112:115], v[24:27]
    v_mfma_f32_16x16x32_bf16 v[28:31], v[76:79], v[116:119], v[28:31]
    v_mfma_f32_16x16x32_bf16 v[32:35], v[76:79], v[120:123], v[32:35]
    v_mfma_f32_16x16x32_bf16 v[36:39], v[76:79], v[124:127], v[36:39]
    s_waitcnt vmcnt(6)
    s_barrier
    ds_read_b128 v[128:131], v10 offset:16384
    ds_read_b128 v[132:135], v10 offset:18432
    ds_read_b128 v[136:139], v10 offset:20480
    ds_read_b128 v[140:143], v10 offset:22528
    ds_read_b128 v[144:147], v11 offset:16384
    ds_read_b128 v[148:151], v11 offset:18432
    ds_read_b128 v[152:155], v11 offset:20480
    ds_read_b128 v[156:159], v11 offset:22528
    ds_read_b128 v[112:115], v10 offset:24576
    ds_read_b128 v[116:119], v10 offset:26624
    ds_read_b128 v[120:123], v10 offset:28672
    ds_read_b128 v[124:127], v10 offset:30720
    s_waitcnt lgkmcnt(8)
    v_mfma_f32_16x16x32_bf16 v[24:27], v[80:83], v[128:131], v[24:27]
    v_mfma_f32_16x16x32_bf16 v[28:31], v[80:83], v[132:135], v[28:31]
    v_mfma_f32_16x16x32_bf16 v[32:35], v[80:83], v[136:139], v[32:35]
    v_mfma_f32_16x16x32_bf16 v[36:39], v[80:83], v[140:143], v[36:39]
    ds_read_b128 v[128:131], v11 offset:24576
    ds_read_b128 v[132:135], v11 offset:26624
    ds_read_b128 v[136:139], v11 offset:28672
    ds_read_b128 v[140:143], v11 offset:30720
    s_waitcnt lgkmcnt(8)
    v_mfma_f32_16x16x32_bf16 v[24:27], v[84:87], v[144:147], v[24:27]
    v_mfma_f32_16x16x32_bf16 v[28:31], v[84:87], v[148:151], v[28:31]
    v_mfma_f32_16x16x32_bf16 v[32:35], v[84:87], v[152:155], v[32:35]
    v_mfma_f32_16x16x32_bf16 v[36:39], v[84:87], v[156:159], v[36:39]
    s_waitcnt lgkmcnt(4)
    v_mfma_f32_16x16x32_bf16 v[24:27], v[88:91], v[112:115], v[24:27]
    v_mfma_f32_16x16x32_bf16 v[28:31], v[88:91], v[116:119], v[28:31]
    v_mfma_f32_16x16x32_bf16 v[32:35], v[88:91], v[120:123], v[32:35]
    v_mfma_f32_16x16x32_bf16 v[36:39], v[88:91], v[124:127], v[36:39]
    s_waitcnt lgkmcnt(0)
    v_mfma_f32_16x16x32_bf16 v[24:27], v[92:95], v[128:131], v[24:27]
    v_mfma_f32_16x16x32_bf16 v[28:31], v[92:95], v[132:135], v[28:31]
    v_mfma_f32_16x16x32_bf16 v[32:35], v[92:95], v[136:139], v[32:35]
    v_mfma_f32_16x16x32_bf16 v[36:39], v[92:95], v[140:143], v[36:39]
    s_waitcnt vmcnt(0)
    s_barrier
    ds_read_b128 v[144:147], v10 offset:32768
    ds_read_b128 v[148:151], v10 offset:34816
    ds_read_b128 v[152:155], v10 offset:36864
    ds_read_b128 v[156:159], v10 offset:38912
    ds_read_b128 v[112:115], v11 offset:32768
    ds_read_b128 v[116:119], v11 offset:34816
    ds_read_b128 v[120:123], v11 offset:36864
    ds_read_b128 v[124:127], v11 offset:38912
    ds_read_b128 v[128:131], v10 offset:40960
    ds_read_b128 v[132:135], v10 offset:43008
    ds_read_b128 v[136:139], v10 offset:45056
    ds_read_b128 v[140:143], v10 offset:47104
    s_waitcnt lgkmcnt(8)
    v_mfma_f32_16x16x32_bf16 v[24:27], v[96:99], v[144:147], v[24:27]
    v_mfma_f32_16x16x32_bf16 v[28:31], v[96:99], v[148:151], v[28:31]
    v_mfma_f32_16x16x32_bf16 v[32:35], v[96:99], v[152:155], v[32:35]
    v_mfma_f32_16x16x32_bf16 v[36:39], v[96:99], v[156:159], v[36:39]
    ds_read_b128 v[144:147], v11 offset:40960
    ds_read_b128 v[148:151], v11 offset:43008
    ds_read_b128 v[152:155], v11 offset:45056
    ds_read_b128 v[156:159], v11 offset:47104
    s_waitcnt lgkmcnt(8)
    v_mfma_f32_16x16x32_bf16 v[24:27], v[100:103], v[112:115], v[24:27]
    v_mfma_f32_16x16x32_bf16 v[28:31], v[100:103], v[116:119], v[28:31]
    v_mfma_f32_16x16x32_bf16 v[32:35], v[100:103], v[120:123], v[32:35]
    v_mfma_f32_16x16x32_bf16 v[36:39], v[100:103], v[124:127], v[36:39]
    s_waitcnt lgkmcnt(4)
    v_mfma_f32_16x16x32_bf16 v[24:27], v[104:107], v[128:131], v[24:27]
    v_mfma_f32_16x16x32_bf16 v[28:31], v[104:107], v[132:135], v[28:31]
    v_mfma_f32_16x16x32_bf16 v[32:35], v[104:107], v[136:139], v[32:35]
    v_mfma_f32_16x16x32_bf16 v[36:39], v[104:107], v[140:143], v[36:39]
    s_waitcnt lgkmcnt(0)
    v_mfma_f32_16x16x32_bf16 v[24:27], v[108:111], v[144:147], v[24:27]
    v_mfma_f32_16x16x32_bf16 v[28:31], v[108:111], v[148:151], v[28:31]
    v_mfma_f32_16x16x32_bf16 v[32:35], v[108:111], v[152:155], v[32:35]
    v_mfma_f32_16x16x32_bf16 v[36:39], v[108:111], v[156:159], v[36:39]
    ds_read_b64_tr_b16 v[160:161], v16 offset:0
    ds_read_b64_tr_b16 v[162:163], v16 offset:32
    s_nop 5
    s_cmp_lg_u32 s48, 0
    s_cbranch_scc1 p_x3hi8
    ds_write_b128 v9, v[32:35] offset:0
    ds_write_b128 v9, v[36:39] offset:1024
    s_branch p_x3j9
p_x3hi8:
    ds_write_b128 v9, v[24:27] offset:0
    ds_write_b128 v9, v[28:31] offset:1024
    s_nop 1
    v_pk_add_f32 v[24:25], v[32:33], 0 op_sel_hi:[1,0]
    v_pk_add_f32 v[26:27], v[34:35], 0 op_sel_hi:[1,0]
    v_pk_add_f32 v[28:29], v[36:37], 0 op_sel_hi:[1,0]
    v_pk_add_f32 v[30:31], v[38:39], 0 op_sel_hi:[1,0]
p_x3j9:
    s_waitcnt lgkmcnt(0)
    s_barrier
    ds_read_b128 v[32:35], v19 offset:0
    ds_read_b128 v[36:39], v19 offset:1024
    s_waitcnt lgkmcnt(0)
    v_pk_add_f32 v[24:25], v[24:25], v[32:33]
    v_pk_add_f32 v[26:27], v[26:27], v[34:35]
    v_pk_add_f32 v[28:29], v[28:29], v[36:37]
    v_pk_add_f32 v[30:31], v[30:31], v[38:39]
    s_waitcnt lgkmcnt(0)
    s_nop 4
    v_cvt_pk_bf16_f32 v112, v24, v25
    v_cvt_pk_bf16_f32 v113, v26, v27
    v_lshlrev_b32 v24, 16, v112
    v_and_b32 v25, 0xffff0000, v112
    v_lshlrev_b32 v26, 16, v113
    v_and_b32 v27, 0xffff0000, v113
    v_lshlrev_b32 v114, 16, v160
    v_and_b32 v115, 0xffff0000, v160
    v_lshlrev_b32 v116, 16, v161
    v_and_b32 v117, 0xffff0000, v161
    v_pk_mul_f32 v[24:25], v[24:25], v[20:21] op_sel:[0,1] op_sel_hi:[1,1]
    v_pk_mul_f32 v[114:115], v[114:115], v[20:21] op_sel_hi:[1,0]
    v_pk_mul_f32 v[26:27], v[26:27], v[20:21] op_sel:[0,1] op_sel_hi:[1,1]
    v_pk_mul_f32 v[116:117], v[116:117], v[20:21] op_sel_hi:[1,0]
    v_cvt_pk_bf16_f32 v112, v24, v25
    v_cvt_pk_bf16_f32 v113, v26, v27
    v_lshlrev_b32 v24, 16, v112
    v_and_b32 v25, 0xffff0000, v112
    v_lshlrev_b32 v26, 16, v113
    v_and_b32 v27, 0xffff0000, v113
    v_cvt_pk_bf16_f32 v112, v114, v115
    v_cvt_pk_bf16_f32 v113, v116, v117
    v_lshlrev_b32 v114, 16, v112
    v_and_b32 v115, 0xffff0000, v112
    v_lshlrev_b32 v116, 16, v113
    v_and_b32 v117, 0xffff0000, v113
    v_pk_add_f32 v[24:25], v[24:25], v[114:115]
    v_pk_add_f32 v[26:27], v[26:27], v[116:117]
    v_cvt_pk_bf16_f32 v64, v24, v25
    v_cvt_pk_bf16_f32 v65, v26, v27
    v_cvt_pk_bf16_f32 v120, v28, v29
    v_cvt_pk_bf16_f32 v121, v30, v31
    v_lshlrev_b32 v28, 16, v120
    v_and_b32 v29, 0xffff0000, v120
    v_lshlrev_b32 v30, 16, v121
    v_and_b32 v31, 0xffff0000, v121
    v_lshlrev_b32 v122, 16, v162
    v_and_b32 v123, 0xffff0000, v162
    v_lshlrev_b32 v124, 16, v163
    v_and_b32 v125, 0xffff0000, v163
    v_pk_mul_f32 v[28:29], v[28:29], v[22:23] op_sel:[0,1] op_sel_hi:[1,1]
    v_pk_mul_f32 v[122:123], v[122:123], v[22:23] op_sel_hi:[1,0]
    v_pk_mul_f32 v[30:31], v[30:31], v[22:23] op_sel:[0,1] op_sel_hi:[1,1]
    v_pk_mul_f32 v[124:125], v[124:125], v[22:23] op_sel_hi:[1,0]
    v_cvt_pk_bf16_f32 v120, v28, v29
    v_cvt_pk_bf16_f32 v121, v30, v31
    v_lshlrev_b32 v28, 16, v120
    v_and_b32 v29, 0xffff0000, v120
    v_lshlrev_b32 v30, 16, v121
    v_and_b32 v31, 0xffff0000, v121
    v_cvt_pk_bf16_f32 v120, v122, v123
    v_cvt_pk_bf16_f32 v121, v124, v125
    v_lshlrev_b32 v122, 16, v120
    v_and_b32 v123, 0xffff0000, v120
    v_lshlrev_b32 v124, 16, v121
    v_and_b32 v125, 0xffff0000, v121
    v_pk_add_f32 v[28:29], v[28:29], v[122:123]
    v_pk_add_f32 v[30:31], v[30:31], v[124:125]
    v_cvt_pk_bf16_f32 v66, v28, v29
    v_cvt_pk_bf16_f32 v67, v30, v31
    s_nop 1
    v_permlane16_swap_b32 v64, v66
    v_permlane16_swap_b32 v65, v67
    buffer_store_dwordx4 v[64:67], v17, s[28:31], 0 offen
    s_endpgm
p_nc27:
    s_waitcnt vmcnt(10)
    s_barrier
    s_waitcnt vmcnt(6)
    s_barrier
    s_waitcnt vmcnt(0)
    s_barrier
    s_endpgm
f_end:
    s_endpgm
.section .rodata,"a"
.p2align 6
.amdhsa_kernel gated_mix__ssm_conv_s4__mixer_gmlp__prompt_kernel
  .amdhsa_next_free_vgpr 168
  .amdhsa_next_free_sgpr 102
  .amdhsa_accum_offset 168
  .amdhsa_group_segment_fixed_size 0
  .amdhsa_kernarg_size 144
  .amdhsa_user_sgpr_count 2
  .amdhsa_user_sgpr_kernarg_segment_ptr 1
  .amdhsa_system_sgpr_workgroup_id_x 1
.end_amdhsa_kernel
```
